```python
import torch

def _softmax(x, axis=-1):
    return torch.softmax(x, dim=axis)

def _gelu(x):
    return torch.nn.functional.gelu(x, approximate='tanh')

def _silu(x):
    return torch.nn.functional.silu(x)

def _sigmoid(x):
    return torch.sigmoid(x)

def _layernorm(x, axis=-1, eps=1e-05):
    m = x.mean(dim=axis, keepdim=True)
    v = x.var(dim=axis, keepdim=True, unbiased=False)
    return (x - m) / torch.sqrt(v + eps)

def _scatter_add(tgt, idx, src, axis=0):
    return tgt.clone().index_add_(axis, idx, src)

def _segment_sum(src, seg, n):
    out = torch.zeros((n,) + src.shape[1:], dtype=src.dtype)
    return out.index_add_(0, seg, src)

def _pad(x, pw):
    flat = tuple((v for pair in reversed(pw) for v in pair))
    return torch.nn.functional.pad(x, flat)
kernel_name = 'gated_mix__memory_aug_recurrent_mem_tr__softmax_full_mha__prompt'

def setup_inputs():

    _w = lambda a: (lambda t: t.to(torch.bfloat16) if t.is_floating_point() else t)(torch.as_tensor(a))

    def _A_setup():
        B, S, Dm = (1, 2048, 512)
        H, Dh = (32, 128)
        M, seg = (8, 32)
        seg = min(seg, S)
        S = S // seg * seg
        return {'x': _w((lambda *s: torch.randn(*s, dtype=torch.bfloat16) * 0.05)(B, S, Dm)), 'mem0': _w((lambda *s: torch.randn(*s, dtype=torch.bfloat16) * 0.8)(B, M, Dm)), 'Wq': _w((lambda *s: torch.randn(*s, dtype=torch.bfloat16) * 1.6)(Dm, H, Dh) * Dm ** (-0.5)), 'Wk': _w((lambda *s: torch.randn(*s, dtype=torch.bfloat16) * 1.6)(Dm, H, Dh) * Dm ** (-0.5)), 'Wv': _w((lambda *s: torch.randn(*s, dtype=torch.bfloat16) * 0.8)(Dm, H, Dh) * Dm ** (-0.5)), 'Wo': _w((lambda *s: torch.randn(*s, dtype=torch.bfloat16) * 0.8)(H, Dh, Dm) * (H * Dh) ** (-0.5)), 'seg_len': seg}
    _A_in = _A_setup()

    def _B_setup():
        B, S, D = (1, 2048, 512)
        return {'x': _w((lambda *s: torch.randn(*s, dtype=torch.bfloat16) * 0.05)(B, S, D)), 'wqkv': _w((lambda *s: torch.randn(*s, dtype=torch.bfloat16) * 0.8)(D, 3 * D)), 'wo': _w((lambda *s: torch.randn(*s, dtype=torch.bfloat16) * 0.05)(D, D))}
    _B_in = _B_setup()
    return {'A_x': _A_in['x'], 'A_mem0': _A_in['mem0'], 'A_Wq': _A_in['Wq'], 'A_Wk': _A_in['Wk'], 'A_Wv': _A_in['Wv'], 'A_Wo': _A_in['Wo'], 'A_seg_len': _A_in['seg_len'], 'B_x': _B_in['x'], 'B_wqkv': _B_in['wqkv'], 'B_wo': _B_in['wo'], 'gate_w': _w((lambda *s: torch.randn(*s, dtype=torch.bfloat16) * 0.05)(512) * 16.0)}

def reference(A_x, A_mem0, A_Wq, A_Wk, A_Wv, A_Wo, A_seg_len, B_x, B_wqkv, B_wo, gate_w):

    def _A_ref(x, mem0, Wq, Wk, Wv, Wo, seg_len):
        B, S, Dm = x.shape
        H, Dh = (Wq.shape[1], Wq.shape[2])
        M = mem0.shape[1]
        scale = Dh ** (-0.5)
        n_seg = S // seg_len
        L = M + seg_len
        idx = torch.arange(L)
        mask = (idx[:, None] < M) | (idx[:, None] >= idx[None, :])
        mem = mem0
        outs = []
        for s in range(n_seg):
            xs = x[:, s * seg_len:(s + 1) * seg_len, :].clone()
            h = torch.concatenate([mem, xs], axis=1)
            q = torch.einsum('btd,dhe->bhte', h, Wq)
            k = torch.einsum('btd,dhe->bhte', h, Wk)
            v = torch.einsum('btd,dhe->bhte', h, Wv)
            scores = torch.einsum('bhqe,bhke->bhqk', q, k) * scale
            scores = torch.where(mask[None, None], scores, -1000000000.0)
            p = _softmax(scores, axis=-1)
            o = torch.einsum('bhqk,bhke->bhqe', p, v)
            o = torch.einsum('bhte,hed->btd', o, Wo)
            mem = o[:, :M, :].clone()
            outs.append(o[:, M:, :])
        return torch.concatenate(outs, axis=1)

    def _B_ref(x, wqkv, wo):
        B, S, D = x.shape
        H = 32
        Dh = D // H
        qkv = (lambda x, *d: x.permute(*d))((x @ wqkv).reshape(B, S, 3, H, Dh), 2, 0, 3, 1, 4)
        q, k, v = (qkv[0], qkv[1], qkv[2])
        scale = Dh ** (-0.5)
        scores = torch.einsum('bhqd,bhkd->bhqk', q, k) * scale
        p = _softmax(scores, axis=-1)
        o = torch.einsum('bhqk,bhkd->bhqd', p, v)
        return (lambda x, *d: x.permute(*d))(o, 0, 2, 1, 3).reshape(B, S, D) @ wo
    x = A_x
    g = _sigmoid((x * gate_w).sum(-1, keepdims=True))
    a = _A_ref(x, A_mem0, A_Wq, A_Wk, A_Wv, A_Wo, A_seg_len)
    b = _B_ref(x, B_wqkv, B_wo)
    return g * a + (1 - g) * b
```

```asm
; @launch grid=(256,1,1) block=(512,1,1) lds=163840
.amdgcn_target "amdgcn-amd-amdhsa--gfx950"
.text
.globl gated_mix__memory_aug_recurrent_mem_tr__softmax_full_mha__prompt_kernel
.p2align 8
.type gated_mix__memory_aug_recurrent_mem_tr__softmax_full_mha__prompt_kernel,@function
gated_mix__memory_aug_recurrent_mem_tr__softmax_full_mha__prompt_kernel:
s_cmp_lt_u32 s2, 256
s_cbranch_scc0 Lexit
s_load_dwordx4 s[76:79], s[0:1], 96
s_load_dwordx2 s[8:9], s[0:1], 0
s_load_dwordx8 s[64:71], s[0:1], 16
s_load_dwordx2 s[72:73], s[0:1], 64
s_getreg_b32 s3, hwreg(HW_REG_XCC_ID)
s_and_b32 s3, s3, 15
v_lshrrev_b32 v1, 6, v0
s_nop 0
v_readfirstlane_b32 s36, v1
s_mov_b32 s6, 268435456
s_mov_b32 s7, 0x20000
s_mov_b32 s33, 0
s_waitcnt lgkmcnt(0)
s_mov_b32 s98, s76
s_mov_b32 s99, s77
s_mov_b32 s4, s78
s_mov_b32 s5, s79
s_xor_b32 s3, s3, 3
s_add_u32 s3, s3, 0
s_and_b32 s94, s3, 7
s_lshr_b32 s95, s2, 3
v_mov_b32 v63, v0
s_mov_b32 s63, 1
s_mov_b32 s61, 0
Ldispatch:
s_sub_u32 s100, s94, 1
s_lshl_b32 s100, s100, 5
s_add_u32 s100, s100, s95
s_cmp_eq_u32 s94, 0
s_cbranch_scc0 Lworker
s_mov_b32 s12, s95
s_cmp_eq_u32 s3, 0
s_cselect_b32 s101, 1, 0x10001
Lchain:
s_mov_b32 s93, s36
s_lshr_b32 s15, s36, 2
s_and_b32 s13, s36, 3
s_mov_b32 s14, 0
s_mov_b32 s46, 63
s_lshl_b32 s8, s12, 7
s_lshl_b32 s40, s13, 2
s_add_u32 s8, s8, s40
s_add_u32 s8, s8, 100696064
s_lshr_b32 s9, s12, 1
s_lshl_b32 s9, s9, 7
s_add_u32 s9, s9, 100663296
s_mov_b32 s43, s9
v_and_b32 v1, 63, v0
v_lshlrev_b32 v56, 4, v1
s_lshl_b32 s40, s13, 10
v_add_u32 v57, s40, v56
s_lshr_b32 s40, 131072, s15
v_add_u32 v58, s40, v57
v_and_b32 v2, 8, v1
v_cmp_eq_u32 vcc, 0, v2
s_mov_b64 s[36:37], vcc
s_not_b64 s[38:39], vcc
v_mov_b32 v3, 0xeeee
v_mov_b32 v4, 0x4444
v_cndmask_b32 v59, v3, v4, vcc
s_mov_b32 s34, 0x3e0293ee
s_mov_b32 s35, 0x3e0293ee
s_mov_b32 s10, 0x41c00000
s_cmp_eq_u32 s15, 0
s_cbranch_scc0 LroleB
v_lshrrev_b32 v1, 4, v56
v_lshrrev_b32 v2, 4, v1
v_and_b32 v3, 15, v1
v_and_b32 v4, 1, v2
v_lshlrev_b32 v4, 2, v4
v_xor_b32 v3, v3, v4
v_lshlrev_b32 v3, 4, v3
v_xor_b32 v4, 128, v3
v_lshl_add_u32 v48, v2, 13, v3
v_lshl_add_u32 v49, v2, 13, v4
v_lshl_add_u32 v50, v2, 10, v3
v_lshl_add_u32 v51, v2, 10, v4
v_bfe_u32 v2, v1, 2, 1
v_bfe_u32 v3, v1, 3, 1
v_bfe_u32 v4, v1, 4, 1
v_bfe_u32 v5, v1, 5, 1
v_and_b32 v6, 3, v1
v_lshl_add_u32 v7, v4, 1, v2
v_xor_b32 v7, s13, v7
v_lshlrev_b32 v7, 6, v7
v_lshl_add_u32 v8, v4, 2, v2
v_lshl_add_u32 v9, v3, 3, v8
v_lshl_add_u32 v9, v5, 4, v9
v_lshl_add_u32 v52, v9, 8, v7
v_lshrrev_b32 v10, 1, v6
v_lshl_add_u32 v52, v10, 5, v52
v_and_b32 v10, 1, v6
v_lshl_add_u32 v52, v10, 3, v52
v_lshl_add_u32 v9, v5, 2, v2
v_lshl_add_u32 v9, v4, 3, v9
v_lshl_add_u32 v7, v5, 1, v2
v_xor_b32 v7, s13, v7
v_lshlrev_b32 v7, 6, v7
v_lshl_add_u32 v53, v9, 8, v7
v_lshl_add_u32 v53, v3, 5, v53
v_lshl_add_u32 v53, v6, 3, v53
v_add_u32 v52, 0, v52
v_add_u32 v53, 0, v53
s_lshl_b32 s88, s12, 8
s_lshl_b32 s90, s13, 17
s_add_u32 s88, s88, s90
s_lshl_b32 s89, s12, 17
s_lshl_b32 s90, s13, 14
s_add_u32 s89, s89, s90
s_lshl_b32 s92, s13, 12
s_add_u32 s92, s92, 0
s_waitcnt lgkmcnt(0)
s_mov_b32 s76, s64
s_mov_b32 s77, s65
s_mov_b32 s78, 4194304
s_mov_b32 s79, 0x20000
s_mov_b32 s80, s66
s_mov_b32 s81, s67
s_mov_b32 s82, 4194304
s_mov_b32 s83, 0x20000
s_add_u32 s91, s88, 0
s_add_u32 m0, s92, 0
s_nop 0
buffer_load_dwordx4 v48, s[76:79], s91 offen  lds
s_add_u32 s91, s91, 32768
s_add_u32 m0, s92, 1024
s_nop 0
buffer_load_dwordx4 v49, s[76:79], s91 offen  lds
s_add_u32 s91, s91, 32768
s_add_u32 m0, s92, 2048
s_nop 0
buffer_load_dwordx4 v48, s[76:79], s91 offen  lds
s_add_u32 s91, s91, 32768
s_add_u32 m0, s92, 3072
s_nop 0
buffer_load_dwordx4 v49, s[76:79], s91 offen  lds
s_add_u32 s91, s88, 524288
s_add_u32 m0, s92, 16384
s_nop 0
buffer_load_dwordx4 v48, s[76:79], s91 offen  lds
s_add_u32 s91, s91, 32768
s_add_u32 m0, s92, 17408
s_nop 0
buffer_load_dwordx4 v49, s[76:79], s91 offen  lds
s_add_u32 s91, s91, 32768
s_add_u32 m0, s92, 18432
s_nop 0
buffer_load_dwordx4 v48, s[76:79], s91 offen  lds
s_add_u32 s91, s91, 32768
s_add_u32 m0, s92, 19456
s_nop 0
buffer_load_dwordx4 v49, s[76:79], s91 offen  lds
s_add_u32 s91, s88, 1048576
s_add_u32 m0, s92, 32768
s_nop 0
buffer_load_dwordx4 v48, s[76:79], s91 offen  lds
s_add_u32 s91, s91, 32768
s_add_u32 m0, s92, 33792
s_nop 0
buffer_load_dwordx4 v49, s[76:79], s91 offen  lds
s_add_u32 s91, s91, 32768
s_add_u32 m0, s92, 34816
s_nop 0
buffer_load_dwordx4 v48, s[76:79], s91 offen  lds
s_add_u32 s91, s91, 32768
s_add_u32 m0, s92, 35840
s_nop 0
buffer_load_dwordx4 v49, s[76:79], s91 offen  lds
s_add_u32 s91, s88, 1572864
s_add_u32 m0, s92, 49152
s_nop 0
buffer_load_dwordx4 v48, s[76:79], s91 offen  lds
s_add_u32 s91, s91, 32768
s_add_u32 m0, s92, 50176
s_nop 0
buffer_load_dwordx4 v49, s[76:79], s91 offen  lds
s_add_u32 s91, s91, 32768
s_add_u32 m0, s92, 51200
s_nop 0
buffer_load_dwordx4 v48, s[76:79], s91 offen  lds
s_add_u32 s91, s91, 32768
s_add_u32 m0, s92, 52224
s_nop 0
buffer_load_dwordx4 v49, s[76:79], s91 offen  lds
s_and_b32 s40, s14, 3
s_lshl_b32 s16, s40, 13
s_add_u32 s16, s16, 68157440
s_add_u32 s17, s16, 4096
s_lshl_b32 s41, s12, 7
s_and_b32 s42, s13, 1
s_lshl_b32 s24, s42, 12
s_add_u32 s24, s24, s16
s_add_u32 s24, s24, s41
s_mov_b32 s26, s24
s_mov_b32 s40, 67108864
s_add_u32 s18, s40, s41
s_lshl_b32 s41, s13, 14
s_add_u32 s18, s18, s41
s_add_u32 s19, s18, 0x10000
s_add_u32 s20, s18, 0x20000
s_add_u32 s21, s18, 0x30000
s_lshl_b32 s41, s12, 12
s_add_u32 s22, s40, s41
s_lshl_b32 s42, s42, 17
s_add_u32 s22, s22, s42
s_mov_b32 s25, 0
s_lshl_b32 s41, s13, 11
s_lshl_b32 s40, s14, 5
s_add_u32 s40, s40, s12
s_lshl_b32 s27, s40, 13
s_add_u32 s27, s27, s41
s_lshr_b32 s30, s27, 1
s_add_u32 s28, s27, 16777216
s_add_u32 s29, s30, 50331648
s_add_u32 s30, s30, 58720256
s_add_u32 s23, s29, 8257536
s_add_u32 s47, s30, 8257536
s_add_u32 s40, s24, 8192
s_and_b32 s40, s40, 0x6000
s_andn2_b32 s24, s24, 0x6000
s_or_b32 s24, s24, s40
s_lshl_b32 s91, s94, 2
s_add_u32 s91, s91, 128
v_mov_b32 v61, s91
s_lshl_b32 s91, s63, s95
v_mov_b32 v62, s91
s_cmp_eq_u32 s93, 0
s_cbranch_scc0 Lnoat_1
s_mov_b64 exec, 1
global_atomic_or v62, v61, v62, s[98:99] sc0
s_mov_b64 exec, -1
Lnoat_1:
s_load_dwordx2 s[84:85], s[0:1], 8
s_lshl_b32 s42, s15, 5
s_add_u32 s42, s42, s12
v_and_b32 v24, 0x70, v56
v_lshlrev_b32 v24, 6, v24
s_lshl_b32 s40, s42, 4
v_add_u32 v24, s40, v24
s_waitcnt lgkmcnt(0)
global_load_dwordx4 v[20:23], v24, s[84:85]
s_waitcnt vmcnt(12) lgkmcnt(0)
s_barrier
ds_read_b64_tr_b16 v[64:65], v52 offset:0
ds_read_b64_tr_b16 v[66:67], v52 offset:512
ds_read_b64_tr_b16 v[68:69], v52 offset:8192
ds_read_b64_tr_b16 v[70:71], v52 offset:8704
ds_read_b64_tr_b16 v[72:73], v52 offset:16
ds_read_b64_tr_b16 v[74:75], v52 offset:528
ds_read_b64_tr_b16 v[76:77], v52 offset:8208
ds_read_b64_tr_b16 v[78:79], v52 offset:8720
s_waitcnt vmcnt(8) lgkmcnt(0)
s_barrier
s_add_u32 s91, s88, 2097152
s_add_u32 m0, s92, 0
s_nop 0
buffer_load_dwordx4 v48, s[76:79], s91 offen  lds
s_add_u32 s91, s91, 32768
s_add_u32 m0, s92, 1024
s_nop 0
buffer_load_dwordx4 v49, s[76:79], s91 offen  lds
s_add_u32 s91, s91, 32768
s_add_u32 m0, s92, 2048
s_nop 0
buffer_load_dwordx4 v48, s[76:79], s91 offen  lds
s_add_u32 s91, s91, 32768
s_add_u32 m0, s92, 3072
s_nop 0
buffer_load_dwordx4 v49, s[76:79], s91 offen  lds
ds_read_b64_tr_b16 v[80:81], v52 offset:16384
ds_read_b64_tr_b16 v[82:83], v52 offset:16896
ds_read_b64_tr_b16 v[84:85], v52 offset:24576
ds_read_b64_tr_b16 v[86:87], v52 offset:25088
ds_read_b64_tr_b16 v[88:89], v52 offset:16400
ds_read_b64_tr_b16 v[90:91], v52 offset:16912
ds_read_b64_tr_b16 v[92:93], v52 offset:24592
ds_read_b64_tr_b16 v[94:95], v52 offset:25104
s_waitcnt vmcnt(8) lgkmcnt(0)
s_barrier
s_add_u32 s91, s88, 2621440
s_add_u32 m0, s92, 16384
s_nop 0
buffer_load_dwordx4 v48, s[76:79], s91 offen  lds
s_add_u32 s91, s91, 32768
s_add_u32 m0, s92, 17408
s_nop 0
buffer_load_dwordx4 v49, s[76:79], s91 offen  lds
s_add_u32 s91, s91, 32768
s_add_u32 m0, s92, 18432
s_nop 0
buffer_load_dwordx4 v48, s[76:79], s91 offen  lds
s_add_u32 s91, s91, 32768
s_add_u32 m0, s92, 19456
s_nop 0
buffer_load_dwordx4 v49, s[76:79], s91 offen  lds
ds_read_b64_tr_b16 v[96:97], v52 offset:32768
ds_read_b64_tr_b16 v[98:99], v52 offset:33280
ds_read_b64_tr_b16 v[100:101], v52 offset:40960
ds_read_b64_tr_b16 v[102:103], v52 offset:41472
ds_read_b64_tr_b16 v[104:105], v52 offset:32784
ds_read_b64_tr_b16 v[106:107], v52 offset:33296
ds_read_b64_tr_b16 v[108:109], v52 offset:40976
ds_read_b64_tr_b16 v[110:111], v52 offset:41488
s_waitcnt vmcnt(8) lgkmcnt(0)
s_barrier
s_add_u32 s91, s88, 3145728
s_add_u32 m0, s92, 32768
s_nop 0
buffer_load_dwordx4 v48, s[76:79], s91 offen  lds
s_add_u32 s91, s91, 32768
s_add_u32 m0, s92, 33792
s_nop 0
buffer_load_dwordx4 v49, s[76:79], s91 offen  lds
s_add_u32 s91, s91, 32768
s_add_u32 m0, s92, 34816
s_nop 0
buffer_load_dwordx4 v48, s[76:79], s91 offen  lds
s_add_u32 s91, s91, 32768
s_add_u32 m0, s92, 35840
s_nop 0
buffer_load_dwordx4 v49, s[76:79], s91 offen  lds
s_xor_b32 s91, s2, 45
s_or_b32 s91, s91, s61
s_cmp_eq_u32 s91, 0
s_cbranch_scc0 Lnz_3
s_mul_i32 s91, s93, 5120
s_add_u32 s91, s91, 100663296
v_and_b32 v61, 63, v63
v_lshlrev_b32 v61, 4, v61
v_mov_b64 v[12:13], 0
v_mov_b64 v[14:15], 0
buffer_store_dwordx4 v[12:15], v61, s[4:7], s91 offen sc1
s_add_u32 s91, s91, 1024
buffer_store_dwordx4 v[12:15], v61, s[4:7], s91 offen sc1
s_add_u32 s91, s91, 1024
buffer_store_dwordx4 v[12:15], v61, s[4:7], s91 offen sc1
s_add_u32 s91, s91, 1024
buffer_store_dwordx4 v[12:15], v61, s[4:7], s91 offen sc1
s_add_u32 s91, s91, 1024
buffer_store_dwordx4 v[12:15], v61, s[4:7], s91 offen sc1
s_waitcnt vmcnt(0)
s_barrier
s_cmp_eq_u32 s93, 0
s_cbranch_scc0 Lnz_3
s_mov_b64 exec, 1
v_mov_b32 v12, 12
v_mov_b32 v13, 1
global_store_dword v12, v13, s[98:99] sc1
s_mov_b64 exec, -1
s_waitcnt vmcnt(0)
Lnz_3:
s_cmp_eq_u32 s63, 0
s_cbranch_scc1 Lcd_2
v_mov_b32 v61, 163824
s_cmp_eq_u32 s93, 0
s_cbranch_scc0 Lcf_4
s_waitcnt vmcnt(63)
s_mov_b64 exec, 1
ds_write_b32 v61, v62
s_mov_b64 exec, -1
s_waitcnt lgkmcnt(0)
Lcf_4:
s_barrier
ds_read_b32 v61, v61
s_waitcnt lgkmcnt(0)
v_readfirstlane_b32 s91, v61
s_bitcmp1_b32 s91, s95
s_cbranch_scc1 Lreclaim
Lcd_2:
v_mov_b64 v[16:17], -1
v_mov_b64 v[18:19], -1
s_lshl_b32 s40, s12, 12
s_lshl_b32 s41, s15, 17
s_add_u32 s40, s40, s41
s_add_u32 s40, s40, 67108864
buffer_store_dwordx4 v[16:19], v57, s[4:7], s40 offen sc1
v_min_u32 v20, -2, v20
v_min_u32 v21, -2, v21
v_min_u32 v22, -2, v22
v_min_u32 v23, -2, v23
s_cmp_eq_u32 s13, 0
s_cbranch_scc1 Lnz_5
v_mov_b64 v[20:21], -1
v_mov_b64 v[22:23], -1
Lnz_5:
s_lshl_b32 s42, s15, 5
s_add_u32 s42, s42, s12
s_lshl_b32 s40, s42, 7
s_lshl_b32 s41, s13, 13
s_add_u32 s40, s40, s41
s_add_u32 s40, s40, 68157440
s_mov_b64 exec, 0xff
buffer_store_dwordx4 v[20:23], v56, s[4:7], s40 offen sc1
s_mov_b64 exec, -1
ds_read_b64_tr_b16 v[112:113], v52 offset:49152
ds_read_b64_tr_b16 v[114:115], v52 offset:49664
ds_read_b64_tr_b16 v[116:117], v52 offset:57344
ds_read_b64_tr_b16 v[118:119], v52 offset:57856
ds_read_b64_tr_b16 v[120:121], v52 offset:49168
ds_read_b64_tr_b16 v[122:123], v52 offset:49680
ds_read_b64_tr_b16 v[124:125], v52 offset:57360
ds_read_b64_tr_b16 v[126:127], v52 offset:57872
s_waitcnt vmcnt(8) lgkmcnt(0)
s_barrier
s_add_u32 s91, s88, 3670016
s_add_u32 m0, s92, 49152
s_nop 0
buffer_load_dwordx4 v48, s[76:79], s91 offen  lds
s_add_u32 s91, s91, 32768
s_add_u32 m0, s92, 50176
s_nop 0
buffer_load_dwordx4 v49, s[76:79], s91 offen  lds
s_add_u32 s91, s91, 32768
s_add_u32 m0, s92, 51200
s_nop 0
buffer_load_dwordx4 v48, s[76:79], s91 offen  lds
s_add_u32 s91, s91, 32768
s_add_u32 m0, s92, 52224
s_nop 0
buffer_load_dwordx4 v49, s[76:79], s91 offen  lds
ds_read_b64_tr_b16 v[128:129], v52 offset:0
ds_read_b64_tr_b16 v[130:131], v52 offset:512
ds_read_b64_tr_b16 v[132:133], v52 offset:8192
ds_read_b64_tr_b16 v[134:135], v52 offset:8704
ds_read_b64_tr_b16 v[136:137], v52 offset:16
ds_read_b64_tr_b16 v[138:139], v52 offset:528
ds_read_b64_tr_b16 v[140:141], v52 offset:8208
ds_read_b64_tr_b16 v[142:143], v52 offset:8720
s_waitcnt vmcnt(8) lgkmcnt(0)
s_barrier
s_add_u32 s91, s88, 0
s_add_u32 m0, s92, 0
s_nop 0
buffer_load_dwordx4 v48, s[80:83], s91 offen  lds
s_add_u32 s91, s91, 32768
s_add_u32 m0, s92, 1024
s_nop 0
buffer_load_dwordx4 v49, s[80:83], s91 offen  lds
s_add_u32 s91, s91, 32768
s_add_u32 m0, s92, 2048
s_nop 0
buffer_load_dwordx4 v48, s[80:83], s91 offen  lds
s_add_u32 s91, s91, 32768
s_add_u32 m0, s92, 3072
s_nop 0
buffer_load_dwordx4 v49, s[80:83], s91 offen  lds
ds_read_b64_tr_b16 v[144:145], v52 offset:16384
ds_read_b64_tr_b16 v[146:147], v52 offset:16896
ds_read_b64_tr_b16 v[148:149], v52 offset:24576
ds_read_b64_tr_b16 v[150:151], v52 offset:25088
ds_read_b64_tr_b16 v[152:153], v52 offset:16400
ds_read_b64_tr_b16 v[154:155], v52 offset:16912
ds_read_b64_tr_b16 v[156:157], v52 offset:24592
ds_read_b64_tr_b16 v[158:159], v52 offset:25104
s_waitcnt vmcnt(8) lgkmcnt(0)
s_barrier
s_add_u32 s91, s88, 524288
s_add_u32 m0, s92, 16384
s_nop 0
buffer_load_dwordx4 v48, s[80:83], s91 offen  lds
s_add_u32 s91, s91, 32768
s_add_u32 m0, s92, 17408
s_nop 0
buffer_load_dwordx4 v49, s[80:83], s91 offen  lds
s_add_u32 s91, s91, 32768
s_add_u32 m0, s92, 18432
s_nop 0
buffer_load_dwordx4 v48, s[80:83], s91 offen  lds
s_add_u32 s91, s91, 32768
s_add_u32 m0, s92, 19456
s_nop 0
buffer_load_dwordx4 v49, s[80:83], s91 offen  lds
ds_read_b64_tr_b16 v[160:161], v52 offset:32768
ds_read_b64_tr_b16 v[162:163], v52 offset:33280
ds_read_b64_tr_b16 v[164:165], v52 offset:40960
ds_read_b64_tr_b16 v[166:167], v52 offset:41472
ds_read_b64_tr_b16 v[168:169], v52 offset:32784
ds_read_b64_tr_b16 v[170:171], v52 offset:33296
ds_read_b64_tr_b16 v[172:173], v52 offset:40976
ds_read_b64_tr_b16 v[174:175], v52 offset:41488
s_waitcnt vmcnt(8) lgkmcnt(0)
s_barrier
s_add_u32 s91, s88, 1048576
s_add_u32 m0, s92, 32768
s_nop 0
buffer_load_dwordx4 v48, s[80:83], s91 offen  lds
s_add_u32 s91, s91, 32768
s_add_u32 m0, s92, 33792
s_nop 0
buffer_load_dwordx4 v49, s[80:83], s91 offen  lds
s_add_u32 s91, s91, 32768
s_add_u32 m0, s92, 34816
s_nop 0
buffer_load_dwordx4 v48, s[80:83], s91 offen  lds
s_add_u32 s91, s91, 32768
s_add_u32 m0, s92, 35840
s_nop 0
buffer_load_dwordx4 v49, s[80:83], s91 offen  lds
v_mov_b32 v2, 4
v_mov_b32 v3, s101
s_cmp_eq_u32 s93, 0
s_cbranch_scc0 Lnoarr
s_mov_b64 exec, 1
global_atomic_add v2, v3, s[98:99]
s_mov_b64 exec, -1
Lnoarr:
ds_read_b64_tr_b16 v[176:177], v52 offset:49152
ds_read_b64_tr_b16 v[178:179], v52 offset:49664
ds_read_b64_tr_b16 v[180:181], v52 offset:57344
ds_read_b64_tr_b16 v[182:183], v52 offset:57856
ds_read_b64_tr_b16 v[184:185], v52 offset:49168
ds_read_b64_tr_b16 v[186:187], v52 offset:49680
ds_read_b64_tr_b16 v[188:189], v52 offset:57360
ds_read_b64_tr_b16 v[190:191], v52 offset:57872
s_waitcnt vmcnt(8) lgkmcnt(0)
s_barrier
s_add_u32 s91, s88, 1572864
s_add_u32 m0, s92, 49152
s_nop 0
buffer_load_dwordx4 v48, s[80:83], s91 offen  lds
s_add_u32 s91, s91, 32768
s_add_u32 m0, s92, 50176
s_nop 0
buffer_load_dwordx4 v49, s[80:83], s91 offen  lds
s_add_u32 s91, s91, 32768
s_add_u32 m0, s92, 51200
s_nop 0
buffer_load_dwordx4 v48, s[80:83], s91 offen  lds
s_add_u32 s91, s91, 32768
s_add_u32 m0, s92, 52224
s_nop 0
buffer_load_dwordx4 v49, s[80:83], s91 offen  lds
ds_read_b64_tr_b16 v[32:33], v52 offset:0
ds_read_b64_tr_b16 v[34:35], v52 offset:512
ds_read_b64_tr_b16 v[36:37], v52 offset:8192
ds_read_b64_tr_b16 v[38:39], v52 offset:8704
ds_read_b64_tr_b16 v[192:193], v52 offset:16
ds_read_b64_tr_b16 v[194:195], v52 offset:528
ds_read_b64_tr_b16 v[196:197], v52 offset:8208
ds_read_b64_tr_b16 v[198:199], v52 offset:8720
s_waitcnt lgkmcnt(0)
ds_write_b128 v58, v[32:35] offset:0
ds_write_b128 v58, v[36:39] offset:4096
s_waitcnt vmcnt(8) lgkmcnt(0)
s_barrier
s_add_u32 s91, s88, 2097152
s_add_u32 m0, s92, 0
s_nop 0
buffer_load_dwordx4 v48, s[80:83], s91 offen  lds
s_add_u32 s91, s91, 32768
s_add_u32 m0, s92, 1024
s_nop 0
buffer_load_dwordx4 v49, s[80:83], s91 offen  lds
s_add_u32 s91, s91, 32768
s_add_u32 m0, s92, 2048
s_nop 0
buffer_load_dwordx4 v48, s[80:83], s91 offen  lds
s_add_u32 s91, s91, 32768
s_add_u32 m0, s92, 3072
s_nop 0
buffer_load_dwordx4 v49, s[80:83], s91 offen  lds
ds_read_b64_tr_b16 v[32:33], v52 offset:16384
ds_read_b64_tr_b16 v[34:35], v52 offset:16896
ds_read_b64_tr_b16 v[36:37], v52 offset:24576
ds_read_b64_tr_b16 v[38:39], v52 offset:25088
ds_read_b64_tr_b16 v[200:201], v52 offset:16400
ds_read_b64_tr_b16 v[202:203], v52 offset:16912
ds_read_b64_tr_b16 v[204:205], v52 offset:24592
ds_read_b64_tr_b16 v[206:207], v52 offset:25104
s_waitcnt lgkmcnt(0)
ds_write_b128 v58, v[32:35] offset:8192
ds_write_b128 v58, v[36:39] offset:12288
s_waitcnt vmcnt(8) lgkmcnt(0)
s_barrier
s_add_u32 s91, s88, 2621440
s_add_u32 m0, s92, 16384
s_nop 0
buffer_load_dwordx4 v48, s[80:83], s91 offen  lds
s_add_u32 s91, s91, 32768
s_add_u32 m0, s92, 17408
s_nop 0
buffer_load_dwordx4 v49, s[80:83], s91 offen  lds
s_add_u32 s91, s91, 32768
s_add_u32 m0, s92, 18432
s_nop 0
buffer_load_dwordx4 v48, s[80:83], s91 offen  lds
s_add_u32 s91, s91, 32768
s_add_u32 m0, s92, 19456
s_nop 0
buffer_load_dwordx4 v49, s[80:83], s91 offen  lds
ds_read_b64_tr_b16 v[32:33], v52 offset:32768
ds_read_b64_tr_b16 v[34:35], v52 offset:33280
ds_read_b64_tr_b16 v[36:37], v52 offset:40960
ds_read_b64_tr_b16 v[38:39], v52 offset:41472
ds_read_b64_tr_b16 v[208:209], v52 offset:32784
ds_read_b64_tr_b16 v[210:211], v52 offset:33296
ds_read_b64_tr_b16 v[212:213], v52 offset:40976
ds_read_b64_tr_b16 v[214:215], v52 offset:41488
s_waitcnt lgkmcnt(0)
ds_write_b128 v58, v[32:35] offset:16384
ds_write_b128 v58, v[36:39] offset:20480
s_waitcnt vmcnt(8) lgkmcnt(0)
s_barrier
s_add_u32 s91, s88, 3145728
s_add_u32 m0, s92, 32768
s_nop 0
buffer_load_dwordx4 v48, s[80:83], s91 offen  lds
s_add_u32 s91, s91, 32768
s_add_u32 m0, s92, 33792
s_nop 0
buffer_load_dwordx4 v49, s[80:83], s91 offen  lds
s_add_u32 s91, s91, 32768
s_add_u32 m0, s92, 34816
s_nop 0
buffer_load_dwordx4 v48, s[80:83], s91 offen  lds
s_add_u32 s91, s91, 32768
s_add_u32 m0, s92, 35840
s_nop 0
buffer_load_dwordx4 v49, s[80:83], s91 offen  lds
ds_read_b64_tr_b16 v[32:33], v52 offset:49152
ds_read_b64_tr_b16 v[34:35], v52 offset:49664
ds_read_b64_tr_b16 v[36:37], v52 offset:57344
ds_read_b64_tr_b16 v[38:39], v52 offset:57856
ds_read_b64_tr_b16 v[216:217], v52 offset:49168
ds_read_b64_tr_b16 v[218:219], v52 offset:49680
ds_read_b64_tr_b16 v[220:221], v52 offset:57360
ds_read_b64_tr_b16 v[222:223], v52 offset:57872
s_waitcnt lgkmcnt(0)
ds_write_b128 v58, v[32:35] offset:24576
ds_write_b128 v58, v[36:39] offset:28672
s_waitcnt vmcnt(8) lgkmcnt(0)
s_barrier
s_add_u32 s91, s88, 3670016
s_add_u32 m0, s92, 49152
s_nop 0
buffer_load_dwordx4 v48, s[80:83], s91 offen  lds
s_add_u32 s91, s91, 32768
s_add_u32 m0, s92, 50176
s_nop 0
buffer_load_dwordx4 v49, s[80:83], s91 offen  lds
s_add_u32 s91, s91, 32768
s_add_u32 m0, s92, 51200
s_nop 0
buffer_load_dwordx4 v48, s[80:83], s91 offen  lds
s_add_u32 s91, s91, 32768
s_add_u32 m0, s92, 52224
s_nop 0
buffer_load_dwordx4 v49, s[80:83], s91 offen  lds
v_mov_b32 v44, 0
global_load_dwordx4 v[44:47], v44, s[98:99] sc1
ds_read_b64_tr_b16 v[0:1], v52 offset:0
ds_read_b64_tr_b16 v[2:3], v52 offset:512
ds_read_b64_tr_b16 v[4:5], v52 offset:8192
ds_read_b64_tr_b16 v[6:7], v52 offset:8704
ds_read_b64_tr_b16 v[224:225], v52 offset:16
ds_read_b64_tr_b16 v[226:227], v52 offset:528
ds_read_b64_tr_b16 v[228:229], v52 offset:8208
ds_read_b64_tr_b16 v[230:231], v52 offset:8720
s_waitcnt vmcnt(8) lgkmcnt(0)
s_barrier
ds_read_b64_tr_b16 v[8:9], v52 offset:16384
ds_read_b64_tr_b16 v[10:11], v52 offset:16896
ds_read_b64_tr_b16 v[12:13], v52 offset:24576
ds_read_b64_tr_b16 v[14:15], v52 offset:25088
ds_read_b64_tr_b16 v[232:233], v52 offset:16400
ds_read_b64_tr_b16 v[234:235], v52 offset:16912
ds_read_b64_tr_b16 v[236:237], v52 offset:24592
ds_read_b64_tr_b16 v[238:239], v52 offset:25104
s_waitcnt vmcnt(4) lgkmcnt(0)
s_barrier
ds_read_b64_tr_b16 v[16:17], v52 offset:32768
ds_read_b64_tr_b16 v[18:19], v52 offset:33280
ds_read_b64_tr_b16 v[20:21], v52 offset:40960
ds_read_b64_tr_b16 v[22:23], v52 offset:41472
ds_read_b64_tr_b16 v[240:241], v52 offset:32784
ds_read_b64_tr_b16 v[242:243], v52 offset:33296
ds_read_b64_tr_b16 v[244:245], v52 offset:40976
ds_read_b64_tr_b16 v[246:247], v52 offset:41488
s_waitcnt vmcnt(0) lgkmcnt(0)
s_barrier
ds_read_b64_tr_b16 v[24:25], v52 offset:49152
ds_read_b64_tr_b16 v[26:27], v52 offset:49664
ds_read_b64_tr_b16 v[28:29], v52 offset:57344
ds_read_b64_tr_b16 v[30:31], v52 offset:57856
ds_read_b64_tr_b16 v[248:249], v52 offset:49168
ds_read_b64_tr_b16 v[250:251], v52 offset:49680
ds_read_b64_tr_b16 v[252:253], v52 offset:57360
ds_read_b64_tr_b16 v[254:255], v52 offset:57872
s_waitcnt lgkmcnt(0)
s_barrier
ds_write_b128 v57, v[0:3] offset:32768
ds_write_b128 v57, v[4:7] offset:36864
ds_write_b128 v57, v[8:11] offset:40960
ds_write_b128 v57, v[12:15] offset:45056
ds_write_b128 v57, v[16:19] offset:49152
ds_write_b128 v57, v[20:23] offset:53248
ds_write_b128 v57, v[24:27] offset:57344
ds_write_b128 v57, v[28:31] offset:61440
s_waitcnt lgkmcnt(0)
LcodeA:
v_and_b32 v44, 0xffff, v45
v_mul_u32_u24 v44, v44, v47
v_cmp_gt_u32 vcc, 32, v44
s_cbranch_vccz Lhs_6
Lpl_7:
v_mov_b32 v44, 0
global_load_dwordx4 v[44:47], v44, s[98:99] sc1
s_add_u32 s33, s33, 1
s_cmp_gt_u32 s33, 524288
s_cbranch_scc1 Lexit
s_waitcnt vmcnt(0)
v_and_b32 v44, 0xffff, v45
v_mul_u32_u24 v44, v44, v47
v_cmp_gt_u32 vcc, 32, v44
s_cbranch_vccz Lpe_8
s_sleep 2
s_branch Lpl_7
Lpe_8:
Lhs_6:
v_readfirstlane_b32 s101, v45
v_lshrrev_b32 v1, 4, v56
v_xor_b32 v61, 1024, v57
v_xor_b32 v62, 2048, v57
v_xor_b32 v63, 3072, v57
v_lshrrev_b32 v52, 1, v57
v_or_b32 v53, 32, v1
v_lshlrev_b32 v53, 3, v53
v_add_u32 v53, 28672, v53
v_lshrrev_b32 v2, 4, v1
v_and_b32 v3, 7, v1
v_and_b32 v4, 8, v1
v_lshl_add_u32 v54, v2, 7, v4
v_lshl_add_u32 v54, v3, 4, v54
s_lshl_b32 s40, s13, 9
v_add_u32 v54, s40, v54
v_and_b32 v4, 15, v1
v_and_b32 v2, 1, v2
v_lshlrev_b32 v2, 2, v2
v_sub_u32 v2, v4, v2
v_mov_b32 v5, 0x3f80
v_mov_b32 v6, 0x3f800000
v_cmp_eq_u32 vcc, 0, v2
s_nop 1
v_cndmask_b32 v48, 0, v5, vcc
v_cmp_eq_u32 vcc, 1, v2
s_nop 1
v_cndmask_b32 v48, v48, v6, vcc
v_cmp_eq_u32 vcc, 2, v2
s_nop 1
v_cndmask_b32 v49, 0, v5, vcc
v_cmp_eq_u32 vcc, 3, v2
s_nop 1
v_cndmask_b32 v49, v49, v6, vcc
v_cmp_eq_u32 vcc, 8, v2
s_nop 1
v_cndmask_b32 v50, 0, v5, vcc
v_cmp_eq_u32 vcc, 9, v2
s_nop 1
v_cndmask_b32 v50, v50, v6, vcc
v_cmp_eq_u32 vcc, 10, v2
s_nop 1
v_cndmask_b32 v51, 0, v5, vcc
v_cmp_eq_u32 vcc, 11, v2
s_nop 1
v_cndmask_b32 v51, v51, v6, vcc
v_cmp_eq_u32 vcc, 0, v3
s_nop 1
v_cndmask_b32 v8, 0, v5, vcc
v_cmp_eq_u32 vcc, 1, v3
s_nop 1
v_cndmask_b32 v8, v8, v6, vcc
v_cmp_eq_u32 vcc, 2, v3
s_nop 1
v_cndmask_b32 v9, 0, v5, vcc
v_cmp_eq_u32 vcc, 3, v3
s_nop 1
v_cndmask_b32 v9, v9, v6, vcc
v_cmp_eq_u32 vcc, 4, v3
s_nop 1
v_cndmask_b32 v10, 0, v5, vcc
v_cmp_eq_u32 vcc, 5, v3
s_nop 1
v_cndmask_b32 v10, v10, v6, vcc
v_cmp_eq_u32 vcc, 6, v3
s_nop 1
v_cndmask_b32 v11, 0, v5, vcc
v_cmp_eq_u32 vcc, 7, v3
s_nop 1
v_cndmask_b32 v11, v11, v6, vcc
ds_write_b128 v56, v[8:11] offset:30720
v_and_b32 v55, 0x70, v56
v_bfe_u32 v60, v56, 9, 1
v_lshl_add_u32 v55, v60, 2, v55
v_bfe_u32 v60, v56, 8, 1
v_lshl_add_u32 v55, v60, 3, v55
v_mov_b32 v60, 0
ds_read_b128 v[32:35], v58 offset:0
ds_read_b128 v[36:39], v58 offset:4096
ds_read_b128 v[40:43], v58 offset:8192
ds_read_b128 v[44:47], v58 offset:12288
v_mov_b64 v[16:17], 0
v_mov_b64 v[18:19], 0
v_mov_b64 v[20:21], 0
v_mov_b64 v[22:23], 0
v_mov_b64 v[24:25], 0
v_mov_b64 v[26:27], 0
v_mov_b64 v[28:29], 0
v_mov_b64 v[30:31], 0
s_cmp_gt_u32 s101, 0xffff
s_cbranch_scc1 LsafeA
.p2alignl 6, 0xbf800000
s_nop 0
LstepA_9:
s_setprio 2
s_waitcnt lgkmcnt(0)
s_barrier
ds_read_b128 v[0:3], v56 offset:0
ds_read_b128 v[4:7], v56 offset:1024
ds_read_b128 v[8:11], v56 offset:2048
ds_read_b128 v[12:15], v56 offset:3072
s_waitcnt lgkmcnt(3)
v_smfmac_f32_16x16x64_bf16 v[16:19], v[0:3], v[64:71], v59
v_smfmac_f32_16x16x64_bf16 v[20:23], v[0:3], v[32:39], v59
ds_read_b128 v[32:35], v58 offset:16384
ds_read_b128 v[36:39], v58 offset:20480
v_smfmac_f32_16x16x64_bf16 v[24:27], v[0:3], v[72:79], v59
v_smfmac_f32_16x16x64_bf16 v[28:31], v[0:3], v[192:199], v59
s_waitcnt lgkmcnt(4)
v_smfmac_f32_16x16x64_bf16 v[16:19], v[4:7], v[80:87], v59
v_smfmac_f32_16x16x64_bf16 v[20:23], v[4:7], v[40:47], v59
ds_read_b128 v[40:43], v58 offset:24576
ds_read_b128 v[44:47], v58 offset:28672
v_smfmac_f32_16x16x64_bf16 v[24:27], v[4:7], v[88:95], v59
v_smfmac_f32_16x16x64_bf16 v[28:31], v[4:7], v[200:207], v59
s_waitcnt lgkmcnt(5)
v_smfmac_f32_16x16x64_bf16 v[16:19], v[8:11], v[96:103], v59
s_waitcnt lgkmcnt(2)
v_smfmac_f32_16x16x64_bf16 v[20:23], v[8:11], v[32:39], v59
ds_read_b128 v[32:35], v57 offset:32768
ds_read_b128 v[36:39], v57 offset:36864
v_smfmac_f32_16x16x64_bf16 v[24:27], v[8:11], v[104:111], v59
v_smfmac_f32_16x16x64_bf16 v[28:31], v[8:11], v[208:215], v59
v_smfmac_f32_16x16x64_bf16 v[16:19], v[12:15], v[112:119], v59
s_waitcnt lgkmcnt(2)
v_smfmac_f32_16x16x64_bf16 v[20:23], v[12:15], v[40:47], v59
ds_read_b128 v[40:43], v57 offset:40960
ds_read_b128 v[44:47], v57 offset:45056
s_barrier
ds_read_b128 v[0:3], v56 offset:4096
v_smfmac_f32_16x16x64_bf16 v[24:27], v[12:15], v[120:127], v59
ds_read_b128 v[4:7], v56 offset:5120
v_smfmac_f32_16x16x64_bf16 v[28:31], v[12:15], v[216:223], v59
ds_read_b128 v[8:11], v56 offset:6144
ds_read_b128 v[12:15], v56 offset:7168
s_waitcnt lgkmcnt(3)
v_smfmac_f32_16x16x64_bf16 v[16:19], v[0:3], v[128:135], v59
v_smfmac_f32_16x16x64_bf16 v[20:23], v[0:3], v[32:39], v59
ds_read_b128 v[32:35], v57 offset:49152
ds_read_b128 v[36:39], v57 offset:53248
v_smfmac_f32_16x16x64_bf16 v[24:27], v[0:3], v[136:143], v59
v_smfmac_f32_16x16x64_bf16 v[28:31], v[0:3], v[224:231], v59
s_waitcnt lgkmcnt(4)
v_smfmac_f32_16x16x64_bf16 v[16:19], v[4:7], v[144:151], v59
v_smfmac_f32_16x16x64_bf16 v[20:23], v[4:7], v[40:47], v59
ds_read_b128 v[40:43], v57 offset:57344
ds_read_b128 v[44:47], v57 offset:61440
v_smfmac_f32_16x16x64_bf16 v[24:27], v[4:7], v[152:159], v59
ds_read_b128 v[0:3], v57 offset:8192
v_smfmac_f32_16x16x64_bf16 v[28:31], v[4:7], v[232:239], v59
ds_read_b128 v[4:7], v57 offset:12288
s_waitcnt lgkmcnt(7)
v_smfmac_f32_16x16x64_bf16 v[16:19], v[8:11], v[160:167], v59
s_waitcnt lgkmcnt(4)
v_smfmac_f32_16x16x64_bf16 v[20:23], v[8:11], v[32:39], v59
v_smfmac_f32_16x16x64_bf16 v[16:19], v[12:15], v[176:183], v59
s_waitcnt lgkmcnt(2)
v_smfmac_f32_16x16x64_bf16 v[20:23], v[12:15], v[40:47], v59
v_smfmac_f32_16x16x64_bf16 v[24:27], v[8:11], v[168:175], v59
v_smfmac_f32_16x16x64_bf16 v[28:31], v[8:11], v[240:247], v59
v_cvt_pk_bf16_f32 v16, v16, v17
v_smfmac_f32_16x16x64_bf16 v[24:27], v[12:15], v[184:191], v59
v_cvt_pk_bf16_f32 v17, v18, v19
v_smfmac_f32_16x16x64_bf16 v[28:31], v[12:15], v[248:255], v59
s_barrier
v_cvt_pk_bf16_f32 v18, v20, v21
v_cvt_pk_bf16_f32 v19, v22, v23
v_cvt_pk_bf16_f32 v24, v24, v25
v_cvt_pk_bf16_f32 v25, v26, v27
v_mfma_f32_16x16x32_bf16 v[20:23], v[16:19], v[48:51], 0
s_nop 0
v_cvt_pk_bf16_f32 v26, v28, v29
v_cvt_pk_bf16_f32 v27, v30, v31
s_nop 1
v_mfma_f32_16x16x32_bf16 v[28:31], v[24:27], v[48:51], 0
s_waitcnt lgkmcnt(0)
s_nop 0
v_cvt_pk_bf16_f32 v16, v20, v21
v_cvt_pk_bf16_f32 v17, v22, v23
s_nop 3
v_cvt_pk_bf16_f32 v18, v28, v29
v_cvt_pk_bf16_f32 v19, v30, v31
s_nop 1
v_mfma_f32_16x16x32_bf16 v[24:27], v[4:7], v[16:19], 0
v_mfma_f32_16x16x32_bf16 v[20:23], v[0:3], v[16:19], 0
v_mfma_f32_16x16x32_bf16 v[28:31], v[16:19], v[16:19], 0
ds_read_b128 v[0:3], v57 offset:16384
ds_read_b64 v[6:7], v57 offset:20480
ds_read_b64 v[4:5], v57 offset:20488
s_nop 0
v_mov_b32_dpp v20, v24 row_ror:8 row_mask:0xf bank_mask:0xc
v_mov_b32_dpp v21, v25 row_ror:8 row_mask:0xf bank_mask:0xc
ds_write_b64 v57, v[20:21] offset:24576
v_mov_b32_dpp v22, v26 row_ror:8 row_mask:0xf bank_mask:0xc
v_mov_b32_dpp v23, v27 row_ror:8 row_mask:0xf bank_mask:0xc
ds_write_b64 v57, v[22:23] offset:24584
v_mov_b32_dpp v28, v30 row_ror:8 row_mask:0xf bank_mask:0xc
v_mov_b32_dpp v29, v31 row_ror:8 row_mask:0xf bank_mask:0xc
ds_write_b64 v52, v[28:29] offset:28672
v_pk_mul_f32 v[26:27], v[20:21], s[34:35]
s_waitcnt lgkmcnt(0)
v_pk_mul_f32 v[28:29], v[22:23], s[34:35]
s_barrier
ds_read_b128 v[32:35], v61 offset:24576
ds_read_b128 v[36:39], v62 offset:24576
ds_read_b128 v[40:43], v63 offset:24576
ds_read_b64 v[8:9], v53 offset:0
ds_read_b64 v[10:11], v53 offset:512
ds_read_b64 v[12:13], v53 offset:1024
ds_read_b64 v[14:15], v53 offset:1536
s_nop 0
s_waitcnt lgkmcnt(6)
v_pk_fma_f32 v[26:27], v[32:33], s[34:35], v[26:27]
v_pk_fma_f32 v[28:29], v[34:35], s[34:35], v[28:29]
s_waitcnt lgkmcnt(5)
v_pk_fma_f32 v[26:27], v[36:37], s[34:35], v[26:27]
v_pk_fma_f32 v[28:29], v[38:39], s[34:35], v[28:29]
s_waitcnt lgkmcnt(4)
v_pk_fma_f32 v[26:27], v[40:41], s[34:35], v[26:27]
v_pk_fma_f32 v[28:29], v[42:43], s[34:35], v[28:29]
v_exp_f32 v20, v26
v_exp_f32 v21, v27
s_waitcnt lgkmcnt(2)
v_pk_add_f32 v[8:9], v[8:9], v[10:11]
v_exp_f32 v22, v28
s_waitcnt lgkmcnt(0)
v_pk_add_f32 v[12:13], v[12:13], v[14:15]
v_exp_f32 v23, v29
v_pk_mul_f32 v[30:31], v[8:9], s[34:35]
v_cvt_pk_bf16_f32 v36, v20, v21
v_pk_fma_f32 v[30:31], v[12:13], s[34:35], v[30:31]
v_cvt_pk_bf16_f32 v37, v22, v23
v_mov_b32_dpp v38, v36 row_ror:8 row_mask:0xf bank_mask:0xf
v_exp_f32 v24, v30
v_mov_b32_dpp v39, v37 row_ror:8 row_mask:0xf bank_mask:0xf
v_exp_f32 v25, v31
s_barrier
ds_read_b128 v[44:47], v57 offset:8192
v_max3_f32 v60, abs(v26), abs(v27), abs(v28)
v_mfma_f32_16x16x32_bf16 v[8:11], v[0:3], v[36:39], 0
v_cvt_pk_bf16_f32 v40, v24, v25
v_max3_f32 v60, v60, abs(v29), abs(v30)
v_mfma_f32_16x16x32_bf16 v[12:15], v[4:7], v[36:39], 0
v_max_f32 v60, v60, abs(v31)
v_mov_b32_dpp v41, v40 row_ror:8 row_mask:0xf bank_mask:0xf
v_cmp_nle_f32 vcc, v60, s10
v_pk_add_f32 v[32:33], v[20:21], v[22:23]
v_add_f32 v34, v24, v25
v_add_f32 v32, v32, v33
s_waitcnt lgkmcnt(0)
s_cbranch_vccnz Lslow_12
Lback_13:
v_fmac_f32 v32, 0.5, v34
v_mfma_f32_16x16x16_bf16 v[8:11], v[44:45], v[40:41], v[8:11]
s_nop 0
v_add_f32_dpp v33, v32, v32 row_ror:8 row_mask:0xf bank_mask:0xf
v_add_f32_dpp v32, v32, v32 row_ror:8 row_mask:0xf bank_mask:0xf
v_mfma_f32_16x16x16_bf16 v[12:15], v[46:47], v[40:41], v[12:15]
s_mov_b64 vcc, s[36:37]
v_permlane16_swap_b32 v32, v33
v_add_f32 v34, v32, v33
v_add_f32 v32, v32, v33
s_nop 1
v_permlane32_swap_b32 v32, v34
v_add_f32 v32, v32, v34
v_rcp_f32 v32, v32
v_cndmask_b32 v8, v12, v8, vcc
v_cndmask_b32 v9, v13, v9, vcc
v_cndmask_b32 v10, v14, v10, vcc
v_cndmask_b32 v11, v15, v11, vcc
v_pk_mul_f32 v[8:9], v[8:9], v[32:33] op_sel_hi:[1,0]
v_pk_mul_f32 v[10:11], v[10:11], v[32:33] op_sel_hi:[1,0]
v_cvt_pk_bf16_f32 v8, v8, v9
v_cvt_pk_bf16_f32 v9, v10, v11
ds_write_b64 v54, v[8:9] offset:16384
s_add_u32 s14, s14, 1
s_mov_b32 s23, s29
s_add_u32 s29, s29, 131072
s_waitcnt lgkmcnt(0)
s_barrier
s_setprio 1
s_nop 15
ds_write_b128 v57, v[16:19] offset:12288
ds_read_b128 v[24:27], v56 offset:30720
s_cmp_eq_u32 s13, 0
s_cbranch_scc0 Lw1_16
s_cmp_eq_u32 s25, 0
s_cbranch_scc0 Le1_23
s_waitcnt lgkmcnt(0)
s_barrier
s_nop 15
s_nop 11
buffer_load_dwordx4 v[0:3], v56, s[4:7], s22 offen offset:0 sc1
buffer_load_dwordx4 v[4:7], v56, s[4:7], s22 offen offset:1024 sc1
buffer_load_dwordx4 v[8:11], v56, s[4:7], s22 offen offset:2048 sc1
buffer_load_dwordx4 v[12:15], v56, s[4:7], s22 offen offset:3072 sc1
s_nop 15
s_nop 15
buffer_load_dwordx4 v[32:35], v56, s[4:7], s22 offen offset:0 sc1
buffer_load_dwordx4 v[36:39], v56, s[4:7], s22 offen offset:1024 sc1
buffer_load_dwordx4 v[40:43], v56, s[4:7], s22 offen offset:2048 sc1
buffer_load_dwordx4 v[44:47], v56, s[4:7], s22 offen offset:3072 sc1
s_waitcnt vmcnt(7)
v_mfma_f32_16x16x32_bf16 v[20:23], v[0:3], v[24:27], 0
v_or_b32 v60, v0, v2
s_waitcnt vmcnt(6)
v_mfma_f32_16x16x32_bf16 v[20:23], v[4:7], v[24:27], v[20:23]
v_or3_b32 v60, v60, v4, v6
s_waitcnt vmcnt(5)
v_mfma_f32_16x16x32_bf16 v[20:23], v[8:11], v[24:27], v[20:23]
v_or3_b32 v60, v60, v8, v10
s_waitcnt vmcnt(4)
v_mfma_f32_16x16x32_bf16 v[20:23], v[12:15], v[24:27], v[20:23]
v_or3_b32 v60, v60, v12, v14
v_and_b32 v60, 1, v60
v_cmp_ne_u32 vcc, 0, v60
s_nop 4
v_permlane32_swap_b32 v20, v22
v_permlane32_swap_b32 v21, v23
v_pk_add_f32 v[20:21], v[20:21], v[22:23]
v_cvt_pk_bf16_f32 v20, v20, v21
v_min_u32 v20, -2, v20
s_cbranch_vccnz Lty_26
buffer_store_dword v20, v55, s[4:7], s24 offen
s_barrier
s_branch Ltail_24
Lty_26:
s_waitcnt vmcnt(3)
v_mfma_f32_16x16x32_bf16 v[20:23], v[32:35], v[24:27], 0
v_or_b32 v60, v32, v34
s_waitcnt vmcnt(2)
v_mfma_f32_16x16x32_bf16 v[20:23], v[36:39], v[24:27], v[20:23]
v_or3_b32 v60, v60, v36, v38
s_waitcnt vmcnt(1)
v_mfma_f32_16x16x32_bf16 v[20:23], v[40:43], v[24:27], v[20:23]
v_or3_b32 v60, v60, v40, v42
s_waitcnt vmcnt(0)
v_mfma_f32_16x16x32_bf16 v[20:23], v[44:47], v[24:27], v[20:23]
v_or3_b32 v60, v60, v44, v46
v_and_b32 v60, 1, v60
v_cmp_ne_u32 vcc, 0, v60
s_nop 4
v_permlane32_swap_b32 v20, v22
v_permlane32_swap_b32 v21, v23
v_pk_add_f32 v[20:21], v[20:21], v[22:23]
v_cvt_pk_bf16_f32 v20, v20, v21
v_min_u32 v20, -2, v20
s_cbranch_vccnz Lf0_21
buffer_store_dword v20, v55, s[4:7], s24 offen
s_barrier
s_branch Ltail_24
Le1_23:
s_waitcnt lgkmcnt(0)
s_barrier
s_nop 15
s_nop 11
buffer_load_dwordx4 v[0:3], v56, s[4:7], s22 offen offset:0 sc1
buffer_load_dwordx4 v[4:7], v56, s[4:7], s22 offen offset:1024 sc1
buffer_load_dwordx4 v[8:11], v56, s[4:7], s22 offen offset:2048 sc1
buffer_load_dwordx4 v[12:15], v56, s[4:7], s22 offen offset:3072 sc1
s_nop 15
s_nop 15
buffer_load_dwordx4 v[32:35], v56, s[4:7], s22 offen offset:0 sc1
buffer_load_dwordx4 v[36:39], v56, s[4:7], s22 offen offset:1024 sc1
buffer_load_dwordx4 v[40:43], v56, s[4:7], s22 offen offset:2048 sc1
buffer_load_dwordx4 v[44:47], v56, s[4:7], s22 offen offset:3072 sc1
s_waitcnt vmcnt(7)
v_mfma_f32_16x16x32_bf16 v[20:23], v[0:3], v[24:27], 0
v_and_b32 v60, v0, v2
s_waitcnt vmcnt(6)
v_mfma_f32_16x16x32_bf16 v[20:23], v[4:7], v[24:27], v[20:23]
v_bitop3_b32 v60, v60, v4, v6 bitop3:0x80
s_waitcnt vmcnt(5)
v_mfma_f32_16x16x32_bf16 v[20:23], v[8:11], v[24:27], v[20:23]
v_bitop3_b32 v60, v60, v8, v10 bitop3:0x80
s_waitcnt vmcnt(4)
v_mfma_f32_16x16x32_bf16 v[20:23], v[12:15], v[24:27], v[20:23]
v_bitop3_b32 v60, v60, v12, v14 bitop3:0x80
v_and_b32 v60, 1, v60
v_cmp_ne_u32 vcc, 1, v60
s_nop 4
v_permlane32_swap_b32 v20, v22
v_permlane32_swap_b32 v21, v23
v_pk_add_f32 v[20:21], v[20:21], v[22:23]
v_cvt_pk_bf16_f32 v20, v20, v21
v_min_u32 v20, -2, v20
s_cbranch_vccnz Lty_27
buffer_store_dword v20, v55, s[4:7], s24 offen
s_barrier
s_branch Ltail_24
Lty_27:
s_waitcnt vmcnt(3)
v_mfma_f32_16x16x32_bf16 v[20:23], v[32:35], v[24:27], 0
v_and_b32 v60, v32, v34
s_waitcnt vmcnt(2)
v_mfma_f32_16x16x32_bf16 v[20:23], v[36:39], v[24:27], v[20:23]
v_bitop3_b32 v60, v60, v36, v38 bitop3:0x80
s_waitcnt vmcnt(1)
v_mfma_f32_16x16x32_bf16 v[20:23], v[40:43], v[24:27], v[20:23]
v_bitop3_b32 v60, v60, v40, v42 bitop3:0x80
s_waitcnt vmcnt(0)
v_mfma_f32_16x16x32_bf16 v[20:23], v[44:47], v[24:27], v[20:23]
v_bitop3_b32 v60, v60, v44, v46 bitop3:0x80
v_and_b32 v60, 1, v60
v_cmp_ne_u32 vcc, 1, v60
s_nop 4
v_permlane32_swap_b32 v20, v22
v_permlane32_swap_b32 v21, v23
v_pk_add_f32 v[20:21], v[20:21], v[22:23]
v_cvt_pk_bf16_f32 v20, v20, v21
v_min_u32 v20, -2, v20
s_cbranch_vccnz Lf0_22
buffer_store_dword v20, v55, s[4:7], s24 offen
s_barrier
Ltail_24:
v_mov_b32 v60, -1
buffer_store_dword v60, v55, s[4:7], s26 offen
s_waitcnt vmcnt(2)
LjoinA_15:
ds_read_b128 v[32:35], v58 offset:0
ds_read_b128 v[36:39], v58 offset:4096
ds_read_b128 v[40:43], v58 offset:8192
ds_read_b128 v[44:47], v58 offset:12288
v_mov_b64 v[16:17], 0
v_mov_b64 v[18:19], 0
v_mov_b64 v[20:21], 0
v_mov_b64 v[22:23], 0
v_mov_b64 v[24:25], 0
v_mov_b64 v[26:27], 0
v_mov_b64 v[28:29], 0
v_mov_b64 v[30:31], 0
Ljoin2_28:
s_mov_b32 s26, s24
s_xor_b32 s25, s25, 1
s_add_u32 s40, s24, 8192
s_and_b32 s40, s40, 0x6000
s_andn2_b32 s24, s24, 0x6000
s_or_b32 s24, s24, s40
s_cmp_eq_u32 s14, s46
s_cbranch_scc1 LdfA_lastA
s_branch LstepA_9
Lw1_16:
s_waitcnt lgkmcnt(0)
s_barrier
s_cmp_eq_u32 s13, 1
s_cbranch_scc0 Lnored_14
s_cmp_eq_u32 s25, 0
s_cbranch_scc0 Lw1e_29
s_nop 15
s_nop 15
s_nop 15
s_nop 15
s_nop 3
buffer_load_dwordx4 v[0:3], v56, s[4:7], s22 offen offset:0 sc1
buffer_load_dwordx4 v[4:7], v56, s[4:7], s22 offen offset:1024 sc1
buffer_load_dwordx4 v[8:11], v56, s[4:7], s22 offen offset:2048 sc1
buffer_load_dwordx4 v[12:15], v56, s[4:7], s22 offen offset:3072 sc1
ds_read_b128 v[32:35], v58 offset:0
ds_read_b128 v[36:39], v58 offset:4096
ds_read_b128 v[40:43], v58 offset:8192
ds_read_b128 v[44:47], v58 offset:12288
v_mov_b64 v[16:17], 0
v_mov_b64 v[18:19], 0
v_mov_b64 v[28:29], 0
v_mov_b64 v[30:31], 0
s_barrier
s_waitcnt vmcnt(3)
v_mfma_f32_16x16x32_bf16 v[20:23], v[0:3], v[24:27], 0
v_or_b32 v60, v0, v2
s_waitcnt vmcnt(2)
v_mfma_f32_16x16x32_bf16 v[20:23], v[4:7], v[24:27], v[20:23]
v_or3_b32 v60, v60, v4, v6
s_waitcnt vmcnt(1)
v_mfma_f32_16x16x32_bf16 v[20:23], v[8:11], v[24:27], v[20:23]
v_or3_b32 v60, v60, v8, v10
s_waitcnt vmcnt(0)
v_mfma_f32_16x16x32_bf16 v[20:23], v[12:15], v[24:27], v[20:23]
v_or3_b32 v60, v60, v12, v14
v_and_b32 v60, 1, v60
v_cmp_ne_u32 vcc, 0, v60
s_nop 4
v_permlane32_swap_b32 v20, v22
v_permlane32_swap_b32 v21, v23
v_pk_add_f32 v[20:21], v[20:21], v[22:23]
v_cvt_pk_bf16_f32 v20, v20, v21
v_min_u32 v20, -2, v20
s_cbranch_vccnz Lf1_30
buffer_store_dword v20, v55, s[4:7], s24 offen
v_mov_b32 v60, -1
buffer_store_dword v60, v55, s[4:7], s26 offen
v_mov_b64 v[20:21], 0
v_mov_b64 v[22:23], 0
v_mov_b64 v[24:25], 0
v_mov_b64 v[26:27], 0
s_branch Ljoin2_28
Lf1_30:
s_waitcnt lgkmcnt(0)
buffer_load_dwordx4 v[0:3], v56, s[4:7], s22 offen offset:0 sc1
buffer_load_dwordx4 v[4:7], v56, s[4:7], s22 offen offset:1024 sc1
buffer_load_dwordx4 v[8:11], v56, s[4:7], s22 offen offset:2048 sc1
buffer_load_dwordx4 v[12:15], v56, s[4:7], s22 offen offset:3072 sc1
s_nop 15
s_nop 7
buffer_load_dwordx4 v[32:35], v56, s[4:7], s22 offen offset:0 sc1
buffer_load_dwordx4 v[36:39], v56, s[4:7], s22 offen offset:1024 sc1
buffer_load_dwordx4 v[40:43], v56, s[4:7], s22 offen offset:2048 sc1
buffer_load_dwordx4 v[44:47], v56, s[4:7], s22 offen offset:3072 sc1
s_branch LlX_17
Lw1e_29:
s_nop 15
s_nop 15
s_nop 15
s_nop 15
s_nop 3
buffer_load_dwordx4 v[0:3], v56, s[4:7], s22 offen offset:0 sc1
buffer_load_dwordx4 v[4:7], v56, s[4:7], s22 offen offset:1024 sc1
buffer_load_dwordx4 v[8:11], v56, s[4:7], s22 offen offset:2048 sc1
buffer_load_dwordx4 v[12:15], v56, s[4:7], s22 offen offset:3072 sc1
ds_read_b128 v[32:35], v58 offset:0
ds_read_b128 v[36:39], v58 offset:4096
ds_read_b128 v[40:43], v58 offset:8192
ds_read_b128 v[44:47], v58 offset:12288
v_mov_b64 v[16:17], 0
v_mov_b64 v[18:19], 0
v_mov_b64 v[28:29], 0
v_mov_b64 v[30:31], 0
s_barrier
s_waitcnt vmcnt(3)
v_mfma_f32_16x16x32_bf16 v[20:23], v[0:3], v[24:27], 0
v_and_b32 v60, v0, v2
s_waitcnt vmcnt(2)
v_mfma_f32_16x16x32_bf16 v[20:23], v[4:7], v[24:27], v[20:23]
v_bitop3_b32 v60, v60, v4, v6 bitop3:0x80
s_waitcnt vmcnt(1)
v_mfma_f32_16x16x32_bf16 v[20:23], v[8:11], v[24:27], v[20:23]
v_bitop3_b32 v60, v60, v8, v10 bitop3:0x80
s_waitcnt vmcnt(0)
v_mfma_f32_16x16x32_bf16 v[20:23], v[12:15], v[24:27], v[20:23]
v_bitop3_b32 v60, v60, v12, v14 bitop3:0x80
v_and_b32 v60, 1, v60
v_cmp_ne_u32 vcc, 1, v60
s_nop 4
v_permlane32_swap_b32 v20, v22
v_permlane32_swap_b32 v21, v23
v_pk_add_f32 v[20:21], v[20:21], v[22:23]
v_cvt_pk_bf16_f32 v20, v20, v21
v_min_u32 v20, -2, v20
s_cbranch_vccnz Lf1_31
buffer_store_dword v20, v55, s[4:7], s24 offen
v_mov_b32 v60, -1
buffer_store_dword v60, v55, s[4:7], s26 offen
v_mov_b64 v[20:21], 0
v_mov_b64 v[22:23], 0
v_mov_b64 v[24:25], 0
v_mov_b64 v[26:27], 0
s_branch Ljoin2_28
Lf1_31:
s_waitcnt lgkmcnt(0)
buffer_load_dwordx4 v[0:3], v56, s[4:7], s22 offen offset:0 sc1
buffer_load_dwordx4 v[4:7], v56, s[4:7], s22 offen offset:1024 sc1
buffer_load_dwordx4 v[8:11], v56, s[4:7], s22 offen offset:2048 sc1
buffer_load_dwordx4 v[12:15], v56, s[4:7], s22 offen offset:3072 sc1
s_nop 15
s_nop 7
buffer_load_dwordx4 v[32:35], v56, s[4:7], s22 offen offset:0 sc1
buffer_load_dwordx4 v[36:39], v56, s[4:7], s22 offen offset:1024 sc1
buffer_load_dwordx4 v[40:43], v56, s[4:7], s22 offen offset:2048 sc1
buffer_load_dwordx4 v[44:47], v56, s[4:7], s22 offen offset:3072 sc1
s_branch LlX_18
LlX_17:
s_waitcnt vmcnt(7)
v_mfma_f32_16x16x32_bf16 v[20:23], v[0:3], v[24:27], 0
v_or_b32 v60, v0, v2
s_waitcnt vmcnt(6)
v_mfma_f32_16x16x32_bf16 v[20:23], v[4:7], v[24:27], v[20:23]
v_or3_b32 v60, v60, v4, v6
s_waitcnt vmcnt(5)
v_mfma_f32_16x16x32_bf16 v[20:23], v[8:11], v[24:27], v[20:23]
v_or3_b32 v60, v60, v8, v10
s_waitcnt vmcnt(4)
v_mfma_f32_16x16x32_bf16 v[20:23], v[12:15], v[24:27], v[20:23]
v_or3_b32 v60, v60, v12, v14
v_and_b32 v60, 1, v60
v_cmp_ne_u32 vcc, 0, v60
s_nop 4
v_permlane32_swap_b32 v20, v22
v_permlane32_swap_b32 v21, v23
v_pk_add_f32 v[20:21], v[20:21], v[22:23]
v_cvt_pk_bf16_f32 v20, v20, v21
v_min_u32 v20, -2, v20
s_cbranch_vccz Lfin2_25
buffer_load_dwordx4 v[0:3], v56, s[4:7], s22 offen offset:0 sc1
buffer_load_dwordx4 v[4:7], v56, s[4:7], s22 offen offset:1024 sc1
buffer_load_dwordx4 v[8:11], v56, s[4:7], s22 offen offset:2048 sc1
buffer_load_dwordx4 v[12:15], v56, s[4:7], s22 offen offset:3072 sc1
s_add_u32 s33, s33, 1
s_cmp_gt_u32 s33, 524288
s_cbranch_scc1 Lexit
LlY_19:
s_waitcnt vmcnt(7)
v_mfma_f32_16x16x32_bf16 v[20:23], v[32:35], v[24:27], 0
v_or_b32 v60, v32, v34
s_waitcnt vmcnt(6)
v_mfma_f32_16x16x32_bf16 v[20:23], v[36:39], v[24:27], v[20:23]
v_or3_b32 v60, v60, v36, v38
s_waitcnt vmcnt(5)
v_mfma_f32_16x16x32_bf16 v[20:23], v[40:43], v[24:27], v[20:23]
v_or3_b32 v60, v60, v40, v42
s_waitcnt vmcnt(4)
v_mfma_f32_16x16x32_bf16 v[20:23], v[44:47], v[24:27], v[20:23]
v_or3_b32 v60, v60, v44, v46
v_and_b32 v60, 1, v60
v_cmp_ne_u32 vcc, 0, v60
s_nop 4
v_permlane32_swap_b32 v20, v22
v_permlane32_swap_b32 v21, v23
v_pk_add_f32 v[20:21], v[20:21], v[22:23]
v_cvt_pk_bf16_f32 v20, v20, v21
v_min_u32 v20, -2, v20
s_cbranch_vccz Lfin2_25
buffer_load_dwordx4 v[32:35], v56, s[4:7], s22 offen offset:0 sc1
buffer_load_dwordx4 v[36:39], v56, s[4:7], s22 offen offset:1024 sc1
buffer_load_dwordx4 v[40:43], v56, s[4:7], s22 offen offset:2048 sc1
buffer_load_dwordx4 v[44:47], v56, s[4:7], s22 offen offset:3072 sc1
s_add_u32 s33, s33, 1
s_cmp_gt_u32 s33, 524288
s_cbranch_scc1 Lexit
s_branch LlX_17
Lf0_21:
buffer_load_dwordx4 v[32:35], v56, s[4:7], s22 offen offset:0 sc1
buffer_load_dwordx4 v[36:39], v56, s[4:7], s22 offen offset:1024 sc1
buffer_load_dwordx4 v[40:43], v56, s[4:7], s22 offen offset:2048 sc1
buffer_load_dwordx4 v[44:47], v56, s[4:7], s22 offen offset:3072 sc1
s_nop 15
s_nop 7
buffer_load_dwordx4 v[0:3], v56, s[4:7], s22 offen offset:0 sc1
buffer_load_dwordx4 v[4:7], v56, s[4:7], s22 offen offset:1024 sc1
buffer_load_dwordx4 v[8:11], v56, s[4:7], s22 offen offset:2048 sc1
buffer_load_dwordx4 v[12:15], v56, s[4:7], s22 offen offset:3072 sc1
s_barrier
s_branch LlY_19
LlX_18:
s_waitcnt vmcnt(7)
v_mfma_f32_16x16x32_bf16 v[20:23], v[0:3], v[24:27], 0
v_and_b32 v60, v0, v2
s_waitcnt vmcnt(6)
v_mfma_f32_16x16x32_bf16 v[20:23], v[4:7], v[24:27], v[20:23]
v_bitop3_b32 v60, v60, v4, v6 bitop3:0x80
s_waitcnt vmcnt(5)
v_mfma_f32_16x16x32_bf16 v[20:23], v[8:11], v[24:27], v[20:23]
v_bitop3_b32 v60, v60, v8, v10 bitop3:0x80
s_waitcnt vmcnt(4)
v_mfma_f32_16x16x32_bf16 v[20:23], v[12:15], v[24:27], v[20:23]
v_bitop3_b32 v60, v60, v12, v14 bitop3:0x80
v_and_b32 v60, 1, v60
v_cmp_ne_u32 vcc, 1, v60
s_nop 4
v_permlane32_swap_b32 v20, v22
v_permlane32_swap_b32 v21, v23
v_pk_add_f32 v[20:21], v[20:21], v[22:23]
v_cvt_pk_bf16_f32 v20, v20, v21
v_min_u32 v20, -2, v20
s_cbranch_vccz Lfin2_25
buffer_load_dwordx4 v[0:3], v56, s[4:7], s22 offen offset:0 sc1
buffer_load_dwordx4 v[4:7], v56, s[4:7], s22 offen offset:1024 sc1
buffer_load_dwordx4 v[8:11], v56, s[4:7], s22 offen offset:2048 sc1
buffer_load_dwordx4 v[12:15], v56, s[4:7], s22 offen offset:3072 sc1
s_add_u32 s33, s33, 1
s_cmp_gt_u32 s33, 524288
s_cbranch_scc1 Lexit
LlY_20:
s_waitcnt vmcnt(7)
v_mfma_f32_16x16x32_bf16 v[20:23], v[32:35], v[24:27], 0
v_and_b32 v60, v32, v34
s_waitcnt vmcnt(6)
v_mfma_f32_16x16x32_bf16 v[20:23], v[36:39], v[24:27], v[20:23]
v_bitop3_b32 v60, v60, v36, v38 bitop3:0x80
s_waitcnt vmcnt(5)
v_mfma_f32_16x16x32_bf16 v[20:23], v[40:43], v[24:27], v[20:23]
v_bitop3_b32 v60, v60, v40, v42 bitop3:0x80
s_waitcnt vmcnt(4)
v_mfma_f32_16x16x32_bf16 v[20:23], v[44:47], v[24:27], v[20:23]
v_bitop3_b32 v60, v60, v44, v46 bitop3:0x80
v_and_b32 v60, 1, v60
v_cmp_ne_u32 vcc, 1, v60
s_nop 4
v_permlane32_swap_b32 v20, v22
v_permlane32_swap_b32 v21, v23
v_pk_add_f32 v[20:21], v[20:21], v[22:23]
v_cvt_pk_bf16_f32 v20, v20, v21
v_min_u32 v20, -2, v20
s_cbranch_vccz Lfin2_25
buffer_load_dwordx4 v[32:35], v56, s[4:7], s22 offen offset:0 sc1
buffer_load_dwordx4 v[36:39], v56, s[4:7], s22 offen offset:1024 sc1
buffer_load_dwordx4 v[40:43], v56, s[4:7], s22 offen offset:2048 sc1
buffer_load_dwordx4 v[44:47], v56, s[4:7], s22 offen offset:3072 sc1
s_add_u32 s33, s33, 1
s_cmp_gt_u32 s33, 524288
s_cbranch_scc1 Lexit
s_branch LlX_18
Lf0_22:
buffer_load_dwordx4 v[32:35], v56, s[4:7], s22 offen offset:0 sc1
buffer_load_dwordx4 v[36:39], v56, s[4:7], s22 offen offset:1024 sc1
buffer_load_dwordx4 v[40:43], v56, s[4:7], s22 offen offset:2048 sc1
buffer_load_dwordx4 v[44:47], v56, s[4:7], s22 offen offset:3072 sc1
s_nop 15
s_nop 7
buffer_load_dwordx4 v[0:3], v56, s[4:7], s22 offen offset:0 sc1
buffer_load_dwordx4 v[4:7], v56, s[4:7], s22 offen offset:1024 sc1
buffer_load_dwordx4 v[8:11], v56, s[4:7], s22 offen offset:2048 sc1
buffer_load_dwordx4 v[12:15], v56, s[4:7], s22 offen offset:3072 sc1
s_barrier
s_branch LlY_20
Lfin2_25:
buffer_store_dword v20, v55, s[4:7], s24 offen
s_branch Ltail_24
Lnored_14:
s_waitcnt vmcnt(0)
s_barrier
s_branch LjoinA_15
Lslow_12:
v_max3_f32 v60, v26, v27, v28
v_max3_f32 v60, v60, v29, v30
v_max_f32 v60, v60, v31
s_nop 1
v_max_f32_dpp v32, v60, v60 row_ror:8 row_mask:0xf bank_mask:0xf
v_max_f32_dpp v60, v60, v60 row_ror:8 row_mask:0xf bank_mask:0xf
s_nop 1
v_permlane16_swap_b32 v60, v32
v_max_f32 v33, v60, v32
v_max_f32 v60, v60, v32
s_nop 1
v_permlane32_swap_b32 v60, v33
v_max_f32 v60, v60, v33
v_sub_f32 v26, v26, v60
v_sub_f32 v27, v27, v60
v_sub_f32 v28, v28, v60
v_sub_f32 v29, v29, v60
v_sub_f32 v30, v30, v60
v_sub_f32 v31, v31, v60
v_exp_f32 v20, v26
v_exp_f32 v21, v27
v_exp_f32 v22, v28
v_exp_f32 v23, v29
v_exp_f32 v24, v30
v_exp_f32 v25, v31
v_cvt_pk_bf16_f32 v36, v20, v21
v_cvt_pk_bf16_f32 v37, v22, v23
s_nop 0
v_mov_b32_dpp v38, v36 row_ror:8 row_mask:0xf bank_mask:0xf
v_mov_b32_dpp v39, v37 row_ror:8 row_mask:0xf bank_mask:0xf
s_nop 1
v_mfma_f32_16x16x32_bf16 v[8:11], v[0:3], v[36:39], 0
v_cvt_pk_bf16_f32 v40, v24, v25
v_mfma_f32_16x16x32_bf16 v[12:15], v[4:7], v[36:39], 0
s_nop 0
v_mov_b32_dpp v41, v40 row_ror:8 row_mask:0xf bank_mask:0xf
v_pk_add_f32 v[32:33], v[20:21], v[22:23]
v_add_f32 v34, v24, v25
v_add_f32 v32, v32, v33
s_nop 2
s_branch Lback_13
LdfA_pubA:
v_min_u32 v16, -2, v16
v_min_u32 v17, -2, v17
v_min_u32 v18, -2, v18
v_min_u32 v19, -2, v19
s_mov_b64 exec, s[38:39]
buffer_store_dwordx4 v[16:19], v56, s[4:7], s29 offen sc1
s_mov_b64 exec, -1
s_branch LdfA
LdfA_lastA:
s_setprio 2
s_waitcnt lgkmcnt(0)
s_barrier
ds_read_b128 v[0:3], v56 offset:0
ds_read_b128 v[4:7], v56 offset:1024
ds_read_b128 v[8:11], v56 offset:2048
ds_read_b128 v[12:15], v56 offset:3072
s_waitcnt lgkmcnt(3)
v_smfmac_f32_16x16x64_bf16 v[20:23], v[0:3], v[32:39], v59
ds_read_b128 v[32:35], v58 offset:16384
ds_read_b128 v[36:39], v58 offset:20480
v_smfmac_f32_16x16x64_bf16 v[28:31], v[0:3], v[192:199], v59
s_waitcnt lgkmcnt(4)
v_smfmac_f32_16x16x64_bf16 v[20:23], v[4:7], v[40:47], v59
ds_read_b128 v[40:43], v58 offset:24576
ds_read_b128 v[44:47], v58 offset:28672
v_smfmac_f32_16x16x64_bf16 v[28:31], v[4:7], v[200:207], v59
s_waitcnt lgkmcnt(5)
s_waitcnt lgkmcnt(2)
v_smfmac_f32_16x16x64_bf16 v[20:23], v[8:11], v[32:39], v59
ds_read_b128 v[32:35], v57 offset:32768
ds_read_b128 v[36:39], v57 offset:36864
v_smfmac_f32_16x16x64_bf16 v[28:31], v[8:11], v[208:215], v59
s_waitcnt lgkmcnt(2)
v_smfmac_f32_16x16x64_bf16 v[20:23], v[12:15], v[40:47], v59
ds_read_b128 v[40:43], v57 offset:40960
ds_read_b128 v[44:47], v57 offset:45056
s_barrier
ds_read_b128 v[0:3], v56 offset:4096
ds_read_b128 v[4:7], v56 offset:5120
v_smfmac_f32_16x16x64_bf16 v[28:31], v[12:15], v[216:223], v59
ds_read_b128 v[8:11], v56 offset:6144
ds_read_b128 v[12:15], v56 offset:7168
s_waitcnt lgkmcnt(3)
v_smfmac_f32_16x16x64_bf16 v[20:23], v[0:3], v[32:39], v59
ds_read_b128 v[32:35], v57 offset:49152
ds_read_b128 v[36:39], v57 offset:53248
v_smfmac_f32_16x16x64_bf16 v[28:31], v[0:3], v[224:231], v59
s_waitcnt lgkmcnt(4)
v_smfmac_f32_16x16x64_bf16 v[20:23], v[4:7], v[40:47], v59
ds_read_b128 v[40:43], v57 offset:57344
ds_read_b128 v[44:47], v57 offset:61440
ds_read_b128 v[0:3], v57 offset:8192
v_smfmac_f32_16x16x64_bf16 v[28:31], v[4:7], v[232:239], v59
ds_read_b128 v[4:7], v57 offset:12288
s_waitcnt lgkmcnt(7)
s_waitcnt lgkmcnt(4)
v_smfmac_f32_16x16x64_bf16 v[20:23], v[8:11], v[32:39], v59
s_waitcnt lgkmcnt(2)
v_smfmac_f32_16x16x64_bf16 v[20:23], v[12:15], v[40:47], v59
v_smfmac_f32_16x16x64_bf16 v[28:31], v[8:11], v[240:247], v59
v_cvt_pk_bf16_f32 v16, v16, v17
v_cvt_pk_bf16_f32 v17, v18, v19
v_smfmac_f32_16x16x64_bf16 v[28:31], v[12:15], v[248:255], v59
v_cvt_pk_bf16_f32 v18, v20, v21
v_cvt_pk_bf16_f32 v19, v22, v23
v_cvt_pk_bf16_f32 v24, v24, v25
v_cvt_pk_bf16_f32 v25, v26, v27
v_mfma_f32_16x16x32_bf16 v[20:23], v[16:19], v[48:51], 0
s_nop 0
v_cvt_pk_bf16_f32 v26, v28, v29
v_cvt_pk_bf16_f32 v27, v30, v31
s_nop 1
v_mfma_f32_16x16x32_bf16 v[28:31], v[24:27], v[48:51], 0
s_waitcnt lgkmcnt(0)
s_nop 0
v_cvt_pk_bf16_f32 v16, v20, v21
v_cvt_pk_bf16_f32 v17, v22, v23
s_nop 3
v_cvt_pk_bf16_f32 v18, v28, v29
v_cvt_pk_bf16_f32 v19, v30, v31
s_nop 1
s_branch LdfA_pubA
LsafeA:
.p2alignl 6, 0xbf800000
s_nop 0
LstepA_34:
s_setprio 2
s_waitcnt lgkmcnt(0)
s_barrier
ds_read_b128 v[0:3], v56 offset:0
ds_read_b128 v[4:7], v56 offset:1024
ds_read_b128 v[8:11], v56 offset:2048
ds_read_b128 v[12:15], v56 offset:3072
s_waitcnt lgkmcnt(3)
v_smfmac_f32_16x16x64_bf16 v[16:19], v[0:3], v[64:71], v59
v_smfmac_f32_16x16x64_bf16 v[20:23], v[0:3], v[32:39], v59
ds_read_b128 v[32:35], v58 offset:16384
ds_read_b128 v[36:39], v58 offset:20480
v_smfmac_f32_16x16x64_bf16 v[24:27], v[0:3], v[72:79], v59
v_smfmac_f32_16x16x64_bf16 v[28:31], v[0:3], v[192:199], v59
s_waitcnt lgkmcnt(4)
v_smfmac_f32_16x16x64_bf16 v[16:19], v[4:7], v[80:87], v59
v_smfmac_f32_16x16x64_bf16 v[20:23], v[4:7], v[40:47], v59
ds_read_b128 v[40:43], v58 offset:24576
ds_read_b128 v[44:47], v58 offset:28672
v_smfmac_f32_16x16x64_bf16 v[24:27], v[4:7], v[88:95], v59
v_smfmac_f32_16x16x64_bf16 v[28:31], v[4:7], v[200:207], v59
s_waitcnt lgkmcnt(5)
v_smfmac_f32_16x16x64_bf16 v[16:19], v[8:11], v[96:103], v59
s_waitcnt lgkmcnt(2)
v_smfmac_f32_16x16x64_bf16 v[20:23], v[8:11], v[32:39], v59
ds_read_b128 v[32:35], v57 offset:32768
ds_read_b128 v[36:39], v57 offset:36864
v_smfmac_f32_16x16x64_bf16 v[24:27], v[8:11], v[104:111], v59
v_smfmac_f32_16x16x64_bf16 v[28:31], v[8:11], v[208:215], v59
v_smfmac_f32_16x16x64_bf16 v[16:19], v[12:15], v[112:119], v59
s_waitcnt lgkmcnt(2)
v_smfmac_f32_16x16x64_bf16 v[20:23], v[12:15], v[40:47], v59
ds_read_b128 v[40:43], v57 offset:40960
ds_read_b128 v[44:47], v57 offset:45056
s_barrier
ds_read_b128 v[0:3], v56 offset:4096
v_smfmac_f32_16x16x64_bf16 v[24:27], v[12:15], v[120:127], v59
ds_read_b128 v[4:7], v56 offset:5120
v_smfmac_f32_16x16x64_bf16 v[28:31], v[12:15], v[216:223], v59
ds_read_b128 v[8:11], v56 offset:6144
ds_read_b128 v[12:15], v56 offset:7168
s_waitcnt lgkmcnt(3)
v_smfmac_f32_16x16x64_bf16 v[16:19], v[0:3], v[128:135], v59
v_smfmac_f32_16x16x64_bf16 v[20:23], v[0:3], v[32:39], v59
ds_read_b128 v[32:35], v57 offset:49152
ds_read_b128 v[36:39], v57 offset:53248
v_smfmac_f32_16x16x64_bf16 v[24:27], v[0:3], v[136:143], v59
v_smfmac_f32_16x16x64_bf16 v[28:31], v[0:3], v[224:231], v59
s_waitcnt lgkmcnt(4)
v_smfmac_f32_16x16x64_bf16 v[16:19], v[4:7], v[144:151], v59
v_smfmac_f32_16x16x64_bf16 v[20:23], v[4:7], v[40:47], v59
ds_read_b128 v[40:43], v57 offset:57344
ds_read_b128 v[44:47], v57 offset:61440
v_smfmac_f32_16x16x64_bf16 v[24:27], v[4:7], v[152:159], v59
ds_read_b128 v[0:3], v57 offset:8192
v_smfmac_f32_16x16x64_bf16 v[28:31], v[4:7], v[232:239], v59
ds_read_b128 v[4:7], v57 offset:12288
s_waitcnt lgkmcnt(7)
v_smfmac_f32_16x16x64_bf16 v[16:19], v[8:11], v[160:167], v59
s_waitcnt lgkmcnt(4)
v_smfmac_f32_16x16x64_bf16 v[20:23], v[8:11], v[32:39], v59
v_smfmac_f32_16x16x64_bf16 v[16:19], v[12:15], v[176:183], v59
s_waitcnt lgkmcnt(2)
v_smfmac_f32_16x16x64_bf16 v[20:23], v[12:15], v[40:47], v59
v_smfmac_f32_16x16x64_bf16 v[24:27], v[8:11], v[168:175], v59
v_smfmac_f32_16x16x64_bf16 v[28:31], v[8:11], v[240:247], v59
v_cvt_pk_bf16_f32 v16, v16, v17
v_smfmac_f32_16x16x64_bf16 v[24:27], v[12:15], v[184:191], v59
v_cvt_pk_bf16_f32 v17, v18, v19
v_smfmac_f32_16x16x64_bf16 v[28:31], v[12:15], v[248:255], v59
s_barrier
v_cvt_pk_bf16_f32 v18, v20, v21
v_cvt_pk_bf16_f32 v19, v22, v23
v_cvt_pk_bf16_f32 v24, v24, v25
v_cvt_pk_bf16_f32 v25, v26, v27
v_mfma_f32_16x16x32_bf16 v[20:23], v[16:19], v[48:51], 0
s_nop 0
v_cvt_pk_bf16_f32 v26, v28, v29
v_cvt_pk_bf16_f32 v27, v30, v31
s_nop 1
v_mfma_f32_16x16x32_bf16 v[28:31], v[24:27], v[48:51], 0
s_waitcnt lgkmcnt(0)
s_nop 0
v_cvt_pk_bf16_f32 v16, v20, v21
v_cvt_pk_bf16_f32 v17, v22, v23
s_nop 3
v_cvt_pk_bf16_f32 v18, v28, v29
v_cvt_pk_bf16_f32 v19, v30, v31
s_nop 1
v_mfma_f32_16x16x32_bf16 v[24:27], v[4:7], v[16:19], 0
v_mfma_f32_16x16x32_bf16 v[20:23], v[0:3], v[16:19], 0
v_mfma_f32_16x16x32_bf16 v[28:31], v[16:19], v[16:19], 0
ds_read_b128 v[0:3], v57 offset:16384
ds_read_b64 v[6:7], v57 offset:20480
ds_read_b64 v[4:5], v57 offset:20488
s_nop 0
v_mov_b32_dpp v20, v24 row_ror:8 row_mask:0xf bank_mask:0xc
v_mov_b32_dpp v21, v25 row_ror:8 row_mask:0xf bank_mask:0xc
ds_write_b64 v57, v[20:21] offset:24576
v_mov_b32_dpp v22, v26 row_ror:8 row_mask:0xf bank_mask:0xc
v_mov_b32_dpp v23, v27 row_ror:8 row_mask:0xf bank_mask:0xc
ds_write_b64 v57, v[22:23] offset:24584
v_mov_b32_dpp v28, v30 row_ror:8 row_mask:0xf bank_mask:0xc
v_mov_b32_dpp v29, v31 row_ror:8 row_mask:0xf bank_mask:0xc
ds_write_b64 v52, v[28:29] offset:28672
v_pk_mul_f32 v[26:27], v[20:21], s[34:35]
s_waitcnt lgkmcnt(0)
v_pk_mul_f32 v[28:29], v[22:23], s[34:35]
s_barrier
ds_read_b128 v[32:35], v61 offset:24576
ds_read_b128 v[36:39], v62 offset:24576
ds_read_b128 v[40:43], v63 offset:24576
ds_read_b64 v[8:9], v53 offset:0
ds_read_b64 v[10:11], v53 offset:512
ds_read_b64 v[12:13], v53 offset:1024
ds_read_b64 v[14:15], v53 offset:1536
s_nop 0
s_waitcnt lgkmcnt(6)
v_pk_fma_f32 v[26:27], v[32:33], s[34:35], v[26:27]
v_pk_fma_f32 v[28:29], v[34:35], s[34:35], v[28:29]
s_waitcnt lgkmcnt(5)
v_pk_fma_f32 v[26:27], v[36:37], s[34:35], v[26:27]
v_pk_fma_f32 v[28:29], v[38:39], s[34:35], v[28:29]
s_waitcnt lgkmcnt(4)
v_pk_fma_f32 v[26:27], v[40:41], s[34:35], v[26:27]
v_pk_fma_f32 v[28:29], v[42:43], s[34:35], v[28:29]
v_exp_f32 v20, v26
v_exp_f32 v21, v27
s_waitcnt lgkmcnt(2)
v_pk_add_f32 v[8:9], v[8:9], v[10:11]
v_exp_f32 v22, v28
s_waitcnt lgkmcnt(0)
v_pk_add_f32 v[12:13], v[12:13], v[14:15]
v_exp_f32 v23, v29
v_pk_mul_f32 v[30:31], v[8:9], s[34:35]
v_cvt_pk_bf16_f32 v36, v20, v21
v_pk_fma_f32 v[30:31], v[12:13], s[34:35], v[30:31]
v_cvt_pk_bf16_f32 v37, v22, v23
v_mov_b32_dpp v38, v36 row_ror:8 row_mask:0xf bank_mask:0xf
v_exp_f32 v24, v30
v_mov_b32_dpp v39, v37 row_ror:8 row_mask:0xf bank_mask:0xf
v_exp_f32 v25, v31
s_barrier
ds_read_b128 v[44:47], v57 offset:8192
v_max3_f32 v60, abs(v26), abs(v27), abs(v28)
v_mfma_f32_16x16x32_bf16 v[8:11], v[0:3], v[36:39], 0
v_cvt_pk_bf16_f32 v40, v24, v25
v_max3_f32 v60, v60, abs(v29), abs(v30)
v_mfma_f32_16x16x32_bf16 v[12:15], v[4:7], v[36:39], 0
v_max_f32 v60, v60, abs(v31)
v_mov_b32_dpp v41, v40 row_ror:8 row_mask:0xf bank_mask:0xf
v_cmp_nle_f32 vcc, v60, s10
v_pk_add_f32 v[32:33], v[20:21], v[22:23]
v_add_f32 v34, v24, v25
v_add_f32 v32, v32, v33
s_waitcnt lgkmcnt(0)
s_cbranch_vccnz Lslow_37
Lback_38:
v_fmac_f32 v32, 0.5, v34
v_mfma_f32_16x16x16_bf16 v[8:11], v[44:45], v[40:41], v[8:11]
s_nop 0
v_add_f32_dpp v33, v32, v32 row_ror:8 row_mask:0xf bank_mask:0xf
v_add_f32_dpp v32, v32, v32 row_ror:8 row_mask:0xf bank_mask:0xf
v_mfma_f32_16x16x16_bf16 v[12:15], v[46:47], v[40:41], v[12:15]
s_mov_b64 vcc, s[36:37]
v_permlane16_swap_b32 v32, v33
v_add_f32 v34, v32, v33
v_add_f32 v32, v32, v33
s_nop 1
v_permlane32_swap_b32 v32, v34
v_add_f32 v32, v32, v34
v_rcp_f32 v32, v32
v_cndmask_b32 v8, v12, v8, vcc
v_cndmask_b32 v9, v13, v9, vcc
v_cndmask_b32 v10, v14, v10, vcc
v_cndmask_b32 v11, v15, v11, vcc
v_pk_mul_f32 v[8:9], v[8:9], v[32:33] op_sel_hi:[1,0]
v_pk_mul_f32 v[10:11], v[10:11], v[32:33] op_sel_hi:[1,0]
v_cvt_pk_bf16_f32 v8, v8, v9
v_cvt_pk_bf16_f32 v9, v10, v11
ds_write_b64 v54, v[8:9] offset:16384
s_add_u32 s14, s14, 1
s_mov_b32 s23, s29
s_add_u32 s29, s29, 131072
s_waitcnt lgkmcnt(0)
s_barrier
s_setprio 1
s_nop 15
ds_write_b128 v57, v[16:19] offset:12288
ds_read_b128 v[24:27], v56 offset:30720
s_cmp_eq_u32 s13, 0
s_cbranch_scc0 Lw1_41
s_cmp_eq_u32 s25, 0
s_cbranch_scc0 Le1_48
s_waitcnt lgkmcnt(0)
s_barrier
s_nop 15
s_nop 11
buffer_load_dwordx4 v[0:3], v56, s[4:7], s22 offen offset:0 sc1
buffer_load_dwordx4 v[4:7], v56, s[4:7], s22 offen offset:1024 sc1
buffer_load_dwordx4 v[8:11], v56, s[4:7], s22 offen offset:2048 sc1
buffer_load_dwordx4 v[12:15], v56, s[4:7], s22 offen offset:3072 sc1
s_nop 15
s_nop 15
buffer_load_dwordx4 v[32:35], v56, s[4:7], s22 offen offset:0 sc1
buffer_load_dwordx4 v[36:39], v56, s[4:7], s22 offen offset:1024 sc1
buffer_load_dwordx4 v[40:43], v56, s[4:7], s22 offen offset:2048 sc1
buffer_load_dwordx4 v[44:47], v56, s[4:7], s22 offen offset:3072 sc1
s_waitcnt vmcnt(7)
v_mfma_f32_16x16x32_bf16 v[20:23], v[0:3], v[24:27], 0
v_or_b32 v60, v0, v2
s_waitcnt vmcnt(6)
v_mfma_f32_16x16x32_bf16 v[20:23], v[4:7], v[24:27], v[20:23]
v_or3_b32 v60, v60, v4, v6
s_waitcnt vmcnt(5)
v_mfma_f32_16x16x32_bf16 v[20:23], v[8:11], v[24:27], v[20:23]
v_or3_b32 v60, v60, v8, v10
s_waitcnt vmcnt(4)
v_mfma_f32_16x16x32_bf16 v[20:23], v[12:15], v[24:27], v[20:23]
v_or3_b32 v60, v60, v12, v14
v_and_b32 v60, 1, v60
v_cmp_ne_u32 vcc, 0, v60
s_nop 4
v_permlane32_swap_b32 v20, v22
v_permlane32_swap_b32 v21, v23
v_pk_add_f32 v[20:21], v[20:21], v[22:23]
v_cvt_pk_bf16_f32 v20, v20, v21
v_min_u32 v20, -2, v20
s_cbranch_vccnz Lty_51
buffer_store_dword v20, v55, s[4:7], s24 offen sc1
s_barrier
s_branch Ltail_49
Lty_51:
s_waitcnt vmcnt(3)
v_mfma_f32_16x16x32_bf16 v[20:23], v[32:35], v[24:27], 0
v_or_b32 v60, v32, v34
s_waitcnt vmcnt(2)
v_mfma_f32_16x16x32_bf16 v[20:23], v[36:39], v[24:27], v[20:23]
v_or3_b32 v60, v60, v36, v38
s_waitcnt vmcnt(1)
v_mfma_f32_16x16x32_bf16 v[20:23], v[40:43], v[24:27], v[20:23]
v_or3_b32 v60, v60, v40, v42
s_waitcnt vmcnt(0)
v_mfma_f32_16x16x32_bf16 v[20:23], v[44:47], v[24:27], v[20:23]
v_or3_b32 v60, v60, v44, v46
v_and_b32 v60, 1, v60
v_cmp_ne_u32 vcc, 0, v60
s_nop 4
v_permlane32_swap_b32 v20, v22
v_permlane32_swap_b32 v21, v23
v_pk_add_f32 v[20:21], v[20:21], v[22:23]
v_cvt_pk_bf16_f32 v20, v20, v21
v_min_u32 v20, -2, v20
s_cbranch_vccnz Lf0_46
buffer_store_dword v20, v55, s[4:7], s24 offen sc1
s_barrier
s_branch Ltail_49
Le1_48:
s_waitcnt lgkmcnt(0)
s_barrier
s_nop 15
s_nop 11
buffer_load_dwordx4 v[0:3], v56, s[4:7], s22 offen offset:0 sc1
buffer_load_dwordx4 v[4:7], v56, s[4:7], s22 offen offset:1024 sc1
buffer_load_dwordx4 v[8:11], v56, s[4:7], s22 offen offset:2048 sc1
buffer_load_dwordx4 v[12:15], v56, s[4:7], s22 offen offset:3072 sc1
s_nop 15
s_nop 15
buffer_load_dwordx4 v[32:35], v56, s[4:7], s22 offen offset:0 sc1
buffer_load_dwordx4 v[36:39], v56, s[4:7], s22 offen offset:1024 sc1
buffer_load_dwordx4 v[40:43], v56, s[4:7], s22 offen offset:2048 sc1
buffer_load_dwordx4 v[44:47], v56, s[4:7], s22 offen offset:3072 sc1
s_waitcnt vmcnt(7)
v_mfma_f32_16x16x32_bf16 v[20:23], v[0:3], v[24:27], 0
v_and_b32 v60, v0, v2
s_waitcnt vmcnt(6)
v_mfma_f32_16x16x32_bf16 v[20:23], v[4:7], v[24:27], v[20:23]
v_bitop3_b32 v60, v60, v4, v6 bitop3:0x80
s_waitcnt vmcnt(5)
v_mfma_f32_16x16x32_bf16 v[20:23], v[8:11], v[24:27], v[20:23]
v_bitop3_b32 v60, v60, v8, v10 bitop3:0x80
s_waitcnt vmcnt(4)
v_mfma_f32_16x16x32_bf16 v[20:23], v[12:15], v[24:27], v[20:23]
v_bitop3_b32 v60, v60, v12, v14 bitop3:0x80
v_and_b32 v60, 1, v60
v_cmp_ne_u32 vcc, 1, v60
s_nop 4
v_permlane32_swap_b32 v20, v22
v_permlane32_swap_b32 v21, v23
v_pk_add_f32 v[20:21], v[20:21], v[22:23]
v_cvt_pk_bf16_f32 v20, v20, v21
v_min_u32 v20, -2, v20
s_cbranch_vccnz Lty_52
buffer_store_dword v20, v55, s[4:7], s24 offen sc1
s_barrier
s_branch Ltail_49
Lty_52:
s_waitcnt vmcnt(3)
v_mfma_f32_16x16x32_bf16 v[20:23], v[32:35], v[24:27], 0
v_and_b32 v60, v32, v34
s_waitcnt vmcnt(2)
v_mfma_f32_16x16x32_bf16 v[20:23], v[36:39], v[24:27], v[20:23]
v_bitop3_b32 v60, v60, v36, v38 bitop3:0x80
s_waitcnt vmcnt(1)
v_mfma_f32_16x16x32_bf16 v[20:23], v[40:43], v[24:27], v[20:23]
v_bitop3_b32 v60, v60, v40, v42 bitop3:0x80
s_waitcnt vmcnt(0)
v_mfma_f32_16x16x32_bf16 v[20:23], v[44:47], v[24:27], v[20:23]
v_bitop3_b32 v60, v60, v44, v46 bitop3:0x80
v_and_b32 v60, 1, v60
v_cmp_ne_u32 vcc, 1, v60
s_nop 4
v_permlane32_swap_b32 v20, v22
v_permlane32_swap_b32 v21, v23
v_pk_add_f32 v[20:21], v[20:21], v[22:23]
v_cvt_pk_bf16_f32 v20, v20, v21
v_min_u32 v20, -2, v20
s_cbranch_vccnz Lf0_47
buffer_store_dword v20, v55, s[4:7], s24 offen sc1
s_barrier
Ltail_49:
v_mov_b32 v60, -1
buffer_store_dword v60, v55, s[4:7], s26 offen sc1
s_waitcnt vmcnt(2)
LjoinA_40:
ds_read_b128 v[32:35], v58 offset:0
ds_read_b128 v[36:39], v58 offset:4096
ds_read_b128 v[40:43], v58 offset:8192
ds_read_b128 v[44:47], v58 offset:12288
v_mov_b64 v[16:17], 0
v_mov_b64 v[18:19], 0
v_mov_b64 v[20:21], 0
v_mov_b64 v[22:23], 0
v_mov_b64 v[24:25], 0
v_mov_b64 v[26:27], 0
v_mov_b64 v[28:29], 0
v_mov_b64 v[30:31], 0
Ljoin2_53:
s_mov_b32 s26, s24
s_xor_b32 s25, s25, 1
s_add_u32 s40, s24, 8192
s_and_b32 s40, s40, 0x6000
s_andn2_b32 s24, s24, 0x6000
s_or_b32 s24, s24, s40
s_cmp_eq_u32 s14, s46
s_cbranch_scc1 LdsA_lastA
s_branch LstepA_34
Lw1_41:
s_waitcnt lgkmcnt(0)
s_barrier
s_cmp_eq_u32 s13, 1
s_cbranch_scc0 Lnored_39
s_cmp_eq_u32 s25, 0
s_cbranch_scc0 Lw1e_54
s_nop 15
s_nop 15
s_nop 15
s_nop 15
s_nop 3
buffer_load_dwordx4 v[0:3], v56, s[4:7], s22 offen offset:0 sc1
buffer_load_dwordx4 v[4:7], v56, s[4:7], s22 offen offset:1024 sc1
buffer_load_dwordx4 v[8:11], v56, s[4:7], s22 offen offset:2048 sc1
buffer_load_dwordx4 v[12:15], v56, s[4:7], s22 offen offset:3072 sc1
ds_read_b128 v[32:35], v58 offset:0
ds_read_b128 v[36:39], v58 offset:4096
ds_read_b128 v[40:43], v58 offset:8192
ds_read_b128 v[44:47], v58 offset:12288
v_mov_b64 v[16:17], 0
v_mov_b64 v[18:19], 0
v_mov_b64 v[28:29], 0
v_mov_b64 v[30:31], 0
s_barrier
s_waitcnt vmcnt(3)
v_mfma_f32_16x16x32_bf16 v[20:23], v[0:3], v[24:27], 0
v_or_b32 v60, v0, v2
s_waitcnt vmcnt(2)
v_mfma_f32_16x16x32_bf16 v[20:23], v[4:7], v[24:27], v[20:23]
v_or3_b32 v60, v60, v4, v6
s_waitcnt vmcnt(1)
v_mfma_f32_16x16x32_bf16 v[20:23], v[8:11], v[24:27], v[20:23]
v_or3_b32 v60, v60, v8, v10
s_waitcnt vmcnt(0)
v_mfma_f32_16x16x32_bf16 v[20:23], v[12:15], v[24:27], v[20:23]
v_or3_b32 v60, v60, v12, v14
v_and_b32 v60, 1, v60
v_cmp_ne_u32 vcc, 0, v60
s_nop 4
v_permlane32_swap_b32 v20, v22
v_permlane32_swap_b32 v21, v23
v_pk_add_f32 v[20:21], v[20:21], v[22:23]
v_cvt_pk_bf16_f32 v20, v20, v21
v_min_u32 v20, -2, v20
s_cbranch_vccnz Lf1_55
buffer_store_dword v20, v55, s[4:7], s24 offen sc1
v_mov_b32 v60, -1
buffer_store_dword v60, v55, s[4:7], s26 offen sc1
v_mov_b64 v[20:21], 0
v_mov_b64 v[22:23], 0
v_mov_b64 v[24:25], 0
v_mov_b64 v[26:27], 0
s_branch Ljoin2_53
Lf1_55:
s_waitcnt lgkmcnt(0)
buffer_load_dwordx4 v[0:3], v56, s[4:7], s22 offen offset:0 sc1
buffer_load_dwordx4 v[4:7], v56, s[4:7], s22 offen offset:1024 sc1
buffer_load_dwordx4 v[8:11], v56, s[4:7], s22 offen offset:2048 sc1
buffer_load_dwordx4 v[12:15], v56, s[4:7], s22 offen offset:3072 sc1
s_nop 15
s_nop 7
buffer_load_dwordx4 v[32:35], v56, s[4:7], s22 offen offset:0 sc1
buffer_load_dwordx4 v[36:39], v56, s[4:7], s22 offen offset:1024 sc1
buffer_load_dwordx4 v[40:43], v56, s[4:7], s22 offen offset:2048 sc1
buffer_load_dwordx4 v[44:47], v56, s[4:7], s22 offen offset:3072 sc1
s_branch LlX_42
Lw1e_54:
s_nop 15
s_nop 15
s_nop 15
s_nop 15
s_nop 3
buffer_load_dwordx4 v[0:3], v56, s[4:7], s22 offen offset:0 sc1
buffer_load_dwordx4 v[4:7], v56, s[4:7], s22 offen offset:1024 sc1
buffer_load_dwordx4 v[8:11], v56, s[4:7], s22 offen offset:2048 sc1
buffer_load_dwordx4 v[12:15], v56, s[4:7], s22 offen offset:3072 sc1
ds_read_b128 v[32:35], v58 offset:0
ds_read_b128 v[36:39], v58 offset:4096
ds_read_b128 v[40:43], v58 offset:8192
ds_read_b128 v[44:47], v58 offset:12288
v_mov_b64 v[16:17], 0
v_mov_b64 v[18:19], 0
v_mov_b64 v[28:29], 0
v_mov_b64 v[30:31], 0
s_barrier
s_waitcnt vmcnt(3)
v_mfma_f32_16x16x32_bf16 v[20:23], v[0:3], v[24:27], 0
v_and_b32 v60, v0, v2
s_waitcnt vmcnt(2)
v_mfma_f32_16x16x32_bf16 v[20:23], v[4:7], v[24:27], v[20:23]
v_bitop3_b32 v60, v60, v4, v6 bitop3:0x80
s_waitcnt vmcnt(1)
v_mfma_f32_16x16x32_bf16 v[20:23], v[8:11], v[24:27], v[20:23]
v_bitop3_b32 v60, v60, v8, v10 bitop3:0x80
s_waitcnt vmcnt(0)
v_mfma_f32_16x16x32_bf16 v[20:23], v[12:15], v[24:27], v[20:23]
v_bitop3_b32 v60, v60, v12, v14 bitop3:0x80
v_and_b32 v60, 1, v60
v_cmp_ne_u32 vcc, 1, v60
s_nop 4
v_permlane32_swap_b32 v20, v22
v_permlane32_swap_b32 v21, v23
v_pk_add_f32 v[20:21], v[20:21], v[22:23]
v_cvt_pk_bf16_f32 v20, v20, v21
v_min_u32 v20, -2, v20
s_cbranch_vccnz Lf1_56
buffer_store_dword v20, v55, s[4:7], s24 offen sc1
v_mov_b32 v60, -1
buffer_store_dword v60, v55, s[4:7], s26 offen sc1
v_mov_b64 v[20:21], 0
v_mov_b64 v[22:23], 0
v_mov_b64 v[24:25], 0
v_mov_b64 v[26:27], 0
s_branch Ljoin2_53
Lf1_56:
s_waitcnt lgkmcnt(0)
buffer_load_dwordx4 v[0:3], v56, s[4:7], s22 offen offset:0 sc1
buffer_load_dwordx4 v[4:7], v56, s[4:7], s22 offen offset:1024 sc1
buffer_load_dwordx4 v[8:11], v56, s[4:7], s22 offen offset:2048 sc1
buffer_load_dwordx4 v[12:15], v56, s[4:7], s22 offen offset:3072 sc1
s_nop 15
s_nop 7
buffer_load_dwordx4 v[32:35], v56, s[4:7], s22 offen offset:0 sc1
buffer_load_dwordx4 v[36:39], v56, s[4:7], s22 offen offset:1024 sc1
buffer_load_dwordx4 v[40:43], v56, s[4:7], s22 offen offset:2048 sc1
buffer_load_dwordx4 v[44:47], v56, s[4:7], s22 offen offset:3072 sc1
s_branch LlX_43
LlX_42:
s_waitcnt vmcnt(7)
v_mfma_f32_16x16x32_bf16 v[20:23], v[0:3], v[24:27], 0
v_or_b32 v60, v0, v2
s_waitcnt vmcnt(6)
v_mfma_f32_16x16x32_bf16 v[20:23], v[4:7], v[24:27], v[20:23]
v_or3_b32 v60, v60, v4, v6
s_waitcnt vmcnt(5)
v_mfma_f32_16x16x32_bf16 v[20:23], v[8:11], v[24:27], v[20:23]
v_or3_b32 v60, v60, v8, v10
s_waitcnt vmcnt(4)
v_mfma_f32_16x16x32_bf16 v[20:23], v[12:15], v[24:27], v[20:23]
v_or3_b32 v60, v60, v12, v14
v_and_b32 v60, 1, v60
v_cmp_ne_u32 vcc, 0, v60
s_nop 4
v_permlane32_swap_b32 v20, v22
v_permlane32_swap_b32 v21, v23
v_pk_add_f32 v[20:21], v[20:21], v[22:23]
v_cvt_pk_bf16_f32 v20, v20, v21
v_min_u32 v20, -2, v20
s_cbranch_vccz Lfin2_50
buffer_load_dwordx4 v[0:3], v56, s[4:7], s22 offen offset:0 sc1
buffer_load_dwordx4 v[4:7], v56, s[4:7], s22 offen offset:1024 sc1
buffer_load_dwordx4 v[8:11], v56, s[4:7], s22 offen offset:2048 sc1
buffer_load_dwordx4 v[12:15], v56, s[4:7], s22 offen offset:3072 sc1
s_add_u32 s33, s33, 1
s_cmp_gt_u32 s33, 524288
s_cbranch_scc1 Lexit
LlY_44:
s_waitcnt vmcnt(7)
v_mfma_f32_16x16x32_bf16 v[20:23], v[32:35], v[24:27], 0
v_or_b32 v60, v32, v34
s_waitcnt vmcnt(6)
v_mfma_f32_16x16x32_bf16 v[20:23], v[36:39], v[24:27], v[20:23]
v_or3_b32 v60, v60, v36, v38
s_waitcnt vmcnt(5)
v_mfma_f32_16x16x32_bf16 v[20:23], v[40:43], v[24:27], v[20:23]
v_or3_b32 v60, v60, v40, v42
s_waitcnt vmcnt(4)
v_mfma_f32_16x16x32_bf16 v[20:23], v[44:47], v[24:27], v[20:23]
v_or3_b32 v60, v60, v44, v46
v_and_b32 v60, 1, v60
v_cmp_ne_u32 vcc, 0, v60
s_nop 4
v_permlane32_swap_b32 v20, v22
v_permlane32_swap_b32 v21, v23
v_pk_add_f32 v[20:21], v[20:21], v[22:23]
v_cvt_pk_bf16_f32 v20, v20, v21
v_min_u32 v20, -2, v20
s_cbranch_vccz Lfin2_50
buffer_load_dwordx4 v[32:35], v56, s[4:7], s22 offen offset:0 sc1
buffer_load_dwordx4 v[36:39], v56, s[4:7], s22 offen offset:1024 sc1
buffer_load_dwordx4 v[40:43], v56, s[4:7], s22 offen offset:2048 sc1
buffer_load_dwordx4 v[44:47], v56, s[4:7], s22 offen offset:3072 sc1
s_add_u32 s33, s33, 1
s_cmp_gt_u32 s33, 524288
s_cbranch_scc1 Lexit
s_branch LlX_42
Lf0_46:
buffer_load_dwordx4 v[32:35], v56, s[4:7], s22 offen offset:0 sc1
buffer_load_dwordx4 v[36:39], v56, s[4:7], s22 offen offset:1024 sc1
buffer_load_dwordx4 v[40:43], v56, s[4:7], s22 offen offset:2048 sc1
buffer_load_dwordx4 v[44:47], v56, s[4:7], s22 offen offset:3072 sc1
s_nop 15
s_nop 7
buffer_load_dwordx4 v[0:3], v56, s[4:7], s22 offen offset:0 sc1
buffer_load_dwordx4 v[4:7], v56, s[4:7], s22 offen offset:1024 sc1
buffer_load_dwordx4 v[8:11], v56, s[4:7], s22 offen offset:2048 sc1
buffer_load_dwordx4 v[12:15], v56, s[4:7], s22 offen offset:3072 sc1
s_barrier
s_branch LlY_44
LlX_43:
s_waitcnt vmcnt(7)
v_mfma_f32_16x16x32_bf16 v[20:23], v[0:3], v[24:27], 0
v_and_b32 v60, v0, v2
s_waitcnt vmcnt(6)
v_mfma_f32_16x16x32_bf16 v[20:23], v[4:7], v[24:27], v[20:23]
v_bitop3_b32 v60, v60, v4, v6 bitop3:0x80
s_waitcnt vmcnt(5)
v_mfma_f32_16x16x32_bf16 v[20:23], v[8:11], v[24:27], v[20:23]
v_bitop3_b32 v60, v60, v8, v10 bitop3:0x80
s_waitcnt vmcnt(4)
v_mfma_f32_16x16x32_bf16 v[20:23], v[12:15], v[24:27], v[20:23]
v_bitop3_b32 v60, v60, v12, v14 bitop3:0x80
v_and_b32 v60, 1, v60
v_cmp_ne_u32 vcc, 1, v60
s_nop 4
v_permlane32_swap_b32 v20, v22
v_permlane32_swap_b32 v21, v23
v_pk_add_f32 v[20:21], v[20:21], v[22:23]
v_cvt_pk_bf16_f32 v20, v20, v21
v_min_u32 v20, -2, v20
s_cbranch_vccz Lfin2_50
buffer_load_dwordx4 v[0:3], v56, s[4:7], s22 offen offset:0 sc1
buffer_load_dwordx4 v[4:7], v56, s[4:7], s22 offen offset:1024 sc1
buffer_load_dwordx4 v[8:11], v56, s[4:7], s22 offen offset:2048 sc1
buffer_load_dwordx4 v[12:15], v56, s[4:7], s22 offen offset:3072 sc1
s_add_u32 s33, s33, 1
s_cmp_gt_u32 s33, 524288
s_cbranch_scc1 Lexit
LlY_45:
s_waitcnt vmcnt(7)
v_mfma_f32_16x16x32_bf16 v[20:23], v[32:35], v[24:27], 0
v_and_b32 v60, v32, v34
s_waitcnt vmcnt(6)
v_mfma_f32_16x16x32_bf16 v[20:23], v[36:39], v[24:27], v[20:23]
v_bitop3_b32 v60, v60, v36, v38 bitop3:0x80
s_waitcnt vmcnt(5)
v_mfma_f32_16x16x32_bf16 v[20:23], v[40:43], v[24:27], v[20:23]
v_bitop3_b32 v60, v60, v40, v42 bitop3:0x80
s_waitcnt vmcnt(4)
v_mfma_f32_16x16x32_bf16 v[20:23], v[44:47], v[24:27], v[20:23]
v_bitop3_b32 v60, v60, v44, v46 bitop3:0x80
v_and_b32 v60, 1, v60
v_cmp_ne_u32 vcc, 1, v60
s_nop 4
v_permlane32_swap_b32 v20, v22
v_permlane32_swap_b32 v21, v23
v_pk_add_f32 v[20:21], v[20:21], v[22:23]
v_cvt_pk_bf16_f32 v20, v20, v21
v_min_u32 v20, -2, v20
s_cbranch_vccz Lfin2_50
buffer_load_dwordx4 v[32:35], v56, s[4:7], s22 offen offset:0 sc1
buffer_load_dwordx4 v[36:39], v56, s[4:7], s22 offen offset:1024 sc1
buffer_load_dwordx4 v[40:43], v56, s[4:7], s22 offen offset:2048 sc1
buffer_load_dwordx4 v[44:47], v56, s[4:7], s22 offen offset:3072 sc1
s_add_u32 s33, s33, 1
s_cmp_gt_u32 s33, 524288
s_cbranch_scc1 Lexit
s_branch LlX_43
Lf0_47:
buffer_load_dwordx4 v[32:35], v56, s[4:7], s22 offen offset:0 sc1
buffer_load_dwordx4 v[36:39], v56, s[4:7], s22 offen offset:1024 sc1
buffer_load_dwordx4 v[40:43], v56, s[4:7], s22 offen offset:2048 sc1
buffer_load_dwordx4 v[44:47], v56, s[4:7], s22 offen offset:3072 sc1
s_nop 15
s_nop 7
buffer_load_dwordx4 v[0:3], v56, s[4:7], s22 offen offset:0 sc1
buffer_load_dwordx4 v[4:7], v56, s[4:7], s22 offen offset:1024 sc1
buffer_load_dwordx4 v[8:11], v56, s[4:7], s22 offen offset:2048 sc1
buffer_load_dwordx4 v[12:15], v56, s[4:7], s22 offen offset:3072 sc1
s_barrier
s_branch LlY_45
Lfin2_50:
buffer_store_dword v20, v55, s[4:7], s24 offen sc1
s_branch Ltail_49
Lnored_39:
s_waitcnt vmcnt(0)
s_barrier
s_branch LjoinA_40
Lslow_37:
v_max3_f32 v60, v26, v27, v28
v_max3_f32 v60, v60, v29, v30
v_max_f32 v60, v60, v31
s_nop 1
v_max_f32_dpp v32, v60, v60 row_ror:8 row_mask:0xf bank_mask:0xf
v_max_f32_dpp v60, v60, v60 row_ror:8 row_mask:0xf bank_mask:0xf
s_nop 1
v_permlane16_swap_b32 v60, v32
v_max_f32 v33, v60, v32
v_max_f32 v60, v60, v32
s_nop 1
v_permlane32_swap_b32 v60, v33
v_max_f32 v60, v60, v33
v_sub_f32 v26, v26, v60
v_sub_f32 v27, v27, v60
v_sub_f32 v28, v28, v60
v_sub_f32 v29, v29, v60
v_sub_f32 v30, v30, v60
v_sub_f32 v31, v31, v60
v_exp_f32 v20, v26
v_exp_f32 v21, v27
v_exp_f32 v22, v28
v_exp_f32 v23, v29
v_exp_f32 v24, v30
v_exp_f32 v25, v31
v_cvt_pk_bf16_f32 v36, v20, v21
v_cvt_pk_bf16_f32 v37, v22, v23
s_nop 0
v_mov_b32_dpp v38, v36 row_ror:8 row_mask:0xf bank_mask:0xf
v_mov_b32_dpp v39, v37 row_ror:8 row_mask:0xf bank_mask:0xf
s_nop 1
v_mfma_f32_16x16x32_bf16 v[8:11], v[0:3], v[36:39], 0
v_cvt_pk_bf16_f32 v40, v24, v25
v_mfma_f32_16x16x32_bf16 v[12:15], v[4:7], v[36:39], 0
s_nop 0
v_mov_b32_dpp v41, v40 row_ror:8 row_mask:0xf bank_mask:0xf
v_pk_add_f32 v[32:33], v[20:21], v[22:23]
v_add_f32 v34, v24, v25
v_add_f32 v32, v32, v33
s_nop 2
s_branch Lback_38
LdsA_pubA:
v_min_u32 v16, -2, v16
v_min_u32 v17, -2, v17
v_min_u32 v18, -2, v18
v_min_u32 v19, -2, v19
s_mov_b64 exec, s[38:39]
buffer_store_dwordx4 v[16:19], v56, s[4:7], s29 offen sc1
s_mov_b64 exec, -1
s_branch LdsA
LdsA_lastA:
s_setprio 2
s_waitcnt lgkmcnt(0)
s_barrier
ds_read_b128 v[0:3], v56 offset:0
ds_read_b128 v[4:7], v56 offset:1024
ds_read_b128 v[8:11], v56 offset:2048
ds_read_b128 v[12:15], v56 offset:3072
s_waitcnt lgkmcnt(3)
v_smfmac_f32_16x16x64_bf16 v[20:23], v[0:3], v[32:39], v59
ds_read_b128 v[32:35], v58 offset:16384
ds_read_b128 v[36:39], v58 offset:20480
v_smfmac_f32_16x16x64_bf16 v[28:31], v[0:3], v[192:199], v59
s_waitcnt lgkmcnt(4)
v_smfmac_f32_16x16x64_bf16 v[20:23], v[4:7], v[40:47], v59
ds_read_b128 v[40:43], v58 offset:24576
ds_read_b128 v[44:47], v58 offset:28672
v_smfmac_f32_16x16x64_bf16 v[28:31], v[4:7], v[200:207], v59
s_waitcnt lgkmcnt(5)
s_waitcnt lgkmcnt(2)
v_smfmac_f32_16x16x64_bf16 v[20:23], v[8:11], v[32:39], v59
ds_read_b128 v[32:35], v57 offset:32768
ds_read_b128 v[36:39], v57 offset:36864
v_smfmac_f32_16x16x64_bf16 v[28:31], v[8:11], v[208:215], v59
s_waitcnt lgkmcnt(2)
v_smfmac_f32_16x16x64_bf16 v[20:23], v[12:15], v[40:47], v59
ds_read_b128 v[40:43], v57 offset:40960
ds_read_b128 v[44:47], v57 offset:45056
s_barrier
ds_read_b128 v[0:3], v56 offset:4096
ds_read_b128 v[4:7], v56 offset:5120
v_smfmac_f32_16x16x64_bf16 v[28:31], v[12:15], v[216:223], v59
ds_read_b128 v[8:11], v56 offset:6144
ds_read_b128 v[12:15], v56 offset:7168
s_waitcnt lgkmcnt(3)
v_smfmac_f32_16x16x64_bf16 v[20:23], v[0:3], v[32:39], v59
ds_read_b128 v[32:35], v57 offset:49152
ds_read_b128 v[36:39], v57 offset:53248
v_smfmac_f32_16x16x64_bf16 v[28:31], v[0:3], v[224:231], v59
s_waitcnt lgkmcnt(4)
v_smfmac_f32_16x16x64_bf16 v[20:23], v[4:7], v[40:47], v59
ds_read_b128 v[40:43], v57 offset:57344
ds_read_b128 v[44:47], v57 offset:61440
ds_read_b128 v[0:3], v57 offset:8192
v_smfmac_f32_16x16x64_bf16 v[28:31], v[4:7], v[232:239], v59
ds_read_b128 v[4:7], v57 offset:12288
s_waitcnt lgkmcnt(7)
s_waitcnt lgkmcnt(4)
v_smfmac_f32_16x16x64_bf16 v[20:23], v[8:11], v[32:39], v59
s_waitcnt lgkmcnt(2)
v_smfmac_f32_16x16x64_bf16 v[20:23], v[12:15], v[40:47], v59
v_smfmac_f32_16x16x64_bf16 v[28:31], v[8:11], v[240:247], v59
v_cvt_pk_bf16_f32 v16, v16, v17
v_cvt_pk_bf16_f32 v17, v18, v19
v_smfmac_f32_16x16x64_bf16 v[28:31], v[12:15], v[248:255], v59
v_cvt_pk_bf16_f32 v18, v20, v21
v_cvt_pk_bf16_f32 v19, v22, v23
v_cvt_pk_bf16_f32 v24, v24, v25
v_cvt_pk_bf16_f32 v25, v26, v27
v_mfma_f32_16x16x32_bf16 v[20:23], v[16:19], v[48:51], 0
s_nop 0
v_cvt_pk_bf16_f32 v26, v28, v29
v_cvt_pk_bf16_f32 v27, v30, v31
s_nop 1
v_mfma_f32_16x16x32_bf16 v[28:31], v[24:27], v[48:51], 0
s_waitcnt lgkmcnt(0)
s_nop 0
v_cvt_pk_bf16_f32 v16, v20, v21
v_cvt_pk_bf16_f32 v17, v22, v23
s_nop 3
v_cvt_pk_bf16_f32 v18, v28, v29
v_cvt_pk_bf16_f32 v19, v30, v31
s_nop 1
s_branch LdsA_pubA
LdfA:
LdsA:
s_waitcnt vmcnt(0)
s_barrier
s_endpgm
LroleB:
v_lshrrev_b32 v1, 4, v56
v_lshrrev_b32 v2, 4, v1
v_and_b32 v3, 15, v1
v_and_b32 v4, 1, v2
v_lshlrev_b32 v4, 2, v4
v_xor_b32 v3, v3, v4
v_lshlrev_b32 v3, 4, v3
v_xor_b32 v4, 128, v3
v_lshl_add_u32 v48, v2, 13, v3
v_lshl_add_u32 v49, v2, 13, v4
v_lshl_add_u32 v50, v2, 10, v3
v_lshl_add_u32 v51, v2, 10, v4
v_bfe_u32 v2, v1, 2, 1
v_bfe_u32 v3, v1, 3, 1
v_bfe_u32 v4, v1, 4, 1
v_bfe_u32 v5, v1, 5, 1
v_and_b32 v6, 3, v1
v_lshl_add_u32 v7, v4, 1, v2
v_xor_b32 v7, s13, v7
v_lshlrev_b32 v7, 6, v7
v_lshl_add_u32 v8, v4, 2, v2
v_lshl_add_u32 v9, v3, 3, v8
v_lshl_add_u32 v9, v5, 4, v9
v_lshl_add_u32 v52, v9, 8, v7
v_lshrrev_b32 v10, 1, v6
v_lshl_add_u32 v52, v10, 5, v52
v_and_b32 v10, 1, v6
v_lshl_add_u32 v52, v10, 3, v52
v_lshl_add_u32 v9, v5, 2, v2
v_lshl_add_u32 v9, v4, 3, v9
v_lshl_add_u32 v7, v5, 1, v2
v_xor_b32 v7, s13, v7
v_lshlrev_b32 v7, 6, v7
v_lshl_add_u32 v53, v9, 8, v7
v_lshl_add_u32 v53, v3, 5, v53
v_lshl_add_u32 v53, v6, 3, v53
v_add_u32 v52, 65536, v52
v_add_u32 v53, 65536, v53
s_lshl_b32 s88, s12, 8
s_lshl_b32 s90, s13, 17
s_add_u32 s88, s88, s90
s_lshl_b32 s89, s12, 17
s_lshl_b32 s90, s13, 14
s_add_u32 s89, s89, s90
s_lshl_b32 s92, s13, 12
s_add_u32 s92, s92, 65536
s_waitcnt lgkmcnt(0)
s_mov_b32 s76, s68
s_mov_b32 s77, s69
s_mov_b32 s78, 4194304
s_mov_b32 s79, 0x20000
s_mov_b32 s80, s70
s_mov_b32 s81, s71
s_mov_b32 s82, 4194304
s_mov_b32 s83, 0x20000
s_add_u32 s91, s89, 0
s_add_u32 m0, s92, 0
s_nop 0
buffer_load_dwordx4 v50, s[80:83], s91 offen  lds
s_add_u32 s91, s91, 4096
s_add_u32 m0, s92, 1024
s_nop 0
buffer_load_dwordx4 v51, s[80:83], s91 offen  lds
s_add_u32 s91, s91, 4096
s_add_u32 m0, s92, 2048
s_nop 0
buffer_load_dwordx4 v50, s[80:83], s91 offen  lds
s_add_u32 s91, s91, 4096
s_add_u32 m0, s92, 3072
s_nop 0
buffer_load_dwordx4 v51, s[80:83], s91 offen  lds
s_add_u32 s91, s89, 65536
s_add_u32 m0, s92, 16384
s_nop 0
buffer_load_dwordx4 v50, s[80:83], s91 offen  lds
s_add_u32 s91, s91, 4096
s_add_u32 m0, s92, 17408
s_nop 0
buffer_load_dwordx4 v51, s[80:83], s91 offen  lds
s_add_u32 s91, s91, 4096
s_add_u32 m0, s92, 18432
s_nop 0
buffer_load_dwordx4 v50, s[80:83], s91 offen  lds
s_add_u32 s91, s91, 4096
s_add_u32 m0, s92, 19456
s_nop 0
buffer_load_dwordx4 v51, s[80:83], s91 offen  lds
s_add_u32 s91, s89, 256
s_add_u32 m0, s92, 32768
s_nop 0
buffer_load_dwordx4 v50, s[80:83], s91 offen  lds
s_add_u32 s91, s91, 4096
s_add_u32 m0, s92, 33792
s_nop 0
buffer_load_dwordx4 v51, s[80:83], s91 offen  lds
s_add_u32 s91, s91, 4096
s_add_u32 m0, s92, 34816
s_nop 0
buffer_load_dwordx4 v50, s[80:83], s91 offen  lds
s_add_u32 s91, s91, 4096
s_add_u32 m0, s92, 35840
s_nop 0
buffer_load_dwordx4 v51, s[80:83], s91 offen  lds
s_add_u32 s91, s89, 65792
s_add_u32 m0, s92, 49152
s_nop 0
buffer_load_dwordx4 v50, s[80:83], s91 offen  lds
s_add_u32 s91, s91, 4096
s_add_u32 m0, s92, 50176
s_nop 0
buffer_load_dwordx4 v51, s[80:83], s91 offen  lds
s_add_u32 s91, s91, 4096
s_add_u32 m0, s92, 51200
s_nop 0
buffer_load_dwordx4 v50, s[80:83], s91 offen  lds
s_add_u32 s91, s91, 4096
s_add_u32 m0, s92, 52224
s_nop 0
buffer_load_dwordx4 v51, s[80:83], s91 offen  lds
s_and_b32 s40, s14, 3
s_lshl_b32 s16, s40, 13
s_add_u32 s16, s16, 68157440
s_add_u32 s17, s16, 4096
s_lshl_b32 s41, s12, 7
s_and_b32 s42, s13, 1
s_lshl_b32 s24, s42, 12
s_add_u32 s24, s24, s16
s_add_u32 s24, s24, s41
s_mov_b32 s26, s24
s_mov_b32 s40, 67108864
s_add_u32 s18, s40, s41
s_lshl_b32 s41, s13, 14
s_add_u32 s18, s18, s41
s_add_u32 s19, s18, 0x10000
s_add_u32 s20, s18, 0x20000
s_add_u32 s21, s18, 0x30000
s_lshl_b32 s41, s12, 12
s_add_u32 s22, s40, s41
s_lshl_b32 s42, s42, 17
s_add_u32 s22, s22, s42
s_mov_b32 s25, 0
s_lshl_b32 s41, s13, 11
s_lshl_b32 s40, s14, 5
s_add_u32 s40, s40, s12
s_lshl_b32 s27, s40, 13
s_add_u32 s27, s27, s41
s_lshr_b32 s30, s27, 1
s_add_u32 s28, s27, 16777216
s_add_u32 s29, s30, 50331648
s_add_u32 s30, s30, 58720256
s_add_u32 s23, s29, 8257536
s_add_u32 s47, s30, 8257536
s_add_u32 s40, s24, 8192
s_and_b32 s40, s40, 0x6000
s_andn2_b32 s24, s24, 0x6000
s_or_b32 s24, s24, s40
s_lshl_b32 s91, s94, 2
s_add_u32 s91, s91, 128
v_mov_b32 v61, s91
s_lshl_b32 s91, s63, s95
v_mov_b32 v62, s91
s_cmp_eq_u32 s93, 0
s_cbranch_scc0 Lnoat_59
s_mov_b64 exec, 1
global_atomic_or v62, v61, v62, s[98:99] sc0
s_mov_b64 exec, -1
Lnoat_59:
s_load_dwordx2 s[84:85], s[0:1], 8
s_lshl_b32 s42, s15, 5
s_add_u32 s42, s42, s12
v_and_b32 v24, 0x70, v56
v_lshlrev_b32 v24, 6, v24
s_lshl_b32 s40, s42, 4
v_add_u32 v24, s40, v24
s_waitcnt lgkmcnt(0)
global_load_dwordx4 v[20:23], v24, s[84:85]
s_waitcnt vmcnt(12) lgkmcnt(0)
s_barrier
ds_read_b64_tr_b16 v[64:65], v53 offset:0
ds_read_b64_tr_b16 v[66:67], v53 offset:512
ds_read_b64_tr_b16 v[68:69], v53 offset:4096
ds_read_b64_tr_b16 v[70:71], v53 offset:4608
ds_read_b64_tr_b16 v[72:73], v53 offset:8192
ds_read_b64_tr_b16 v[74:75], v53 offset:8704
ds_read_b64_tr_b16 v[76:77], v53 offset:12288
ds_read_b64_tr_b16 v[78:79], v53 offset:12800
s_waitcnt vmcnt(8) lgkmcnt(0)
s_barrier
s_add_u32 s91, s89, 512
s_add_u32 m0, s92, 0
s_nop 0
buffer_load_dwordx4 v50, s[80:83], s91 offen  lds
s_add_u32 s91, s91, 4096
s_add_u32 m0, s92, 1024
s_nop 0
buffer_load_dwordx4 v51, s[80:83], s91 offen  lds
s_add_u32 s91, s91, 4096
s_add_u32 m0, s92, 2048
s_nop 0
buffer_load_dwordx4 v50, s[80:83], s91 offen  lds
s_add_u32 s91, s91, 4096
s_add_u32 m0, s92, 3072
s_nop 0
buffer_load_dwordx4 v51, s[80:83], s91 offen  lds
ds_read_b64_tr_b16 v[80:81], v53 offset:16384
ds_read_b64_tr_b16 v[82:83], v53 offset:16896
ds_read_b64_tr_b16 v[84:85], v53 offset:20480
ds_read_b64_tr_b16 v[86:87], v53 offset:20992
ds_read_b64_tr_b16 v[88:89], v53 offset:24576
ds_read_b64_tr_b16 v[90:91], v53 offset:25088
ds_read_b64_tr_b16 v[92:93], v53 offset:28672
ds_read_b64_tr_b16 v[94:95], v53 offset:29184
s_waitcnt vmcnt(8) lgkmcnt(0)
s_barrier
s_add_u32 s91, s89, 66048
s_add_u32 m0, s92, 16384
s_nop 0
buffer_load_dwordx4 v50, s[80:83], s91 offen  lds
s_add_u32 s91, s91, 4096
s_add_u32 m0, s92, 17408
s_nop 0
buffer_load_dwordx4 v51, s[80:83], s91 offen  lds
s_add_u32 s91, s91, 4096
s_add_u32 m0, s92, 18432
s_nop 0
buffer_load_dwordx4 v50, s[80:83], s91 offen  lds
s_add_u32 s91, s91, 4096
s_add_u32 m0, s92, 19456
s_nop 0
buffer_load_dwordx4 v51, s[80:83], s91 offen  lds
ds_read_b64_tr_b16 v[96:97], v53 offset:32768
ds_read_b64_tr_b16 v[98:99], v53 offset:33280
ds_read_b64_tr_b16 v[100:101], v53 offset:36864
ds_read_b64_tr_b16 v[102:103], v53 offset:37376
ds_read_b64_tr_b16 v[104:105], v53 offset:40960
ds_read_b64_tr_b16 v[106:107], v53 offset:41472
ds_read_b64_tr_b16 v[108:109], v53 offset:45056
ds_read_b64_tr_b16 v[110:111], v53 offset:45568
s_waitcnt vmcnt(8) lgkmcnt(0)
s_barrier
s_add_u32 s91, s89, 768
s_add_u32 m0, s92, 32768
s_nop 0
buffer_load_dwordx4 v50, s[80:83], s91 offen  lds
s_add_u32 s91, s91, 4096
s_add_u32 m0, s92, 33792
s_nop 0
buffer_load_dwordx4 v51, s[80:83], s91 offen  lds
s_add_u32 s91, s91, 4096
s_add_u32 m0, s92, 34816
s_nop 0
buffer_load_dwordx4 v50, s[80:83], s91 offen  lds
s_add_u32 s91, s91, 4096
s_add_u32 m0, s92, 35840
s_nop 0
buffer_load_dwordx4 v51, s[80:83], s91 offen  lds
s_xor_b32 s91, s2, 45
s_or_b32 s91, s91, s61
s_cmp_eq_u32 s91, 0
s_cbranch_scc0 Lnz_61
s_mul_i32 s91, s93, 5120
s_add_u32 s91, s91, 100663296
v_and_b32 v61, 63, v63
v_lshlrev_b32 v61, 4, v61
v_mov_b64 v[12:13], 0
v_mov_b64 v[14:15], 0
buffer_store_dwordx4 v[12:15], v61, s[4:7], s91 offen sc1
s_add_u32 s91, s91, 1024
buffer_store_dwordx4 v[12:15], v61, s[4:7], s91 offen sc1
s_add_u32 s91, s91, 1024
buffer_store_dwordx4 v[12:15], v61, s[4:7], s91 offen sc1
s_add_u32 s91, s91, 1024
buffer_store_dwordx4 v[12:15], v61, s[4:7], s91 offen sc1
s_add_u32 s91, s91, 1024
buffer_store_dwordx4 v[12:15], v61, s[4:7], s91 offen sc1
s_waitcnt vmcnt(0)
s_barrier
s_cmp_eq_u32 s93, 0
s_cbranch_scc0 Lnz_61
s_mov_b64 exec, 1
v_mov_b32 v12, 12
v_mov_b32 v13, 1
global_store_dword v12, v13, s[98:99] sc1
s_mov_b64 exec, -1
s_waitcnt vmcnt(0)
Lnz_61:
s_cmp_eq_u32 s63, 0
s_cbranch_scc1 Lcd_60
v_mov_b32 v61, 163824
s_cmp_eq_u32 s93, 0
s_cbranch_scc0 Lcf_62
s_waitcnt vmcnt(63)
s_mov_b64 exec, 1
ds_write_b32 v61, v62
s_mov_b64 exec, -1
s_waitcnt lgkmcnt(0)
Lcf_62:
s_barrier
ds_read_b32 v61, v61
s_waitcnt lgkmcnt(0)
v_readfirstlane_b32 s91, v61
s_bitcmp1_b32 s91, s95
s_cbranch_scc1 Lreclaim
Lcd_60:
v_mov_b64 v[16:17], -1
v_mov_b64 v[18:19], -1
s_lshl_b32 s40, s12, 12
s_lshl_b32 s41, s15, 17
s_add_u32 s40, s40, s41
s_add_u32 s40, s40, 67108864
buffer_store_dwordx4 v[16:19], v57, s[4:7], s40 offen sc1
v_min_u32 v20, -2, v20
v_min_u32 v21, -2, v21
v_min_u32 v22, -2, v22
v_min_u32 v23, -2, v23
s_cmp_eq_u32 s13, 0
s_cbranch_scc1 Lnz_63
v_mov_b64 v[20:21], -1
v_mov_b64 v[22:23], -1
Lnz_63:
s_lshl_b32 s42, s15, 5
s_add_u32 s42, s42, s12
s_lshl_b32 s40, s42, 7
s_lshl_b32 s41, s13, 13
s_add_u32 s40, s40, s41
s_add_u32 s40, s40, 68157440
s_mov_b64 exec, 0xff
buffer_store_dwordx4 v[20:23], v56, s[4:7], s40 offen sc1
s_mov_b64 exec, -1
ds_read_b64_tr_b16 v[112:113], v53 offset:49152
ds_read_b64_tr_b16 v[114:115], v53 offset:49664
ds_read_b64_tr_b16 v[116:117], v53 offset:53248
ds_read_b64_tr_b16 v[118:119], v53 offset:53760
ds_read_b64_tr_b16 v[120:121], v53 offset:57344
ds_read_b64_tr_b16 v[122:123], v53 offset:57856
ds_read_b64_tr_b16 v[124:125], v53 offset:61440
ds_read_b64_tr_b16 v[126:127], v53 offset:61952
s_waitcnt vmcnt(8) lgkmcnt(0)
s_barrier
s_add_u32 s91, s89, 66304
s_add_u32 m0, s92, 49152
s_nop 0
buffer_load_dwordx4 v50, s[80:83], s91 offen  lds
s_add_u32 s91, s91, 4096
s_add_u32 m0, s92, 50176
s_nop 0
buffer_load_dwordx4 v51, s[80:83], s91 offen  lds
s_add_u32 s91, s91, 4096
s_add_u32 m0, s92, 51200
s_nop 0
buffer_load_dwordx4 v50, s[80:83], s91 offen  lds
s_add_u32 s91, s91, 4096
s_add_u32 m0, s92, 52224
s_nop 0
buffer_load_dwordx4 v51, s[80:83], s91 offen  lds
ds_read_b64_tr_b16 v[128:129], v53 offset:0
ds_read_b64_tr_b16 v[130:131], v53 offset:512
ds_read_b64_tr_b16 v[132:133], v53 offset:4096
ds_read_b64_tr_b16 v[134:135], v53 offset:4608
ds_read_b64_tr_b16 v[136:137], v53 offset:8192
ds_read_b64_tr_b16 v[138:139], v53 offset:8704
ds_read_b64_tr_b16 v[140:141], v53 offset:12288
ds_read_b64_tr_b16 v[142:143], v53 offset:12800
s_waitcnt vmcnt(8) lgkmcnt(0)
s_barrier
s_add_u32 s91, s88, 2097152
s_add_u32 m0, s92, 0
s_nop 0
buffer_load_dwordx4 v48, s[76:79], s91 offen  lds
s_add_u32 s91, s91, 32768
s_add_u32 m0, s92, 1024
s_nop 0
buffer_load_dwordx4 v49, s[76:79], s91 offen  lds
s_add_u32 s91, s91, 32768
s_add_u32 m0, s92, 2048
s_nop 0
buffer_load_dwordx4 v48, s[76:79], s91 offen  lds
s_add_u32 s91, s91, 32768
s_add_u32 m0, s92, 3072
s_nop 0
buffer_load_dwordx4 v49, s[76:79], s91 offen  lds
ds_read_b64_tr_b16 v[144:145], v53 offset:16384
ds_read_b64_tr_b16 v[146:147], v53 offset:16896
ds_read_b64_tr_b16 v[148:149], v53 offset:20480
ds_read_b64_tr_b16 v[150:151], v53 offset:20992
ds_read_b64_tr_b16 v[152:153], v53 offset:24576
ds_read_b64_tr_b16 v[154:155], v53 offset:25088
ds_read_b64_tr_b16 v[156:157], v53 offset:28672
ds_read_b64_tr_b16 v[158:159], v53 offset:29184
s_waitcnt vmcnt(8) lgkmcnt(0)
s_barrier
s_add_u32 s91, s88, 2621440
s_add_u32 m0, s92, 16384
s_nop 0
buffer_load_dwordx4 v48, s[76:79], s91 offen  lds
s_add_u32 s91, s91, 32768
s_add_u32 m0, s92, 17408
s_nop 0
buffer_load_dwordx4 v49, s[76:79], s91 offen  lds
s_add_u32 s91, s91, 32768
s_add_u32 m0, s92, 18432
s_nop 0
buffer_load_dwordx4 v48, s[76:79], s91 offen  lds
s_add_u32 s91, s91, 32768
s_add_u32 m0, s92, 19456
s_nop 0
buffer_load_dwordx4 v49, s[76:79], s91 offen  lds
ds_read_b64_tr_b16 v[160:161], v53 offset:32768
ds_read_b64_tr_b16 v[162:163], v53 offset:33280
ds_read_b64_tr_b16 v[164:165], v53 offset:36864
ds_read_b64_tr_b16 v[166:167], v53 offset:37376
ds_read_b64_tr_b16 v[168:169], v53 offset:40960
ds_read_b64_tr_b16 v[170:171], v53 offset:41472
ds_read_b64_tr_b16 v[172:173], v53 offset:45056
ds_read_b64_tr_b16 v[174:175], v53 offset:45568
s_waitcnt vmcnt(8) lgkmcnt(0)
s_barrier
s_add_u32 s91, s88, 3145728
s_add_u32 m0, s92, 32768
s_nop 0
buffer_load_dwordx4 v48, s[76:79], s91 offen  lds
s_add_u32 s91, s91, 32768
s_add_u32 m0, s92, 33792
s_nop 0
buffer_load_dwordx4 v49, s[76:79], s91 offen  lds
s_add_u32 s91, s91, 32768
s_add_u32 m0, s92, 34816
s_nop 0
buffer_load_dwordx4 v48, s[76:79], s91 offen  lds
s_add_u32 s91, s91, 32768
s_add_u32 m0, s92, 35840
s_nop 0
buffer_load_dwordx4 v49, s[76:79], s91 offen  lds
ds_read_b64_tr_b16 v[176:177], v53 offset:49152
ds_read_b64_tr_b16 v[178:179], v53 offset:49664
ds_read_b64_tr_b16 v[180:181], v53 offset:53248
ds_read_b64_tr_b16 v[182:183], v53 offset:53760
ds_read_b64_tr_b16 v[184:185], v53 offset:57344
ds_read_b64_tr_b16 v[186:187], v53 offset:57856
ds_read_b64_tr_b16 v[188:189], v53 offset:61440
ds_read_b64_tr_b16 v[190:191], v53 offset:61952
s_waitcnt vmcnt(8) lgkmcnt(0)
s_barrier
s_add_u32 s91, s88, 3670016
s_add_u32 m0, s92, 49152
s_nop 0
buffer_load_dwordx4 v48, s[76:79], s91 offen  lds
s_add_u32 s91, s91, 32768
s_add_u32 m0, s92, 50176
s_nop 0
buffer_load_dwordx4 v49, s[76:79], s91 offen  lds
s_add_u32 s91, s91, 32768
s_add_u32 m0, s92, 51200
s_nop 0
buffer_load_dwordx4 v48, s[76:79], s91 offen  lds
s_add_u32 s91, s91, 32768
s_add_u32 m0, s92, 52224
s_nop 0
buffer_load_dwordx4 v49, s[76:79], s91 offen  lds
ds_read_b64_tr_b16 v[192:193], v52 offset:0
ds_read_b64_tr_b16 v[194:195], v52 offset:512
ds_read_b64_tr_b16 v[196:197], v52 offset:8192
ds_read_b64_tr_b16 v[198:199], v52 offset:8704
ds_read_b64_tr_b16 v[200:201], v52 offset:16
ds_read_b64_tr_b16 v[202:203], v52 offset:528
ds_read_b64_tr_b16 v[204:205], v52 offset:8208
ds_read_b64_tr_b16 v[206:207], v52 offset:8720
s_waitcnt vmcnt(8) lgkmcnt(0)
s_barrier
s_add_u32 s91, s88, 0
s_add_u32 m0, s92, 0
s_nop 0
buffer_load_dwordx4 v48, s[76:79], s91 offen  lds
s_add_u32 s91, s91, 32768
s_add_u32 m0, s92, 1024
s_nop 0
buffer_load_dwordx4 v49, s[76:79], s91 offen  lds
s_add_u32 s91, s91, 32768
s_add_u32 m0, s92, 2048
s_nop 0
buffer_load_dwordx4 v48, s[76:79], s91 offen  lds
s_add_u32 s91, s91, 32768
s_add_u32 m0, s92, 3072
s_nop 0
buffer_load_dwordx4 v49, s[76:79], s91 offen  lds
ds_read_b64_tr_b16 v[208:209], v52 offset:16384
ds_read_b64_tr_b16 v[210:211], v52 offset:16896
ds_read_b64_tr_b16 v[212:213], v52 offset:24576
ds_read_b64_tr_b16 v[214:215], v52 offset:25088
ds_read_b64_tr_b16 v[216:217], v52 offset:16400
ds_read_b64_tr_b16 v[218:219], v52 offset:16912
ds_read_b64_tr_b16 v[220:221], v52 offset:24592
ds_read_b64_tr_b16 v[222:223], v52 offset:25104
s_waitcnt vmcnt(8) lgkmcnt(0)
s_barrier
s_add_u32 s91, s88, 524288
s_add_u32 m0, s92, 16384
s_nop 0
buffer_load_dwordx4 v48, s[76:79], s91 offen  lds
s_add_u32 s91, s91, 32768
s_add_u32 m0, s92, 17408
s_nop 0
buffer_load_dwordx4 v49, s[76:79], s91 offen  lds
s_add_u32 s91, s91, 32768
s_add_u32 m0, s92, 18432
s_nop 0
buffer_load_dwordx4 v48, s[76:79], s91 offen  lds
s_add_u32 s91, s91, 32768
s_add_u32 m0, s92, 19456
s_nop 0
buffer_load_dwordx4 v49, s[76:79], s91 offen  lds
ds_read_b64_tr_b16 v[224:225], v52 offset:32768
ds_read_b64_tr_b16 v[226:227], v52 offset:33280
ds_read_b64_tr_b16 v[228:229], v52 offset:40960
ds_read_b64_tr_b16 v[230:231], v52 offset:41472
ds_read_b64_tr_b16 v[232:233], v52 offset:32784
ds_read_b64_tr_b16 v[234:235], v52 offset:33296
ds_read_b64_tr_b16 v[236:237], v52 offset:40976
ds_read_b64_tr_b16 v[238:239], v52 offset:41488
s_waitcnt vmcnt(8) lgkmcnt(0)
s_barrier
s_add_u32 s91, s88, 1048576
s_add_u32 m0, s92, 32768
s_nop 0
buffer_load_dwordx4 v48, s[76:79], s91 offen  lds
s_add_u32 s91, s91, 32768
s_add_u32 m0, s92, 33792
s_nop 0
buffer_load_dwordx4 v49, s[76:79], s91 offen  lds
s_add_u32 s91, s91, 32768
s_add_u32 m0, s92, 34816
s_nop 0
buffer_load_dwordx4 v48, s[76:79], s91 offen  lds
s_add_u32 s91, s91, 32768
s_add_u32 m0, s92, 35840
s_nop 0
buffer_load_dwordx4 v49, s[76:79], s91 offen  lds
ds_read_b64_tr_b16 v[240:241], v52 offset:49152
ds_read_b64_tr_b16 v[242:243], v52 offset:49664
ds_read_b64_tr_b16 v[244:245], v52 offset:57344
ds_read_b64_tr_b16 v[246:247], v52 offset:57856
ds_read_b64_tr_b16 v[248:249], v52 offset:49168
ds_read_b64_tr_b16 v[250:251], v52 offset:49680
ds_read_b64_tr_b16 v[252:253], v52 offset:57360
ds_read_b64_tr_b16 v[254:255], v52 offset:57872
s_waitcnt vmcnt(8) lgkmcnt(0)
s_barrier
s_add_u32 s91, s88, 1572864
s_add_u32 m0, s92, 49152
s_nop 0
buffer_load_dwordx4 v48, s[76:79], s91 offen  lds
s_add_u32 s91, s91, 32768
s_add_u32 m0, s92, 50176
s_nop 0
buffer_load_dwordx4 v49, s[76:79], s91 offen  lds
s_add_u32 s91, s91, 32768
s_add_u32 m0, s92, 51200
s_nop 0
buffer_load_dwordx4 v48, s[76:79], s91 offen  lds
s_add_u32 s91, s91, 32768
s_add_u32 m0, s92, 52224
s_nop 0
buffer_load_dwordx4 v49, s[76:79], s91 offen  lds
v_mov_b32 v44, 0
global_load_dwordx4 v[44:47], v44, s[98:99] sc1
ds_read_b64_tr_b16 v[0:1], v52 offset:0
ds_read_b64_tr_b16 v[2:3], v52 offset:512
ds_read_b64_tr_b16 v[4:5], v52 offset:8192
ds_read_b64_tr_b16 v[6:7], v52 offset:8704
ds_read_b64_tr_b16 v[8:9], v52 offset:16
ds_read_b64_tr_b16 v[10:11], v52 offset:528
ds_read_b64_tr_b16 v[12:13], v52 offset:8208
ds_read_b64_tr_b16 v[14:15], v52 offset:8720
s_waitcnt vmcnt(8) lgkmcnt(0)
s_barrier
ds_write_b128 v58, v[0:3] offset:0
ds_write_b128 v58, v[4:7] offset:4096
ds_write_b128 v58, v[8:11] offset:8192
ds_write_b128 v58, v[12:15] offset:12288
ds_read_b64_tr_b16 v[16:17], v52 offset:16384
ds_read_b64_tr_b16 v[18:19], v52 offset:16896
ds_read_b64_tr_b16 v[20:21], v52 offset:24576
ds_read_b64_tr_b16 v[22:23], v52 offset:25088
ds_read_b64_tr_b16 v[24:25], v52 offset:16400
ds_read_b64_tr_b16 v[26:27], v52 offset:16912
ds_read_b64_tr_b16 v[28:29], v52 offset:24592
ds_read_b64_tr_b16 v[30:31], v52 offset:25104
s_waitcnt vmcnt(4) lgkmcnt(0)
s_barrier
ds_write_b128 v58, v[16:19] offset:16384
ds_write_b128 v58, v[20:23] offset:20480
ds_write_b128 v58, v[24:27] offset:24576
ds_write_b128 v58, v[28:31] offset:28672
ds_read_b64_tr_b16 v[0:1], v52 offset:32768
ds_read_b64_tr_b16 v[2:3], v52 offset:33280
ds_read_b64_tr_b16 v[4:5], v52 offset:40960
ds_read_b64_tr_b16 v[6:7], v52 offset:41472
ds_read_b64_tr_b16 v[8:9], v52 offset:32784
ds_read_b64_tr_b16 v[10:11], v52 offset:33296
ds_read_b64_tr_b16 v[12:13], v52 offset:40976
ds_read_b64_tr_b16 v[14:15], v52 offset:41488
s_waitcnt vmcnt(0) lgkmcnt(0)
s_barrier
buffer_load_dword v43, off, s[4:7], s43 sc1
ds_write_b128 v58, v[0:3] offset:32768
ds_write_b128 v58, v[4:7] offset:36864
ds_write_b128 v58, v[8:11] offset:40960
ds_write_b128 v58, v[12:15] offset:45056
ds_read_b64_tr_b16 v[16:17], v52 offset:49152
ds_read_b64_tr_b16 v[18:19], v52 offset:49664
ds_read_b64_tr_b16 v[20:21], v52 offset:57344
ds_read_b64_tr_b16 v[22:23], v52 offset:57856
ds_read_b64_tr_b16 v[24:25], v52 offset:49168
ds_read_b64_tr_b16 v[26:27], v52 offset:49680
ds_read_b64_tr_b16 v[28:29], v52 offset:57360
ds_read_b64_tr_b16 v[30:31], v52 offset:57872
s_waitcnt lgkmcnt(0)
s_barrier
ds_write_b128 v58, v[16:19] offset:49152
ds_write_b128 v58, v[20:23] offset:53248
ds_write_b128 v58, v[24:27] offset:57344
ds_write_b128 v58, v[28:31] offset:61440
s_waitcnt lgkmcnt(0)
LcodeB:
v_and_b32 v44, 0xffff, v45
v_mul_u32_u24 v44, v44, v47
v_cmp_gt_u32 vcc, 32, v44
s_cbranch_vccz Lhs_64
Lpl_65:
v_mov_b32 v44, 0
global_load_dwordx4 v[44:47], v44, s[98:99] sc1
s_add_u32 s33, s33, 1
s_cmp_gt_u32 s33, 524288
s_cbranch_scc1 Lexit
s_waitcnt vmcnt(0)
v_and_b32 v44, 0xffff, v45
v_mul_u32_u24 v44, v44, v47
v_cmp_gt_u32 vcc, 32, v44
s_cbranch_vccz Lpe_66
s_sleep 2
s_branch Lpl_65
Lpe_66:
v_mov_b32 v43, 0
Lhs_64:
v_readfirstlane_b32 s101, v45
s_waitcnt vmcnt(0)
v_and_b32 v43, 15, v43
v_cmp_ne_u32 vcc, 4, v43
s_cbranch_vccz Lkv0
Lkvs_67:
s_sleep 1
buffer_load_dword v60, off, s[4:7], s43 sc1
s_add_u32 s33, s33, 1
s_cmp_gt_u32 s33, 524288
s_cbranch_scc1 Lexit
s_waitcnt vmcnt(0)
v_and_b32 v60, 15, v60
v_cmp_ne_u32 vcc, 4, v60
s_cbranch_vccnz Lkvs_67
Lkv0:
buffer_load_dwordx4 v[24:27], v56, s[4:7], s27 offen sc1
buffer_load_dwordx4 v[28:31], v56, s[4:7], s27 offen offset:1024 sc1
buffer_load_dwordx4 v[32:35], v56, s[4:7], s28 offen sc1
buffer_load_dwordx4 v[36:39], v56, s[4:7], s28 offen offset:1024 sc1
s_add_u32 s27, s27, 262144
s_add_u32 s28, s28, 262144
v_lshrrev_b32 v1, 4, v56
v_lshrrev_b32 v2, 4, v1
v_and_b32 v3, 7, v1
v_and_b32 v4, 15, v1
v_lshlrev_b32 v61, 7, v2
v_lshl_add_u32 v61, v3, 4, v61
v_lshrrev_b32 v5, 1, v2
v_lshlrev_b32 v62, 13, v5
v_lshl_add_u32 v62, v3, 4, v62
v_lshrrev_b32 v5, 3, v4
v_lshl_add_u32 v62, v5, 12, v62
v_and_b32 v5, 1, v2
v_lshl_add_u32 v62, v5, 3, v62
v_bfe_u32 v5, v1, 3, 1
v_lshlrev_b32 v63, 12, v5
v_lshrrev_b32 v5, 5, v1
v_lshl_add_u32 v63, v5, 8, v63
v_bfe_u32 v5, v1, 4, 1
v_lshl_add_u32 v63, v5, 7, v63
v_lshl_add_u32 v63, v3, 4, v63
s_lshl_b32 s40, s13, 10
v_add_u32 v63, s40, v63
s_waitcnt vmcnt(0)
ds_write_b128 v63, v[24:27] offset:8192
ds_write_b128 v63, v[28:31] offset:8704
ds_write_b128 v63, v[32:35] offset:16384
ds_write_b128 v63, v[36:39] offset:16896
v_mov_b64 v[8:9], -1
v_mov_b64 v[10:11], -1
v_mov_b64 v[12:13], -1
v_mov_b64 v[14:15], -1
ds_read_b128 v[24:27], v58 offset:0
ds_read_b128 v[28:31], v58 offset:4096
ds_read_b128 v[32:35], v58 offset:8192
ds_read_b128 v[36:39], v58 offset:12288
ds_read_b128 v[40:43], v58 offset:16384
ds_read_b128 v[44:47], v58 offset:20480
ds_read_b128 v[48:51], v58 offset:24576
ds_read_b128 v[52:55], v58 offset:28672
v_mov_b64 v[16:17], 0
v_mov_b64 v[18:19], 0
v_mov_b64 v[20:21], 0
v_mov_b64 v[22:23], 0
s_cmp_gt_u32 s101, 0xffff
s_cbranch_scc1 LsafeB
s_branch LstepB_68
.p2alignl 6, 0xbf800000
LstepB_68_b7:
s_setprio 0
s_barrier
LstepB_68:
s_nop 15
buffer_load_dwordx4 v[0:3], v57, s[4:7], s16 offen sc1
s_nop 15
s_nop 3
buffer_load_dwordx4 v[0:3], v57, s[4:7], s16 offen sc1
s_nop 15
s_nop 3
buffer_load_dwordx4 v[0:3], v57, s[4:7], s16 offen sc1
s_waitcnt vmcnt(2)
v_max3_u32 v60, v0, v1, v2
v_max_u32 v60, v60, v3
v_cmp_eq_u32 vcc, -1, v60
ds_write_b128 v57, v[0:3] offset:0
s_cbranch_vccnz Lp2_69
Lp2ok_70:
s_setprio 3
buffer_load_dwordx4 v[4:7], v57, s[4:7], s17 offen sc1
s_waitcnt lgkmcnt(0)
s_barrier
buffer_load_dwordx4 v[0:3], v57, s[4:7], s17 offen sc1
s_mov_b64 exec, s[38:39]
buffer_store_dwordx4 v[8:11], v56, s[4:7], s23 offen sc1
s_mov_b64 exec, -1
buffer_store_dwordx4 v[12:15], v56, s[4:7], s47 offen sc1
s_sub_u32 s40, s14, 1
s_max_i32 s40, s40, 0
s_mov_b64 exec, 1
v_mov_b32 v60, s40
buffer_store_dword v60, off, s[4:7], s8 sc1
s_mov_b64 exec, -1
ds_read_b128 v[8:11], v56 offset:0
ds_read_b128 v[12:15], v56 offset:1024
s_waitcnt vmcnt(4)
ds_write_b128 v57, v[4:7] offset:4096
v_max3_u32 v60, v4, v5, v6
v_max_u32 v60, v60, v7
v_cmp_eq_u32 vcc, -1, v60
s_cbranch_vccnz Lp3r_72
Lp3_71:
s_waitcnt lgkmcnt(0)
s_barrier
v_smfmac_f32_16x16x64_bf16 v[16:19], v[8:11], v[24:31], v59
v_smfmac_f32_16x16x64_bf16 v[20:23], v[8:11], v[32:39], v59
s_setprio 0
buffer_load_dwordx4 v[24:27], v56, s[4:7], s27 offen sc1
buffer_load_dwordx4 v[28:31], v56, s[4:7], s27 offen offset:1024 sc1
buffer_load_dwordx4 v[32:35], v56, s[4:7], s28 offen sc1
buffer_load_dwordx4 v[36:39], v56, s[4:7], s28 offen offset:1024 sc1
s_add_u32 s27, s27, 262144
s_add_u32 s28, s28, 262144
ds_read_b128 v[8:11], v56 offset:2048
ds_read_b128 v[4:7], v56 offset:5120
s_waitcnt vmcnt(7)
ds_read_b128 v[0:3], v56 offset:4096
s_and_b32 s11, s14, 7
s_cmp_eq_u32 s11, 6
s_cselect_b32 s11, 1, 0
s_cbranch_scc0 Lnf_73
s_cmp_lt_u32 s14, 62
s_cselect_b32 s40, 2048, 0
s_add_u32 s43, s43, s40
buffer_load_dword v60, off, s[4:7], s43 sc1
Lnf_73:
s_barrier
v_smfmac_f32_16x16x64_bf16 v[16:19], v[12:15], v[40:47], v59
ds_read_b128 v[40:43], v58 offset:32768
ds_read_b128 v[44:47], v58 offset:36864
v_smfmac_f32_16x16x64_bf16 v[20:23], v[12:15], v[48:55], v59
ds_read_b128 v[48:51], v58 offset:40960
ds_read_b128 v[52:55], v58 offset:45056
ds_read_b128 v[12:15], v56 offset:3072
s_waitcnt lgkmcnt(5)
v_smfmac_f32_16x16x64_bf16 v[16:19], v[0:3], v[192:199], v59
v_smfmac_f32_16x16x64_bf16 v[20:23], v[0:3], v[200:207], v59
ds_read_b128 v[0:3], v56 offset:6144
v_smfmac_f32_16x16x64_bf16 v[16:19], v[4:7], v[208:215], v59
v_smfmac_f32_16x16x64_bf16 v[20:23], v[4:7], v[216:223], v59
ds_read_b128 v[4:7], v56 offset:7168
s_waitcnt lgkmcnt(5)
v_smfmac_f32_16x16x64_bf16 v[16:19], v[8:11], v[40:47], v59
ds_read_b128 v[40:43], v58 offset:49152
ds_read_b128 v[44:47], v58 offset:53248
s_waitcnt lgkmcnt(5)
v_smfmac_f32_16x16x64_bf16 v[20:23], v[8:11], v[48:55], v59
ds_read_b128 v[48:51], v58 offset:57344
ds_read_b128 v[52:55], v58 offset:61440
s_waitcnt lgkmcnt(5)
v_smfmac_f32_16x16x64_bf16 v[16:19], v[0:3], v[224:231], v59
v_smfmac_f32_16x16x64_bf16 v[20:23], v[0:3], v[232:239], v59
s_waitcnt lgkmcnt(4)
v_smfmac_f32_16x16x64_bf16 v[16:19], v[4:7], v[240:247], v59
s_waitcnt lgkmcnt(2)
v_smfmac_f32_16x16x64_bf16 v[16:19], v[12:15], v[40:47], v59
s_barrier
v_smfmac_f32_16x16x64_bf16 v[20:23], v[4:7], v[248:255], v59
s_waitcnt lgkmcnt(0)
v_smfmac_f32_16x16x64_bf16 v[20:23], v[12:15], v[48:55], v59
s_setprio 3
v_cvt_pk_bf16_f32 v16, v16, v17
v_cvt_pk_bf16_f32 v17, v18, v19
s_nop 3
v_cvt_pk_bf16_f32 v18, v22, v23
v_cvt_pk_bf16_f32 v19, v20, v21
ds_write_b128 v57, v[16:19] offset:8192
s_mov_b32 s23, s29
s_mov_b32 s47, s30
s_add_u32 s30, s30, 131072
s_add_u32 s29, s29, 131072
s_waitcnt lgkmcnt(0)
s_barrier
s_setprio 0
v_mov_b64 v[40:41], 0
v_mov_b64 v[42:43], 0
v_mov_b64 v[44:45], 0
v_mov_b64 v[46:47], 0
v_mov_b64 v[48:49], 0
v_mov_b64 v[50:51], 0
v_mov_b64 v[52:53], 0
v_mov_b64 v[54:55], 0
s_add_u32 s14, s14, 1
s_setprio 3
s_barrier
ds_read_b128 v[0:3], v61 offset:16384
ds_read_b128 v[4:7], v61 offset:16896
ds_read_b128 v[8:11], v61 offset:17408
ds_read_b128 v[12:15], v61 offset:17920
s_waitcnt lgkmcnt(3)
v_smfmac_f32_16x16x64_bf16 v[40:43], v[0:3], v[64:71], v59
s_waitcnt lgkmcnt(2)
v_smfmac_f32_16x16x64_bf16 v[40:43], v[4:7], v[72:79], v59
v_smfmac_f32_16x16x64_bf16 v[44:47], v[0:3], v[96:103], v59
s_waitcnt lgkmcnt(1)
v_smfmac_f32_16x16x64_bf16 v[40:43], v[8:11], v[80:87], v59
s_waitcnt lgkmcnt(0)
v_smfmac_f32_16x16x64_bf16 v[40:43], v[12:15], v[88:95], v59
v_smfmac_f32_16x16x64_bf16 v[44:47], v[4:7], v[104:111], v59
v_smfmac_f32_16x16x64_bf16 v[44:47], v[8:11], v[112:119], v59
v_cvt_pk_bf16_f32 v40, v40, v41
v_smfmac_f32_16x16x64_bf16 v[44:47], v[12:15], v[120:127], v59
v_cvt_pk_bf16_f32 v41, v42, v43
v_smfmac_f32_16x16x64_bf16 v[48:51], v[0:3], v[128:135], v59
v_and_or_b32 v40, v40, -2, s25
buffer_store_dwordx2 v[40:41], v62, s[4:7], s18 offen
v_smfmac_f32_16x16x64_bf16 v[48:51], v[4:7], v[136:143], v59
v_cvt_pk_bf16_f32 v44, v44, v45
v_smfmac_f32_16x16x64_bf16 v[48:51], v[8:11], v[144:151], v59
v_cvt_pk_bf16_f32 v45, v46, v47
v_smfmac_f32_16x16x64_bf16 v[48:51], v[12:15], v[152:159], v59
v_and_or_b32 v44, v44, -2, s25
buffer_store_dwordx2 v[44:45], v62, s[4:7], s19 offen
v_smfmac_f32_16x16x64_bf16 v[52:55], v[0:3], v[160:167], v59
v_smfmac_f32_16x16x64_bf16 v[52:55], v[4:7], v[168:175], v59
v_cvt_pk_bf16_f32 v48, v48, v49
v_smfmac_f32_16x16x64_bf16 v[52:55], v[8:11], v[176:183], v59
v_cvt_pk_bf16_f32 v49, v50, v51
v_smfmac_f32_16x16x64_bf16 v[52:55], v[12:15], v[184:191], v59
v_and_or_b32 v48, v48, -2, s25
buffer_store_dwordx2 v[48:49], v62, s[4:7], s20 offen
s_nop 3
v_cvt_pk_bf16_f32 v52, v52, v53
v_cvt_pk_bf16_f32 v53, v54, v55
v_and_or_b32 v52, v52, -2, s25
buffer_store_dwordx2 v[52:53], v62, s[4:7], s21 offen
s_barrier
s_setprio 0
ds_read_b128 v[8:11], v57 offset:12288
v_mov_b64 v[12:13], v[16:17]
v_mov_b32 v14, v19
v_mov_b32 v15, v18
s_xor_b32 s25, s25, 1
s_add_u32 s40, s16, 8192
s_and_b32 s40, s40, 0x6000
s_andn2_b32 s16, s16, 0x6000
s_or_b32 s16, s16, s40
s_add_u32 s17, s16, 4096
v_mov_b64 v[16:17], 0
v_mov_b64 v[18:19], 0
v_mov_b64 v[20:21], 0
v_mov_b64 v[22:23], 0
ds_read_b128 v[40:43], v58 offset:16384
ds_read_b128 v[44:47], v58 offset:20480
ds_read_b128 v[48:51], v58 offset:24576
ds_read_b128 v[52:55], v58 offset:28672
s_waitcnt vmcnt(4)
s_cmp_eq_u32 s11, 0
s_cbranch_scc0 Lkvw_74
Lkvok_75:
ds_write_b128 v63, v[24:27] offset:8192
ds_write_b128 v63, v[28:31] offset:8704
ds_write_b128 v63, v[32:35] offset:16384
ds_write_b128 v63, v[36:39] offset:16896
ds_read_b128 v[24:27], v58 offset:0
ds_read_b128 v[28:31], v58 offset:4096
ds_read_b128 v[32:35], v58 offset:8192
ds_read_b128 v[36:39], v58 offset:12288
s_cmp_eq_u32 s14, s46
s_cbranch_scc1 LdfB_lastB_b7
s_branch LstepB_68_b7
Lp2_69:
buffer_load_dwordx4 v[0:3], v57, s[4:7], s16 offen sc1
s_waitcnt vmcnt(2)
v_max3_u32 v60, v0, v1, v2
v_max_u32 v60, v60, v3
v_cmp_eq_u32 vcc, -1, v60
ds_write_b128 v57, v[0:3] offset:0
s_cbranch_vccz Lp2ok_70
buffer_load_dwordx4 v[0:3], v57, s[4:7], s16 offen sc1
s_waitcnt vmcnt(2)
v_max3_u32 v60, v0, v1, v2
v_max_u32 v60, v60, v3
v_cmp_eq_u32 vcc, -1, v60
ds_write_b128 v57, v[0:3] offset:0
s_cbranch_vccz Lp2ok_70
buffer_load_dwordx4 v[0:3], v57, s[4:7], s16 offen sc1
s_waitcnt vmcnt(2)
v_max3_u32 v60, v0, v1, v2
v_max_u32 v60, v60, v3
v_cmp_eq_u32 vcc, -1, v60
ds_write_b128 v57, v[0:3] offset:0
s_cbranch_vccz Lp2ok_70
buffer_load_dwordx4 v[0:3], v57, s[4:7], s16 offen sc1
s_waitcnt vmcnt(2)
v_max3_u32 v60, v0, v1, v2
v_max_u32 v60, v60, v3
v_cmp_eq_u32 vcc, -1, v60
ds_write_b128 v57, v[0:3] offset:0
s_cbranch_vccz Lp2ok_70
s_add_u32 s33, s33, 1
s_cmp_gt_u32 s33, 524288
s_cbranch_scc1 Lexit
s_branch Lp2_69
Lp3r_72:
s_waitcnt vmcnt(3)
Lp3s_76:
ds_write_b128 v57, v[0:3] offset:4096
v_max3_u32 v60, v0, v1, v2
v_max_u32 v60, v60, v3
v_cmp_eq_u32 vcc, -1, v60
s_cbranch_vccz Lp3_71
buffer_load_dwordx4 v[0:3], v57, s[4:7], s17 offen sc1
s_add_u32 s33, s33, 1
s_cmp_gt_u32 s33, 524288
s_cbranch_scc1 Lexit
s_waitcnt vmcnt(0)
s_branch Lp3s_76
Lkvw_74:
v_and_b32 v60, 15, v60
v_cmp_ne_u32 vcc, 4, v60
s_cbranch_vccz Lkvok_75
Lkvs_77:
s_sleep 4
buffer_load_dword v60, off, s[4:7], s43 sc1
s_add_u32 s33, s33, 1
s_cmp_gt_u32 s33, 524288
s_cbranch_scc1 Lexit
s_waitcnt vmcnt(0)
v_and_b32 v60, 15, v60
v_cmp_ne_u32 vcc, 4, v60
s_cbranch_vccnz Lkvs_77
s_branch Lkvok_75
LdfB_pubB:
v_mov_b64 v[12:13], v[16:17]
v_mov_b32 v14, v19
v_mov_b32 v15, v18
v_min_u32 v12, -2, v12
v_min_u32 v13, -2, v13
v_min_u32 v14, -2, v14
v_min_u32 v15, -2, v15
buffer_store_dwordx4 v[12:15], v56, s[4:7], s47 offen sc1
s_branch LdfB
LdfB_lastB_b7:
s_setprio 0
s_barrier
LdfB_lastB:
s_nop 15
buffer_load_dwordx4 v[0:3], v57, s[4:7], s16 offen sc1
s_nop 15
s_nop 3
buffer_load_dwordx4 v[0:3], v57, s[4:7], s16 offen sc1
s_nop 15
s_nop 3
buffer_load_dwordx4 v[0:3], v57, s[4:7], s16 offen sc1
s_waitcnt vmcnt(2)
v_max3_u32 v60, v0, v1, v2
v_max_u32 v60, v60, v3
v_cmp_eq_u32 vcc, -1, v60
ds_write_b128 v57, v[0:3] offset:0
s_cbranch_vccnz Lp2_78
Lp2ok_79:
s_setprio 3
buffer_load_dwordx4 v[4:7], v57, s[4:7], s17 offen sc1
s_waitcnt lgkmcnt(0)
s_barrier
buffer_load_dwordx4 v[0:3], v57, s[4:7], s17 offen sc1
s_mov_b64 exec, s[38:39]
buffer_store_dwordx4 v[8:11], v56, s[4:7], s23 offen sc1
s_mov_b64 exec, -1
buffer_store_dwordx4 v[12:15], v56, s[4:7], s47 offen sc1
s_sub_u32 s40, s14, 1
s_max_i32 s40, s40, 0
s_mov_b64 exec, 1
v_mov_b32 v60, s40
buffer_store_dword v60, off, s[4:7], s8 sc1
s_mov_b64 exec, -1
ds_read_b128 v[8:11], v56 offset:0
ds_read_b128 v[12:15], v56 offset:1024
s_waitcnt vmcnt(4)
ds_write_b128 v57, v[4:7] offset:4096
v_max3_u32 v60, v4, v5, v6
v_max_u32 v60, v60, v7
v_cmp_eq_u32 vcc, -1, v60
s_cbranch_vccnz Lp3r_81
Lp3_80:
s_waitcnt lgkmcnt(0)
s_barrier
v_smfmac_f32_16x16x64_bf16 v[16:19], v[8:11], v[24:31], v59
v_smfmac_f32_16x16x64_bf16 v[20:23], v[8:11], v[32:39], v59
s_setprio 0
ds_read_b128 v[8:11], v56 offset:2048
ds_read_b128 v[4:7], v56 offset:5120
s_waitcnt vmcnt(3)
ds_read_b128 v[0:3], v56 offset:4096
v_smfmac_f32_16x16x64_bf16 v[16:19], v[12:15], v[40:47], v59
ds_read_b128 v[40:43], v58 offset:32768
ds_read_b128 v[44:47], v58 offset:36864
v_smfmac_f32_16x16x64_bf16 v[20:23], v[12:15], v[48:55], v59
ds_read_b128 v[48:51], v58 offset:40960
ds_read_b128 v[52:55], v58 offset:45056
ds_read_b128 v[12:15], v56 offset:3072
s_waitcnt lgkmcnt(5)
v_smfmac_f32_16x16x64_bf16 v[16:19], v[0:3], v[192:199], v59
v_smfmac_f32_16x16x64_bf16 v[20:23], v[0:3], v[200:207], v59
ds_read_b128 v[0:3], v56 offset:6144
v_smfmac_f32_16x16x64_bf16 v[16:19], v[4:7], v[208:215], v59
v_smfmac_f32_16x16x64_bf16 v[20:23], v[4:7], v[216:223], v59
ds_read_b128 v[4:7], v56 offset:7168
s_waitcnt lgkmcnt(5)
v_smfmac_f32_16x16x64_bf16 v[16:19], v[8:11], v[40:47], v59
ds_read_b128 v[40:43], v58 offset:49152
ds_read_b128 v[44:47], v58 offset:53248
s_waitcnt lgkmcnt(5)
v_smfmac_f32_16x16x64_bf16 v[20:23], v[8:11], v[48:55], v59
ds_read_b128 v[48:51], v58 offset:57344
ds_read_b128 v[52:55], v58 offset:61440
s_waitcnt lgkmcnt(5)
v_smfmac_f32_16x16x64_bf16 v[16:19], v[0:3], v[224:231], v59
v_smfmac_f32_16x16x64_bf16 v[20:23], v[0:3], v[232:239], v59
s_waitcnt lgkmcnt(4)
v_smfmac_f32_16x16x64_bf16 v[16:19], v[4:7], v[240:247], v59
s_waitcnt lgkmcnt(2)
v_smfmac_f32_16x16x64_bf16 v[16:19], v[12:15], v[40:47], v59
v_smfmac_f32_16x16x64_bf16 v[20:23], v[4:7], v[248:255], v59
s_waitcnt lgkmcnt(0)
v_smfmac_f32_16x16x64_bf16 v[20:23], v[12:15], v[48:55], v59
v_mov_b32 v60, 63
s_waitcnt vmcnt(0)
s_mov_b64 exec, 1
buffer_store_dword v60, off, s[4:7], s8 sc1
s_mov_b64 exec, -1
s_setprio 3
v_cvt_pk_bf16_f32 v16, v16, v17
v_cvt_pk_bf16_f32 v17, v18, v19
v_cvt_pk_bf16_f32 v18, v22, v23
v_cvt_pk_bf16_f32 v19, v20, v21
s_mov_b32 s47, s30
s_nop 0
s_branch LdfB_pubB
Lp2_78:
buffer_load_dwordx4 v[0:3], v57, s[4:7], s16 offen sc1
s_waitcnt vmcnt(2)
v_max3_u32 v60, v0, v1, v2
v_max_u32 v60, v60, v3
v_cmp_eq_u32 vcc, -1, v60
ds_write_b128 v57, v[0:3] offset:0
s_cbranch_vccz Lp2ok_79
buffer_load_dwordx4 v[0:3], v57, s[4:7], s16 offen sc1
s_waitcnt vmcnt(2)
v_max3_u32 v60, v0, v1, v2
v_max_u32 v60, v60, v3
v_cmp_eq_u32 vcc, -1, v60
ds_write_b128 v57, v[0:3] offset:0
s_cbranch_vccz Lp2ok_79
buffer_load_dwordx4 v[0:3], v57, s[4:7], s16 offen sc1
s_waitcnt vmcnt(2)
v_max3_u32 v60, v0, v1, v2
v_max_u32 v60, v60, v3
v_cmp_eq_u32 vcc, -1, v60
ds_write_b128 v57, v[0:3] offset:0
s_cbranch_vccz Lp2ok_79
buffer_load_dwordx4 v[0:3], v57, s[4:7], s16 offen sc1
s_waitcnt vmcnt(2)
v_max3_u32 v60, v0, v1, v2
v_max_u32 v60, v60, v3
v_cmp_eq_u32 vcc, -1, v60
ds_write_b128 v57, v[0:3] offset:0
s_cbranch_vccz Lp2ok_79
s_add_u32 s33, s33, 1
s_cmp_gt_u32 s33, 524288
s_cbranch_scc1 Lexit
s_branch Lp2_78
Lp3r_81:
s_waitcnt vmcnt(3)
Lp3s_82:
ds_write_b128 v57, v[0:3] offset:4096
v_max3_u32 v60, v0, v1, v2
v_max_u32 v60, v60, v3
v_cmp_eq_u32 vcc, -1, v60
s_cbranch_vccz Lp3_80
buffer_load_dwordx4 v[0:3], v57, s[4:7], s17 offen sc1
s_add_u32 s33, s33, 1
s_cmp_gt_u32 s33, 524288
s_cbranch_scc1 Lexit
s_waitcnt vmcnt(0)
s_branch Lp3s_82
LsafeB:
s_branch LstepB_83
.p2alignl 6, 0xbf800000
LstepB_83_b7:
s_setprio 0
s_barrier
LstepB_83:
s_nop 15
buffer_load_dwordx4 v[0:3], v57, s[4:7], s16 offen sc1
s_nop 15
s_nop 3
buffer_load_dwordx4 v[0:3], v57, s[4:7], s16 offen sc1
s_nop 15
s_nop 3
buffer_load_dwordx4 v[0:3], v57, s[4:7], s16 offen sc1
s_waitcnt vmcnt(2)
v_max3_u32 v60, v0, v1, v2
v_max_u32 v60, v60, v3
v_cmp_eq_u32 vcc, -1, v60
ds_write_b128 v57, v[0:3] offset:0
s_cbranch_vccnz Lp2_84
Lp2ok_85:
s_setprio 3
buffer_load_dwordx4 v[4:7], v57, s[4:7], s17 offen sc1
s_waitcnt lgkmcnt(0)
s_barrier
buffer_load_dwordx4 v[0:3], v57, s[4:7], s17 offen sc1
s_mov_b64 exec, s[38:39]
buffer_store_dwordx4 v[8:11], v56, s[4:7], s23 offen sc1
s_mov_b64 exec, -1
buffer_store_dwordx4 v[12:15], v56, s[4:7], s47 offen sc1
s_sub_u32 s40, s14, 1
s_max_i32 s40, s40, 0
s_mov_b64 exec, 1
v_mov_b32 v60, s40
buffer_store_dword v60, off, s[4:7], s8 sc1
s_mov_b64 exec, -1
ds_read_b128 v[8:11], v56 offset:0
ds_read_b128 v[12:15], v56 offset:1024
s_waitcnt vmcnt(4)
ds_write_b128 v57, v[4:7] offset:4096
v_max3_u32 v60, v4, v5, v6
v_max_u32 v60, v60, v7
v_cmp_eq_u32 vcc, -1, v60
s_cbranch_vccnz Lp3r_87
Lp3_86:
s_waitcnt lgkmcnt(0)
s_barrier
v_smfmac_f32_16x16x64_bf16 v[16:19], v[8:11], v[24:31], v59
v_smfmac_f32_16x16x64_bf16 v[20:23], v[8:11], v[32:39], v59
s_setprio 0
buffer_load_dwordx4 v[24:27], v56, s[4:7], s27 offen sc1
buffer_load_dwordx4 v[28:31], v56, s[4:7], s27 offen offset:1024 sc1
buffer_load_dwordx4 v[32:35], v56, s[4:7], s28 offen sc1
buffer_load_dwordx4 v[36:39], v56, s[4:7], s28 offen offset:1024 sc1
s_add_u32 s27, s27, 262144
s_add_u32 s28, s28, 262144
ds_read_b128 v[8:11], v56 offset:2048
ds_read_b128 v[4:7], v56 offset:5120
s_waitcnt vmcnt(7)
ds_read_b128 v[0:3], v56 offset:4096
s_and_b32 s11, s14, 7
s_cmp_eq_u32 s11, 6
s_cselect_b32 s11, 1, 0
s_cbranch_scc0 Lnf_88
s_cmp_lt_u32 s14, 62
s_cselect_b32 s40, 2048, 0
s_add_u32 s43, s43, s40
buffer_load_dword v60, off, s[4:7], s43 sc1
Lnf_88:
s_barrier
v_smfmac_f32_16x16x64_bf16 v[16:19], v[12:15], v[40:47], v59
ds_read_b128 v[40:43], v58 offset:32768
ds_read_b128 v[44:47], v58 offset:36864
v_smfmac_f32_16x16x64_bf16 v[20:23], v[12:15], v[48:55], v59
ds_read_b128 v[48:51], v58 offset:40960
ds_read_b128 v[52:55], v58 offset:45056
ds_read_b128 v[12:15], v56 offset:3072
s_waitcnt lgkmcnt(5)
v_smfmac_f32_16x16x64_bf16 v[16:19], v[0:3], v[192:199], v59
v_smfmac_f32_16x16x64_bf16 v[20:23], v[0:3], v[200:207], v59
ds_read_b128 v[0:3], v56 offset:6144
v_smfmac_f32_16x16x64_bf16 v[16:19], v[4:7], v[208:215], v59
v_smfmac_f32_16x16x64_bf16 v[20:23], v[4:7], v[216:223], v59
ds_read_b128 v[4:7], v56 offset:7168
s_waitcnt lgkmcnt(5)
v_smfmac_f32_16x16x64_bf16 v[16:19], v[8:11], v[40:47], v59
ds_read_b128 v[40:43], v58 offset:49152
ds_read_b128 v[44:47], v58 offset:53248
s_waitcnt lgkmcnt(5)
v_smfmac_f32_16x16x64_bf16 v[20:23], v[8:11], v[48:55], v59
ds_read_b128 v[48:51], v58 offset:57344
ds_read_b128 v[52:55], v58 offset:61440
s_waitcnt lgkmcnt(5)
v_smfmac_f32_16x16x64_bf16 v[16:19], v[0:3], v[224:231], v59
v_smfmac_f32_16x16x64_bf16 v[20:23], v[0:3], v[232:239], v59
s_waitcnt lgkmcnt(4)
v_smfmac_f32_16x16x64_bf16 v[16:19], v[4:7], v[240:247], v59
s_waitcnt lgkmcnt(2)
v_smfmac_f32_16x16x64_bf16 v[16:19], v[12:15], v[40:47], v59
s_barrier
v_smfmac_f32_16x16x64_bf16 v[20:23], v[4:7], v[248:255], v59
s_waitcnt lgkmcnt(0)
v_smfmac_f32_16x16x64_bf16 v[20:23], v[12:15], v[48:55], v59
s_setprio 3
v_cvt_pk_bf16_f32 v16, v16, v17
v_cvt_pk_bf16_f32 v17, v18, v19
s_nop 3
v_cvt_pk_bf16_f32 v18, v22, v23
v_cvt_pk_bf16_f32 v19, v20, v21
ds_write_b128 v57, v[16:19] offset:8192
s_mov_b32 s23, s29
s_mov_b32 s47, s30
s_add_u32 s30, s30, 131072
s_add_u32 s29, s29, 131072
s_waitcnt lgkmcnt(0)
s_barrier
s_setprio 0
v_mov_b64 v[40:41], 0
v_mov_b64 v[42:43], 0
v_mov_b64 v[44:45], 0
v_mov_b64 v[46:47], 0
v_mov_b64 v[48:49], 0
v_mov_b64 v[50:51], 0
v_mov_b64 v[52:53], 0
v_mov_b64 v[54:55], 0
s_add_u32 s14, s14, 1
s_setprio 3
s_barrier
ds_read_b128 v[0:3], v61 offset:16384
ds_read_b128 v[4:7], v61 offset:16896
ds_read_b128 v[8:11], v61 offset:17408
ds_read_b128 v[12:15], v61 offset:17920
s_waitcnt lgkmcnt(3)
v_smfmac_f32_16x16x64_bf16 v[40:43], v[0:3], v[64:71], v59
s_waitcnt lgkmcnt(2)
v_smfmac_f32_16x16x64_bf16 v[40:43], v[4:7], v[72:79], v59
v_smfmac_f32_16x16x64_bf16 v[44:47], v[0:3], v[96:103], v59
s_waitcnt lgkmcnt(1)
v_smfmac_f32_16x16x64_bf16 v[40:43], v[8:11], v[80:87], v59
s_waitcnt lgkmcnt(0)
v_smfmac_f32_16x16x64_bf16 v[40:43], v[12:15], v[88:95], v59
v_smfmac_f32_16x16x64_bf16 v[44:47], v[4:7], v[104:111], v59
v_smfmac_f32_16x16x64_bf16 v[44:47], v[8:11], v[112:119], v59
v_cvt_pk_bf16_f32 v40, v40, v41
v_smfmac_f32_16x16x64_bf16 v[44:47], v[12:15], v[120:127], v59
v_cvt_pk_bf16_f32 v41, v42, v43
v_smfmac_f32_16x16x64_bf16 v[48:51], v[0:3], v[128:135], v59
v_and_or_b32 v40, v40, -2, s25
buffer_store_dwordx2 v[40:41], v62, s[4:7], s18 offen sc1
v_smfmac_f32_16x16x64_bf16 v[48:51], v[4:7], v[136:143], v59
v_cvt_pk_bf16_f32 v44, v44, v45
v_smfmac_f32_16x16x64_bf16 v[48:51], v[8:11], v[144:151], v59
v_cvt_pk_bf16_f32 v45, v46, v47
v_smfmac_f32_16x16x64_bf16 v[48:51], v[12:15], v[152:159], v59
v_and_or_b32 v44, v44, -2, s25
buffer_store_dwordx2 v[44:45], v62, s[4:7], s19 offen sc1
v_smfmac_f32_16x16x64_bf16 v[52:55], v[0:3], v[160:167], v59
v_smfmac_f32_16x16x64_bf16 v[52:55], v[4:7], v[168:175], v59
v_cvt_pk_bf16_f32 v48, v48, v49
v_smfmac_f32_16x16x64_bf16 v[52:55], v[8:11], v[176:183], v59
v_cvt_pk_bf16_f32 v49, v50, v51
v_smfmac_f32_16x16x64_bf16 v[52:55], v[12:15], v[184:191], v59
v_and_or_b32 v48, v48, -2, s25
buffer_store_dwordx2 v[48:49], v62, s[4:7], s20 offen sc1
s_nop 3
v_cvt_pk_bf16_f32 v52, v52, v53
v_cvt_pk_bf16_f32 v53, v54, v55
v_and_or_b32 v52, v52, -2, s25
buffer_store_dwordx2 v[52:53], v62, s[4:7], s21 offen sc1
s_barrier
s_setprio 0
ds_read_b128 v[8:11], v57 offset:12288
v_mov_b64 v[12:13], v[16:17]
v_mov_b32 v14, v19
v_mov_b32 v15, v18
s_xor_b32 s25, s25, 1
s_add_u32 s40, s16, 8192
s_and_b32 s40, s40, 0x6000
s_andn2_b32 s16, s16, 0x6000
s_or_b32 s16, s16, s40
s_add_u32 s17, s16, 4096
v_mov_b64 v[16:17], 0
v_mov_b64 v[18:19], 0
v_mov_b64 v[20:21], 0
v_mov_b64 v[22:23], 0
ds_read_b128 v[40:43], v58 offset:16384
ds_read_b128 v[44:47], v58 offset:20480
ds_read_b128 v[48:51], v58 offset:24576
ds_read_b128 v[52:55], v58 offset:28672
s_waitcnt vmcnt(4)
s_cmp_eq_u32 s11, 0
s_cbranch_scc0 Lkvw_89
Lkvok_90:
ds_write_b128 v63, v[24:27] offset:8192
ds_write_b128 v63, v[28:31] offset:8704
ds_write_b128 v63, v[32:35] offset:16384
ds_write_b128 v63, v[36:39] offset:16896
ds_read_b128 v[24:27], v58 offset:0
ds_read_b128 v[28:31], v58 offset:4096
ds_read_b128 v[32:35], v58 offset:8192
ds_read_b128 v[36:39], v58 offset:12288
s_cmp_eq_u32 s14, s46
s_cbranch_scc1 LdsB_lastB_b7
s_branch LstepB_83_b7
Lp2_84:
buffer_load_dwordx4 v[0:3], v57, s[4:7], s16 offen sc1
s_waitcnt vmcnt(2)
v_max3_u32 v60, v0, v1, v2
v_max_u32 v60, v60, v3
v_cmp_eq_u32 vcc, -1, v60
ds_write_b128 v57, v[0:3] offset:0
s_cbranch_vccz Lp2ok_85
buffer_load_dwordx4 v[0:3], v57, s[4:7], s16 offen sc1
s_waitcnt vmcnt(2)
v_max3_u32 v60, v0, v1, v2
v_max_u32 v60, v60, v3
v_cmp_eq_u32 vcc, -1, v60
ds_write_b128 v57, v[0:3] offset:0
s_cbranch_vccz Lp2ok_85
buffer_load_dwordx4 v[0:3], v57, s[4:7], s16 offen sc1
s_waitcnt vmcnt(2)
v_max3_u32 v60, v0, v1, v2
v_max_u32 v60, v60, v3
v_cmp_eq_u32 vcc, -1, v60
ds_write_b128 v57, v[0:3] offset:0
s_cbranch_vccz Lp2ok_85
buffer_load_dwordx4 v[0:3], v57, s[4:7], s16 offen sc1
s_waitcnt vmcnt(2)
v_max3_u32 v60, v0, v1, v2
v_max_u32 v60, v60, v3
v_cmp_eq_u32 vcc, -1, v60
ds_write_b128 v57, v[0:3] offset:0
s_cbranch_vccz Lp2ok_85
s_add_u32 s33, s33, 1
s_cmp_gt_u32 s33, 524288
s_cbranch_scc1 Lexit
s_branch Lp2_84
Lp3r_87:
s_waitcnt vmcnt(3)
Lp3s_91:
ds_write_b128 v57, v[0:3] offset:4096
v_max3_u32 v60, v0, v1, v2
v_max_u32 v60, v60, v3
v_cmp_eq_u32 vcc, -1, v60
s_cbranch_vccz Lp3_86
buffer_load_dwordx4 v[0:3], v57, s[4:7], s17 offen sc1
s_add_u32 s33, s33, 1
s_cmp_gt_u32 s33, 524288
s_cbranch_scc1 Lexit
s_waitcnt vmcnt(0)
s_branch Lp3s_91
Lkvw_89:
v_and_b32 v60, 15, v60
v_cmp_ne_u32 vcc, 4, v60
s_cbranch_vccz Lkvok_90
Lkvs_92:
s_sleep 4
buffer_load_dword v60, off, s[4:7], s43 sc1
s_add_u32 s33, s33, 1
s_cmp_gt_u32 s33, 524288
s_cbranch_scc1 Lexit
s_waitcnt vmcnt(0)
v_and_b32 v60, 15, v60
v_cmp_ne_u32 vcc, 4, v60
s_cbranch_vccnz Lkvs_92
s_branch Lkvok_90
LdsB_pubB:
v_mov_b64 v[12:13], v[16:17]
v_mov_b32 v14, v19
v_mov_b32 v15, v18
v_min_u32 v12, -2, v12
v_min_u32 v13, -2, v13
v_min_u32 v14, -2, v14
v_min_u32 v15, -2, v15
buffer_store_dwordx4 v[12:15], v56, s[4:7], s47 offen sc1
s_branch LdsB
LdsB_lastB_b7:
s_setprio 0
s_barrier
LdsB_lastB:
s_nop 15
buffer_load_dwordx4 v[0:3], v57, s[4:7], s16 offen sc1
s_nop 15
s_nop 3
buffer_load_dwordx4 v[0:3], v57, s[4:7], s16 offen sc1
s_nop 15
s_nop 3
buffer_load_dwordx4 v[0:3], v57, s[4:7], s16 offen sc1
s_waitcnt vmcnt(2)
v_max3_u32 v60, v0, v1, v2
v_max_u32 v60, v60, v3
v_cmp_eq_u32 vcc, -1, v60
ds_write_b128 v57, v[0:3] offset:0
s_cbranch_vccnz Lp2_93
Lp2ok_94:
s_setprio 3
buffer_load_dwordx4 v[4:7], v57, s[4:7], s17 offen sc1
s_waitcnt lgkmcnt(0)
s_barrier
buffer_load_dwordx4 v[0:3], v57, s[4:7], s17 offen sc1
s_mov_b64 exec, s[38:39]
buffer_store_dwordx4 v[8:11], v56, s[4:7], s23 offen sc1
s_mov_b64 exec, -1
buffer_store_dwordx4 v[12:15], v56, s[4:7], s47 offen sc1
s_sub_u32 s40, s14, 1
s_max_i32 s40, s40, 0
s_mov_b64 exec, 1
v_mov_b32 v60, s40
buffer_store_dword v60, off, s[4:7], s8 sc1
s_mov_b64 exec, -1
ds_read_b128 v[8:11], v56 offset:0
ds_read_b128 v[12:15], v56 offset:1024
s_waitcnt vmcnt(4)
ds_write_b128 v57, v[4:7] offset:4096
v_max3_u32 v60, v4, v5, v6
v_max_u32 v60, v60, v7
v_cmp_eq_u32 vcc, -1, v60
s_cbranch_vccnz Lp3r_96
Lp3_95:
s_waitcnt lgkmcnt(0)
s_barrier
v_smfmac_f32_16x16x64_bf16 v[16:19], v[8:11], v[24:31], v59
v_smfmac_f32_16x16x64_bf16 v[20:23], v[8:11], v[32:39], v59
s_setprio 0
ds_read_b128 v[8:11], v56 offset:2048
ds_read_b128 v[4:7], v56 offset:5120
s_waitcnt vmcnt(3)
ds_read_b128 v[0:3], v56 offset:4096
v_smfmac_f32_16x16x64_bf16 v[16:19], v[12:15], v[40:47], v59
ds_read_b128 v[40:43], v58 offset:32768
ds_read_b128 v[44:47], v58 offset:36864
v_smfmac_f32_16x16x64_bf16 v[20:23], v[12:15], v[48:55], v59
ds_read_b128 v[48:51], v58 offset:40960
ds_read_b128 v[52:55], v58 offset:45056
ds_read_b128 v[12:15], v56 offset:3072
s_waitcnt lgkmcnt(5)
v_smfmac_f32_16x16x64_bf16 v[16:19], v[0:3], v[192:199], v59
v_smfmac_f32_16x16x64_bf16 v[20:23], v[0:3], v[200:207], v59
ds_read_b128 v[0:3], v56 offset:6144
v_smfmac_f32_16x16x64_bf16 v[16:19], v[4:7], v[208:215], v59
v_smfmac_f32_16x16x64_bf16 v[20:23], v[4:7], v[216:223], v59
ds_read_b128 v[4:7], v56 offset:7168
s_waitcnt lgkmcnt(5)
v_smfmac_f32_16x16x64_bf16 v[16:19], v[8:11], v[40:47], v59
ds_read_b128 v[40:43], v58 offset:49152
ds_read_b128 v[44:47], v58 offset:53248
s_waitcnt lgkmcnt(5)
v_smfmac_f32_16x16x64_bf16 v[20:23], v[8:11], v[48:55], v59
ds_read_b128 v[48:51], v58 offset:57344
ds_read_b128 v[52:55], v58 offset:61440
s_waitcnt lgkmcnt(5)
v_smfmac_f32_16x16x64_bf16 v[16:19], v[0:3], v[224:231], v59
v_smfmac_f32_16x16x64_bf16 v[20:23], v[0:3], v[232:239], v59
s_waitcnt lgkmcnt(4)
v_smfmac_f32_16x16x64_bf16 v[16:19], v[4:7], v[240:247], v59
s_waitcnt lgkmcnt(2)
v_smfmac_f32_16x16x64_bf16 v[16:19], v[12:15], v[40:47], v59
v_smfmac_f32_16x16x64_bf16 v[20:23], v[4:7], v[248:255], v59
s_waitcnt lgkmcnt(0)
v_smfmac_f32_16x16x64_bf16 v[20:23], v[12:15], v[48:55], v59
v_mov_b32 v60, 63
s_waitcnt vmcnt(0)
s_mov_b64 exec, 1
buffer_store_dword v60, off, s[4:7], s8 sc1
s_mov_b64 exec, -1
s_setprio 3
v_cvt_pk_bf16_f32 v16, v16, v17
v_cvt_pk_bf16_f32 v17, v18, v19
v_cvt_pk_bf16_f32 v18, v22, v23
v_cvt_pk_bf16_f32 v19, v20, v21
s_mov_b32 s47, s30
s_nop 0
s_branch LdsB_pubB
Lp2_93:
buffer_load_dwordx4 v[0:3], v57, s[4:7], s16 offen sc1
s_waitcnt vmcnt(2)
v_max3_u32 v60, v0, v1, v2
v_max_u32 v60, v60, v3
v_cmp_eq_u32 vcc, -1, v60
ds_write_b128 v57, v[0:3] offset:0
s_cbranch_vccz Lp2ok_94
buffer_load_dwordx4 v[0:3], v57, s[4:7], s16 offen sc1
s_waitcnt vmcnt(2)
v_max3_u32 v60, v0, v1, v2
v_max_u32 v60, v60, v3
v_cmp_eq_u32 vcc, -1, v60
ds_write_b128 v57, v[0:3] offset:0
s_cbranch_vccz Lp2ok_94
buffer_load_dwordx4 v[0:3], v57, s[4:7], s16 offen sc1
s_waitcnt vmcnt(2)
v_max3_u32 v60, v0, v1, v2
v_max_u32 v60, v60, v3
v_cmp_eq_u32 vcc, -1, v60
ds_write_b128 v57, v[0:3] offset:0
s_cbranch_vccz Lp2ok_94
buffer_load_dwordx4 v[0:3], v57, s[4:7], s16 offen sc1
s_waitcnt vmcnt(2)
v_max3_u32 v60, v0, v1, v2
v_max_u32 v60, v60, v3
v_cmp_eq_u32 vcc, -1, v60
ds_write_b128 v57, v[0:3] offset:0
s_cbranch_vccz Lp2ok_94
s_add_u32 s33, s33, 1
s_cmp_gt_u32 s33, 524288
s_cbranch_scc1 Lexit
s_branch Lp2_93
Lp3r_96:
s_waitcnt vmcnt(3)
Lp3s_97:
ds_write_b128 v57, v[0:3] offset:4096
v_max3_u32 v60, v0, v1, v2
v_max_u32 v60, v60, v3
v_cmp_eq_u32 vcc, -1, v60
s_cbranch_vccz Lp3_95
buffer_load_dwordx4 v[0:3], v57, s[4:7], s17 offen sc1
s_add_u32 s33, s33, 1
s_cmp_gt_u32 s33, 524288
s_cbranch_scc1 Lexit
s_waitcnt vmcnt(0)
s_branch Lp3s_97
LdfB:
LdsB:
s_waitcnt vmcnt(0)
s_barrier
s_mov_b64 exec, 1
v_mov_b32 v1, 64
buffer_store_dword v1, off, s[4:7], s8 sc1
s_endpgm
Lreclaim:
s_load_dwordx2 s[8:9], s[0:1], 0
s_waitcnt vmcnt(0) lgkmcnt(0)
s_barrier
v_mov_b32 v0, v63
v_lshrrev_b32 v1, 6, v0
s_nop 0
v_readfirstlane_b32 s36, v1
s_mov_b32 s63, 1
s_add_u32 s61, s61, 1
s_cmp_gt_u32 s61, 300
s_cbranch_scc1 Lexit
s_ff0_i32_b32 s95, s91
s_cmp_lt_i32 s95, 0
s_cbranch_scc0 Lrc2
s_add_u32 s94, s94, 1
s_and_b32 s94, s94, 7
s_mov_b32 s95, 0
Lrc2:
s_lshl_b32 s91, s94, 2
s_add_u32 s91, s91, 128
v_mov_b32 v61, s91
s_lshl_b32 s91, s63, s95
v_mov_b32 v62, s91
s_cmp_eq_u32 s36, 0
s_cbranch_scc0 Lnoat_98
s_mov_b64 exec, 1
global_atomic_or v62, v61, v62, s[98:99] sc0
s_mov_b64 exec, -1
Lnoat_98:
v_mov_b32 v61, 0
s_cmp_eq_u32 s36, 0
s_cbranch_scc0 Lcf_99
s_waitcnt vmcnt(0)
s_mov_b64 exec, 1
ds_write_b32 v61, v62
s_mov_b64 exec, -1
s_waitcnt lgkmcnt(0)
Lcf_99:
s_barrier
ds_read_b32 v61, v61
s_waitcnt lgkmcnt(0)
v_readfirstlane_b32 s91, v61
s_bitcmp1_b32 s91, s95
s_cbranch_scc1 Lreclaim
s_barrier
s_mov_b32 s63, 0
s_branch Ldispatch
Lworker:
s_mov_b32 s10, 2097152
s_mov_b32 s11, 0x20000
s_mov_b32 s19, 0x20000
s_lshr_b32 s37, s36, 2
s_and_b32 s38, s36, 3
v_and_b32 v1, 63, v0
v_lshlrev_b32 v50, 4, v1
v_and_b32 v2, 31, v1
v_lshrrev_b32 v3, 5, v1
v_bfe_u32 v4, v1, 1, 3
v_xor_b32 v4, v4, v3
s_lshl_b32 s40, s37, 14
s_add_u32 s40, s40, 65536
v_lshlrev_b32 v5, 7, v2
v_add_u32 v5, s40, v5
v_xor_b32 v6, 0, v4
v_lshl_add_u32 v40, v6, 4, v5
v_xor_b32 v6, 2, v4
v_lshl_add_u32 v41, v6, 4, v5
v_xor_b32 v6, 4, v4
v_lshl_add_u32 v42, v6, 4, v5
v_xor_b32 v6, 6, v4
v_lshl_add_u32 v43, v6, 4, v5
v_bfe_u32 v4, v1, 2, 2
v_lshl_add_u32 v5, v3, 3, v4
v_lshlrev_b32 v5, 9, v5
v_bfe_u32 v6, v1, 4, 1
v_lshl_add_u32 v5, v6, 5, v5
v_and_b32 v6, 3, v1
v_lshl_add_u32 v5, v6, 3, v5
s_lshl_b32 s40, s38, 1
v_xor_b32 v6, s40, v4
v_lshl_add_u32 v44, v6, 6, v5
v_xor_b32 v45, 64, v44
v_lshrrev_b32 v4, 3, v1
v_and_b32 v5, 7, v1
v_lshrrev_b32 v6, 4, v1
v_xor_b32 v5, v5, v6
v_lshlrev_b32 v5, 4, v5
v_lshl_add_u32 v46, v4, 10, v5
v_xor_b32 v47, 64, v46
v_lshlrev_b32 v4, 2, v3
v_xor_b32 v4, v4, v2
v_lshlrev_b32 v52, 4, v4
v_mov_b32 v53, v3
s_waitcnt lgkmcnt(0)
s_getpc_b64 s[86:87]
Lpc:
s_add_u32 s86, s86, tile_table-Lpc
s_addc_u32 s87, s87, 0
s_lshl_b32 s40, s100, 3
s_load_dwordx2 s[88:89], s[86:87], s40
s_sub_u32 s40, s100, 32
s_mul_i32 s41, s40, 10923
s_lshr_b32 s41, s41, 16
s_mul_i32 s42, s41, 6
s_sub_u32 s90, s40, s42
s_or_b32 s43, s41, 1
s_cmp_lt_u32 s100, 32
s_cselect_b32 s90, 0, s90
s_cselect_b32 s41, s100, s41
s_andn2_b32 s42, s41, 1
s_cmp_lt_u32 s100, 32
s_cselect_b32 s43, s42, s43
s_and_b32 s42, s41, 1
s_lshl_b32 s42, s42, 10
s_or_b32 s42, s42, 512
s_or_b32 s42, s42, s43
s_lshl_b32 s43, s90, 6
s_or_b32 s43, s43, s41
s_cmp_eq_u32 s90, 0
s_cselect_b32 s26, s42, s43
s_and_b32 s52, s100, 7
s_mov_b32 s62, 0
s_cmp_eq_u32 s90, 0
s_cbranch_scc1 Lnogate
s_mov_b32 s62, 1
s_mul_i32 s82, s41, 5
s_add_u32 s82, s82, s90
s_sub_u32 s82, s82, 1
s_lshl_b32 s82, s82, 3
s_add_u32 s82, s82, s36
s_load_dwordx2 s[84:85], s[0:1], 80
s_waitcnt lgkmcnt(0)
global_load_dwordx4 v[8:11], v50, s[84:85]
Lg_100:
s_cmp_lt_u32 s82, 2048
s_cbranch_scc0 Lge_101
s_lshl_b32 s40, s82, 10
buffer_load_dwordx4 v[12:15], v50, s[8:11], s40 offen
s_waitcnt vmcnt(0)
v_mov_b32 v16, 0
v_dot2c_f32_bf16 v16, v8, v12
v_dot2c_f32_bf16 v16, v9, v13
v_dot2c_f32_bf16 v16, v10, v14
v_dot2c_f32_bf16 v16, v11, v15
s_nop 3
v_add_f32_dpp v16, v16, v16 quad_perm:[1,0,3,2] row_mask:0xf bank_mask:0xf
s_nop 1
v_add_f32_dpp v16, v16, v16 quad_perm:[2,3,0,1] row_mask:0xf bank_mask:0xf
s_nop 1
v_add_f32_dpp v16, v16, v16 row_ror:4 row_mask:0xf bank_mask:0xf
s_nop 1
v_add_f32_dpp v16, v16, v16 row_ror:8 row_mask:0xf bank_mask:0xf
v_mov_b32 v17, v16
s_nop 1
v_permlane16_swap_b32 v16, v17
v_add_f32 v16, v16, v17
v_mov_b32 v17, v16
s_nop 1
v_permlane32_swap_b32 v16, v17
v_add_f32 v16, v16, v17
v_mul_f32 v16, 0xbfb8aa3b, v16
v_exp_f32 v16, v16
s_nop 0
v_add_f32 v16, 1.0, v16
v_rcp_f32 v16, v16
s_lshl_b32 s40, s82, 2
s_add_u32 s40, s40, 77594624
s_mov_b64 exec, 1
buffer_store_dword v16, v50, s[4:7], s40 offen sc1
s_mov_b64 exec, -1
s_add_u32 s82, s82, 1280
s_branch Lg_100
Lge_101:
Lnogate:
s_and_b32 s41, s26, 63
s_bfe_u32 s40, s26, 0x30006
s_bfe_u32 s49, s26, 0x10009
s_bfe_u32 s43, s26, 0x1000a
s_lshl_b32 s80, s40, 11
s_sub_u32 s81, 2, s49
s_lshl_b32 s40, s40, 3
s_lshl_b32 s43, s43, 2
s_add_u32 s40, s40, s43
s_lshl_b32 s42, s37, 2
s_lshr_b32 s42, s42, s49
s_add_u32 s40, s40, s42
s_add_u32 s20, s40, s38
s_lshl_b32 s20, s20, 15
s_lshr_b32 s48, s38, 1
s_and_b32 s48, s48, s49
s_mov_b32 s79, 1.0
s_mov_b32 s78, 0
s_mov_b32 s77, 1024
s_cmp_lt_u32 s41, 48
s_cbranch_scc0 Lpb_102
s_mov_b32 s22, 16384
s_mov_b32 s18, 4194304
s_mov_b32 s75, 262144
s_mov_b32 s76, 2048
s_lshr_b32 s43, s41, 4
s_and_b32 s41, s41, 15
s_lshl_b32 s42, s41, 7
s_add_u32 s80, s80, s42
s_add_u32 s80, s80, 100663296
s_lshl_b32 s74, s40, 18
s_lshl_b32 s42, s41, 14
s_add_u32 s74, s74, s42
s_lshl_b32 s42, s38, 12
s_add_u32 s74, s74, s42
s_lshl_b32 s42, s43, 24
s_add_u32 s74, s74, s42
s_cmp_eq_u32 s43, 1
s_cbranch_scc1 Lpv_104
s_cmp_eq_u32 s43, 2
s_cbranch_scc1 Lpq_105
s_mov_b32 s16, s66
s_mov_b32 s17, s67
s_branch Lpe_103
Lpv_104:
s_mov_b32 s16, s68
s_mov_b32 s17, s69
s_mov_b32 s78, 1
s_branch Lpe_103
Lpq_105:
s_mov_b32 s16, s64
s_mov_b32 s17, s65
s_mov_b32 s79, 0x3e0293ee
s_mov_b32 s81, 16
s_branch Lpe_103
Lpb_102:
s_mov_b32 s16, s72
s_mov_b32 s17, s73
s_mov_b32 s18, 1572864
s_mov_b32 s80, 100688896
s_mov_b32 s81, 1
s_mov_b32 s22, 6144
s_sub_u32 s41, s41, 48
s_mov_b32 s76, 131072
s_lshl_b32 s74, s41, 20
s_lshl_b32 s42, s38, 18
s_add_u32 s74, s74, s42
s_add_u32 s74, s74, 71303168
s_cmp_lt_u32 s41, 4
s_cbranch_scc1 Lpc_106
s_mov_b32 s78, 1
s_mov_b32 s75, 2048
s_lshl_b32 s42, s40, 11
s_add_u32 s74, s74, s42
s_branch Lpe_103
Lpc_106:
s_mov_b32 s75, 1024
s_mov_b32 s77, 65536
s_lshl_b32 s42, s40, 10
s_add_u32 s74, s74, s42
s_cmp_lt_u32 s41, 2
s_cselect_b32 s79, 0x3eb8aa3b, 1.0
Lpe_103:
s_lshl_b32 s23, s22, 5
s_lshl_b32 s21, s41, 9
s_lshl_b32 s42, s22, 2
s_mul_i32 s42, s42, s36
s_add_u32 s21, s21, s42
s_mov_b32 s51, s52
s_mov_b32 s54, s52
s_mul_i32 s42, s52, s23
s_add_u32 s21, s21, s42
s_lshl_b32 s42, s52, 7
s_add_u32 s20, s20, s42
s_lshr_b32 s42, s22, 1
v_mad_u32_u24 v48, v53, s42, v52
v_xor_b32 v49, 128, v48
s_lshl_b32 s24, s36, 12
s_add_u32 s53, s24, 65536
s_mov_b32 s56, 0
s_add_u32 m0, s53, 0
s_add_u32 s40, s20, 0
s_cmp_eq_u32 s48, 0
s_cbranch_scc0 Lxs_107
buffer_load_dwordx4 v46, s[8:11], s40 offen lds
Lxs_107:
s_add_u32 m0, s53, 1024
s_add_u32 s40, s20, 8192
s_cmp_eq_u32 s48, 0
s_cbranch_scc0 Lxs_108
buffer_load_dwordx4 v47, s[8:11], s40 offen lds
Lxs_108:
s_add_u32 m0, s53, 2048
s_add_u32 s40, s20, 16384
s_cmp_eq_u32 s48, 0
s_cbranch_scc0 Lxs_109
buffer_load_dwordx4 v46, s[8:11], s40 offen lds
Lxs_109:
s_add_u32 m0, s53, 3072
s_add_u32 s40, s20, 24576
s_cmp_eq_u32 s48, 0
s_cbranch_scc0 Lxs_110
buffer_load_dwordx4 v47, s[8:11], s40 offen lds
Lxs_110:
s_add_u32 s54, s54, 1
s_cmp_eq_u32 s54, 8
s_cselect_b32 s40, -7, 1
s_lshl_b32 s40, s40, 7
s_add_u32 s20, s20, s40
s_add_u32 s53, s53, 32768
s_cmp_ge_u32 s53, 163840
s_cselect_b32 s40, 98304, 0
s_sub_u32 s53, s53, s40
s_add_u32 m0, s24, 0
s_mov_b32 s41, s21
buffer_load_dwordx4 v48, s[16:19], s41 offen lds
s_add_u32 m0, s24, 1024
s_add_u32 s41, s41, s22
buffer_load_dwordx4 v49, s[16:19], s41 offen lds
s_add_u32 m0, s24, 2048
s_add_u32 s41, s41, s22
buffer_load_dwordx4 v48, s[16:19], s41 offen lds
s_add_u32 m0, s24, 3072
s_add_u32 s41, s41, s22
buffer_load_dwordx4 v49, s[16:19], s41 offen lds
s_add_u32 s51, s51, 1
s_cmp_eq_u32 s51, 8
s_cselect_b32 s40, -7, 1
s_mul_i32 s41, s40, s23
s_add_u32 s21, s21, s41
s_xor_b32 s24, s24, 32768
s_add_u32 m0, s53, 0
s_add_u32 s40, s20, 0
s_cmp_eq_u32 s48, 0
s_cbranch_scc0 Lxs_111
buffer_load_dwordx4 v46, s[8:11], s40 offen lds
Lxs_111:
s_add_u32 m0, s53, 1024
s_add_u32 s40, s20, 8192
s_cmp_eq_u32 s48, 0
s_cbranch_scc0 Lxs_112
buffer_load_dwordx4 v47, s[8:11], s40 offen lds
Lxs_112:
s_add_u32 m0, s53, 2048
s_add_u32 s40, s20, 16384
s_cmp_eq_u32 s48, 0
s_cbranch_scc0 Lxs_113
buffer_load_dwordx4 v46, s[8:11], s40 offen lds
Lxs_113:
s_add_u32 m0, s53, 3072
s_add_u32 s40, s20, 24576
s_cmp_eq_u32 s48, 0
s_cbranch_scc0 Lxs_114
buffer_load_dwordx4 v47, s[8:11], s40 offen lds
Lxs_114:
s_add_u32 s54, s54, 1
s_cmp_eq_u32 s54, 8
s_cselect_b32 s40, -7, 1
s_lshl_b32 s40, s40, 7
s_add_u32 s20, s20, s40
s_add_u32 s53, s53, 32768
s_cmp_ge_u32 s53, 163840
s_cselect_b32 s40, 98304, 0
s_sub_u32 s53, s53, s40
s_add_u32 m0, s24, 0
s_mov_b32 s41, s21
buffer_load_dwordx4 v48, s[16:19], s41 offen lds
s_add_u32 m0, s24, 1024
s_add_u32 s41, s41, s22
buffer_load_dwordx4 v49, s[16:19], s41 offen lds
s_add_u32 m0, s24, 2048
s_add_u32 s41, s41, s22
buffer_load_dwordx4 v48, s[16:19], s41 offen lds
s_add_u32 m0, s24, 3072
s_add_u32 s41, s41, s22
buffer_load_dwordx4 v49, s[16:19], s41 offen lds
s_add_u32 s51, s51, 1
s_cmp_eq_u32 s51, 8
s_cselect_b32 s40, -7, 1
s_mul_i32 s41, s40, s23
s_add_u32 s21, s21, s41
s_xor_b32 s24, s24, 32768
v_mov_b64 v[128:129], 0
v_mov_b64 v[130:131], 0
v_mov_b64 v[132:133], 0
v_mov_b64 v[134:135], 0
v_mov_b64 v[136:137], 0
v_mov_b64 v[138:139], 0
v_mov_b64 v[140:141], 0
v_mov_b64 v[142:143], 0
v_mov_b64 v[144:145], 0
v_mov_b64 v[146:147], 0
v_mov_b64 v[148:149], 0
v_mov_b64 v[150:151], 0
v_mov_b64 v[152:153], 0
v_mov_b64 v[154:155], 0
v_mov_b64 v[156:157], 0
v_mov_b64 v[158:159], 0
v_mov_b64 v[160:161], 0
v_mov_b64 v[162:163], 0
v_mov_b64 v[164:165], 0
v_mov_b64 v[166:167], 0
v_mov_b64 v[168:169], 0
v_mov_b64 v[170:171], 0
v_mov_b64 v[172:173], 0
v_mov_b64 v[174:175], 0
v_mov_b64 v[176:177], 0
v_mov_b64 v[178:179], 0
v_mov_b64 v[180:181], 0
v_mov_b64 v[182:183], 0
v_mov_b64 v[184:185], 0
v_mov_b64 v[186:187], 0
v_mov_b64 v[188:189], 0
v_mov_b64 v[190:191], 0
v_mov_b64 v[192:193], 0
v_mov_b64 v[194:195], 0
v_mov_b64 v[196:197], 0
v_mov_b64 v[198:199], 0
v_mov_b64 v[200:201], 0
v_mov_b64 v[202:203], 0
v_mov_b64 v[204:205], 0
v_mov_b64 v[206:207], 0
v_mov_b64 v[208:209], 0
v_mov_b64 v[210:211], 0
v_mov_b64 v[212:213], 0
v_mov_b64 v[214:215], 0
v_mov_b64 v[216:217], 0
v_mov_b64 v[218:219], 0
v_mov_b64 v[220:221], 0
v_mov_b64 v[222:223], 0
v_mov_b64 v[224:225], 0
v_mov_b64 v[226:227], 0
v_mov_b64 v[228:229], 0
v_mov_b64 v[230:231], 0
v_mov_b64 v[232:233], 0
v_mov_b64 v[234:235], 0
v_mov_b64 v[236:237], 0
v_mov_b64 v[238:239], 0
v_mov_b64 v[240:241], 0
v_mov_b64 v[242:243], 0
v_mov_b64 v[244:245], 0
v_mov_b64 v[246:247], 0
v_mov_b64 v[248:249], 0
v_mov_b64 v[250:251], 0
v_mov_b64 v[252:253], 0
v_mov_b64 v[254:255], 0
s_mov_b32 s47, 0
s_xor_b32 s91, s2, 45
s_or_b32 s91, s91, s61
s_cmp_eq_u32 s91, 0
s_cbranch_scc0 Lnz_115
s_mul_i32 s91, s36, 5120
s_add_u32 s91, s91, 100663296
v_and_b32 v61, 63, v63
v_lshlrev_b32 v61, 4, v61
v_mov_b64 v[12:13], 0
v_mov_b64 v[14:15], 0
buffer_store_dwordx4 v[12:15], v61, s[4:7], s91 offen sc1
s_add_u32 s91, s91, 1024
buffer_store_dwordx4 v[12:15], v61, s[4:7], s91 offen sc1
s_add_u32 s91, s91, 1024
buffer_store_dwordx4 v[12:15], v61, s[4:7], s91 offen sc1
s_add_u32 s91, s91, 1024
buffer_store_dwordx4 v[12:15], v61, s[4:7], s91 offen sc1
s_add_u32 s91, s91, 1024
buffer_store_dwordx4 v[12:15], v61, s[4:7], s91 offen sc1
s_waitcnt vmcnt(0)
s_barrier
s_cmp_eq_u32 s36, 0
s_cbranch_scc0 Lnz_115
s_mov_b64 exec, 1
v_mov_b32 v12, 12
v_mov_b32 v13, 1
global_store_dword v12, v13, s[98:99] sc1
s_mov_b64 exec, -1
s_waitcnt vmcnt(0)
Lnz_115:
s_waitcnt lgkmcnt(0)
s_mov_b32 s101, s89
s_waitcnt vmcnt(4)
s_barrier
s_lshl_b32 s91, s94, 2
s_add_u32 s91, s91, 128
v_mov_b32 v61, s91
s_lshl_b32 s91, s63, s95
v_mov_b32 v62, s91
s_cmp_eq_u32 s36, 0
s_cbranch_scc0 Lnoat_116
s_mov_b64 exec, 1
global_atomic_or v62, v61, v62, s[98:99] sc0
s_mov_b64 exec, -1
Lnoat_116:
ds_read_b64_tr_b16 v[80:81], v44 offset:0
ds_read_b64_tr_b16 v[82:83], v44 offset:2048
ds_read_b64_tr_b16 v[84:85], v45 offset:0
ds_read_b64_tr_b16 v[86:87], v45 offset:2048
ds_read_b128 v[64:67], v40 offset:0
ds_read_b128 v[68:71], v40 offset:4096
ds_read_b128 v[72:75], v40 offset:8192
ds_read_b128 v[76:79], v40 offset:12288
Ltile_117:
s_mov_b32 s28, s74
s_mov_b32 s29, s75
s_mov_b32 s30, s76
s_mov_b32 s31, s77
s_mov_b32 s32, s78
s_mov_b32 s34, s79
s_mov_b32 s35, s79
s_mov_b32 s44, s80
s_mov_b32 s45, s81
s_mov_b32 s50, s49
s_and_b32 s27, s88, 0xffff
s_lshr_b32 s88, s88, 16
s_or_b32 s88, s88, 0xffff0000
s_mov_b32 s25, 0
s_lshl_b32 s40, s50, 1
s_add_u32 s40, s40, s32
s_cmp_eq_u32 s40, 1
s_cbranch_scc1 Lvar_121
s_cmp_eq_u32 s40, 2
s_cbranch_scc1 Lvar_122
s_cmp_eq_u32 s40, 3
s_cbranch_scc1 Lvar_123
Lvar_120:
s_cmp_eq_u32 s25, 6
s_cbranch_scc0 Lnos_124
s_cmp_lt_u32 s27, 65535
s_cselect_b32 s26, s27, s26
s_and_b32 s41, s26, 63
s_bfe_u32 s40, s26, 0x30006
s_bfe_u32 s49, s26, 0x10009
s_bfe_u32 s43, s26, 0x1000a
s_lshl_b32 s80, s40, 11
s_sub_u32 s81, 2, s49
s_lshl_b32 s40, s40, 3
s_lshl_b32 s43, s43, 2
s_add_u32 s40, s40, s43
s_lshl_b32 s42, s37, 2
s_lshr_b32 s42, s42, s49
s_add_u32 s40, s40, s42
s_add_u32 s20, s40, s38
s_lshl_b32 s20, s20, 15
s_lshr_b32 s48, s38, 1
s_and_b32 s48, s48, s49
s_mov_b32 s79, 1.0
s_mov_b32 s78, 0
s_mov_b32 s77, 1024
s_cmp_lt_u32 s41, 48
s_cbranch_scc0 Lpb_125
s_mov_b32 s22, 16384
s_mov_b32 s18, 4194304
s_mov_b32 s75, 262144
s_mov_b32 s76, 2048
s_lshr_b32 s43, s41, 4
s_and_b32 s41, s41, 15
s_lshl_b32 s42, s41, 7
s_add_u32 s80, s80, s42
s_add_u32 s80, s80, 100663296
s_lshl_b32 s74, s40, 18
s_lshl_b32 s42, s41, 14
s_add_u32 s74, s74, s42
s_lshl_b32 s42, s38, 12
s_add_u32 s74, s74, s42
s_lshl_b32 s42, s43, 24
s_add_u32 s74, s74, s42
s_cmp_eq_u32 s43, 1
s_cbranch_scc1 Lpv_127
s_cmp_eq_u32 s43, 2
s_cbranch_scc1 Lpq_128
s_mov_b32 s16, s66
s_mov_b32 s17, s67
s_branch Lpe_126
Lpv_127:
s_mov_b32 s16, s68
s_mov_b32 s17, s69
s_mov_b32 s78, 1
s_branch Lpe_126
Lpq_128:
s_mov_b32 s16, s64
s_mov_b32 s17, s65
s_mov_b32 s79, 0x3e0293ee
s_mov_b32 s81, 16
s_branch Lpe_126
Lpb_125:
s_mov_b32 s16, s72
s_mov_b32 s17, s73
s_mov_b32 s18, 1572864
s_mov_b32 s80, 100688896
s_mov_b32 s81, 1
s_mov_b32 s22, 6144
s_sub_u32 s41, s41, 48
s_mov_b32 s76, 131072
s_lshl_b32 s74, s41, 20
s_lshl_b32 s42, s38, 18
s_add_u32 s74, s74, s42
s_add_u32 s74, s74, 71303168
s_cmp_lt_u32 s41, 4
s_cbranch_scc1 Lpc_129
s_mov_b32 s78, 1
s_mov_b32 s75, 2048
s_lshl_b32 s42, s40, 11
s_add_u32 s74, s74, s42
s_branch Lpe_126
Lpc_129:
s_mov_b32 s75, 1024
s_mov_b32 s77, 65536
s_lshl_b32 s42, s40, 10
s_add_u32 s74, s74, s42
s_cmp_lt_u32 s41, 2
s_cselect_b32 s79, 0x3eb8aa3b, 1.0
Lpe_126:
s_lshl_b32 s23, s22, 5
s_lshl_b32 s21, s41, 9
s_lshl_b32 s42, s22, 2
s_mul_i32 s42, s42, s36
s_add_u32 s21, s21, s42
s_mov_b32 s51, s52
s_mov_b32 s54, s52
s_mul_i32 s42, s52, s23
s_add_u32 s21, s21, s42
s_lshl_b32 s42, s52, 7
s_add_u32 s20, s20, s42
s_lshr_b32 s42, s22, 1
v_mad_u32_u24 v48, v53, s42, v52
v_xor_b32 v49, 128, v48
Lnos_124:
s_waitcnt lgkmcnt(0)
v_mfma_f32_32x32x16_bf16 v[128:143], v[80:83], v[64:67], v[128:143]
ds_read_b64_tr_b16 v[104:105], v44 offset:8192
ds_read_b64_tr_b16 v[106:107], v44 offset:10240
v_mfma_f32_32x32x16_bf16 v[144:159], v[84:87], v[64:67], v[144:159]
ds_read_b64_tr_b16 v[108:109], v45 offset:8192
s_add_u32 m0, s53, 0
s_add_u32 s40, s20, 0
s_cmp_eq_u32 s48, 0
s_cbranch_scc0 Lxs_130
buffer_load_dwordx4 v46, s[8:11], s40 offen lds
Lxs_130:
v_mfma_f32_32x32x16_bf16 v[160:175], v[80:83], v[68:71], v[160:175]
ds_read_b64_tr_b16 v[110:111], v45 offset:10240
ds_read_b128 v[88:91], v41 offset:0
v_mfma_f32_32x32x16_bf16 v[176:191], v[84:87], v[68:71], v[176:191]
ds_read_b128 v[92:95], v41 offset:4096
s_add_u32 m0, s53, 1024
s_add_u32 s40, s20, 8192
s_cmp_eq_u32 s48, 0
s_cbranch_scc0 Lxs_131
buffer_load_dwordx4 v47, s[8:11], s40 offen lds
Lxs_131:
v_mfma_f32_32x32x16_bf16 v[192:207], v[80:83], v[72:75], v[192:207]
ds_read_b128 v[96:99], v41 offset:8192
ds_read_b128 v[100:103], v41 offset:12288
v_mfma_f32_32x32x16_bf16 v[208:223], v[84:87], v[72:75], v[208:223]
v_mfma_f32_32x32x16_bf16 v[224:239], v[80:83], v[76:79], v[224:239]
v_mfma_f32_32x32x16_bf16 v[240:255], v[84:87], v[76:79], v[240:255]
s_waitcnt lgkmcnt(0)
v_mfma_f32_32x32x16_bf16 v[128:143], v[104:107], v[88:91], v[128:143]
ds_read_b64_tr_b16 v[80:81], v44 offset:16384
ds_read_b64_tr_b16 v[82:83], v44 offset:18432
v_mfma_f32_32x32x16_bf16 v[144:159], v[108:111], v[88:91], v[144:159]
ds_read_b64_tr_b16 v[84:85], v45 offset:16384
s_add_u32 m0, s53, 2048
s_add_u32 s40, s20, 16384
s_cmp_eq_u32 s48, 0
s_cbranch_scc0 Lxs_132
buffer_load_dwordx4 v46, s[8:11], s40 offen lds
Lxs_132:
v_mfma_f32_32x32x16_bf16 v[160:175], v[104:107], v[92:95], v[160:175]
ds_read_b64_tr_b16 v[86:87], v45 offset:18432
ds_read_b128 v[64:67], v42 offset:0
v_mfma_f32_32x32x16_bf16 v[176:191], v[108:111], v[92:95], v[176:191]
ds_read_b128 v[68:71], v42 offset:4096
ds_read_b128 v[72:75], v42 offset:8192
v_mfma_f32_32x32x16_bf16 v[192:207], v[104:107], v[96:99], v[192:207]
ds_read_b128 v[76:79], v42 offset:12288
v_mfma_f32_32x32x16_bf16 v[208:223], v[108:111], v[96:99], v[208:223]
v_mfma_f32_32x32x16_bf16 v[224:239], v[104:107], v[100:103], v[224:239]
v_mfma_f32_32x32x16_bf16 v[240:255], v[108:111], v[100:103], v[240:255]
s_waitcnt lgkmcnt(0)
v_mfma_f32_32x32x16_bf16 v[128:143], v[80:83], v[64:67], v[128:143]
ds_read_b64_tr_b16 v[104:105], v44 offset:24576
ds_read_b64_tr_b16 v[106:107], v44 offset:26624
v_mfma_f32_32x32x16_bf16 v[144:159], v[84:87], v[64:67], v[144:159]
ds_read_b64_tr_b16 v[108:109], v45 offset:24576
s_add_u32 m0, s53, 3072
s_add_u32 s40, s20, 24576
s_cmp_eq_u32 s48, 0
s_cbranch_scc0 Lxs_133
buffer_load_dwordx4 v47, s[8:11], s40 offen lds
Lxs_133:
s_add_u32 s54, s54, 1
s_cmp_eq_u32 s54, 8
s_cselect_b32 s40, -7, 1
s_lshl_b32 s40, s40, 7
s_add_u32 s20, s20, s40
s_add_u32 s53, s53, 32768
s_cmp_ge_u32 s53, 163840
s_cselect_b32 s40, 98304, 0
s_sub_u32 s53, s53, s40
v_mfma_f32_32x32x16_bf16 v[160:175], v[80:83], v[68:71], v[160:175]
ds_read_b64_tr_b16 v[110:111], v45 offset:26624
ds_read_b128 v[88:91], v43 offset:0
v_mfma_f32_32x32x16_bf16 v[176:191], v[84:87], v[68:71], v[176:191]
ds_read_b128 v[92:95], v43 offset:4096
ds_read_b128 v[96:99], v43 offset:8192
v_mfma_f32_32x32x16_bf16 v[192:207], v[80:83], v[72:75], v[192:207]
ds_read_b128 v[100:103], v43 offset:12288
v_mfma_f32_32x32x16_bf16 v[208:223], v[84:87], v[72:75], v[208:223]
v_mfma_f32_32x32x16_bf16 v[224:239], v[80:83], v[76:79], v[224:239]
v_mfma_f32_32x32x16_bf16 v[240:255], v[84:87], v[76:79], v[240:255]
s_add_u32 s56, s56, 1
s_cmp_eq_u32 s56, 3
s_cselect_b32 s56, 0, s56
s_cselect_b32 s55, -2, 1
s_lshl_b32 s55, s55, 15
v_add_u32 v40, s55, v40
v_add_u32 v41, s55, v41
v_add_u32 v42, s55, v42
v_add_u32 v43, s55, v43
v_xor_b32 v44, 32768, v44
v_xor_b32 v45, 32768, v45
s_cmp_eq_u32 s48, 0
s_cbranch_scc1 Lw1_135
s_waitcnt vmcnt(0)
Lw1_135:
s_waitcnt vmcnt(4) lgkmcnt(0)
s_barrier
s_cmp_eq_u32 s47, 0
s_cbranch_scc1 Lnsg_136
v_cmp_eq_u32 vcc, 0, v55
s_cbranch_vccz Lck_137
Lpl_138:
v_mov_b32 v55, 12
global_load_dword v55, v55, s[98:99] sc1
s_add_u32 s33, s33, 1
s_cmp_gt_u32 s33, 524288
s_cbranch_scc1 Lexit
s_waitcnt vmcnt(0)
v_cmp_eq_u32 vcc, 0, v55
s_cbranch_vccz Lpe_139
s_sleep 8
s_branch Lpl_138
Lpe_139:
Lck_137:
s_cmp_eq_u32 s36, 0
s_cbranch_scc0 Lsg_140
s_mov_b64 exec, 1
v_mov_b32 v51, s47
buffer_atomic_add v51, off, s[4:7], s46
s_mov_b64 exec, -1
Lsg_140:
s_cmp_eq_u32 s62, 0
s_cbranch_scc1 Ls2_141
s_mov_b32 s62, 100688896
s_cmp_eq_u32 s36, 0
s_cbranch_scc0 Lsg_142
s_mov_b64 exec, 1
v_mov_b32 v51, 1
buffer_atomic_add v51, off, s[4:7], s62
s_mov_b64 exec, -1
Lsg_142:
s_mov_b32 s62, 0
Ls2_141:
s_mov_b32 s47, 0
Lnsg_136:
v_mfma_f32_32x32x16_bf16 v[128:143], v[104:107], v[88:91], v[128:143]
s_add_u32 m0, s24, 0
s_mov_b32 s41, s21
buffer_load_dwordx4 v48, s[16:19], s41 offen lds
ds_read_b64_tr_b16 v[80:81], v44 offset:0
v_mfma_f32_32x32x16_bf16 v[144:159], v[108:111], v[88:91], v[144:159]
ds_read_b64_tr_b16 v[82:83], v44 offset:2048
s_add_u32 m0, s24, 1024
s_add_u32 s41, s41, s22
buffer_load_dwordx4 v49, s[16:19], s41 offen lds
v_mfma_f32_32x32x16_bf16 v[160:175], v[104:107], v[92:95], v[160:175]
ds_read_b64_tr_b16 v[84:85], v45 offset:0
ds_read_b64_tr_b16 v[86:87], v45 offset:2048
v_mfma_f32_32x32x16_bf16 v[176:191], v[108:111], v[92:95], v[176:191]
s_add_u32 m0, s24, 2048
s_add_u32 s41, s41, s22
buffer_load_dwordx4 v48, s[16:19], s41 offen lds
ds_read_b128 v[64:67], v40 offset:0
v_mfma_f32_32x32x16_bf16 v[192:207], v[104:107], v[96:99], v[192:207]
ds_read_b128 v[68:71], v40 offset:4096
s_add_u32 m0, s24, 3072
s_add_u32 s41, s41, s22
buffer_load_dwordx4 v49, s[16:19], s41 offen lds
s_add_u32 s51, s51, 1
s_cmp_eq_u32 s51, 8
s_cselect_b32 s40, -7, 1
s_mul_i32 s41, s40, s23
s_add_u32 s21, s21, s41
s_xor_b32 s24, s24, 32768
v_mfma_f32_32x32x16_bf16 v[208:223], v[108:111], v[96:99], v[208:223]
ds_read_b128 v[72:75], v40 offset:8192
ds_read_b128 v[76:79], v40 offset:12288
v_mfma_f32_32x32x16_bf16 v[224:239], v[104:107], v[100:103], v[224:239]
v_mfma_f32_32x32x16_bf16 v[240:255], v[108:111], v[100:103], v[240:255]
s_add_u32 s25, s25, 1
s_cmp_lt_u32 s25, 8
s_cbranch_scc1 Lvar_120
s_branch Lepi_118
Lvar_121:
s_cmp_eq_u32 s25, 6
s_cbranch_scc0 Lnos_143
s_cmp_lt_u32 s27, 65535
s_cselect_b32 s26, s27, s26
s_and_b32 s41, s26, 63
s_bfe_u32 s40, s26, 0x30006
s_bfe_u32 s49, s26, 0x10009
s_bfe_u32 s43, s26, 0x1000a
s_lshl_b32 s80, s40, 11
s_sub_u32 s81, 2, s49
s_lshl_b32 s40, s40, 3
s_lshl_b32 s43, s43, 2
s_add_u32 s40, s40, s43
s_lshl_b32 s42, s37, 2
s_lshr_b32 s42, s42, s49
s_add_u32 s40, s40, s42
s_add_u32 s20, s40, s38
s_lshl_b32 s20, s20, 15
s_lshr_b32 s48, s38, 1
s_and_b32 s48, s48, s49
s_mov_b32 s79, 1.0
s_mov_b32 s78, 0
s_mov_b32 s77, 1024
s_cmp_lt_u32 s41, 48
s_cbranch_scc0 Lpb_144
s_mov_b32 s22, 16384
s_mov_b32 s18, 4194304
s_mov_b32 s75, 262144
s_mov_b32 s76, 2048
s_lshr_b32 s43, s41, 4
s_and_b32 s41, s41, 15
s_lshl_b32 s42, s41, 7
s_add_u32 s80, s80, s42
s_add_u32 s80, s80, 100663296
s_lshl_b32 s74, s40, 18
s_lshl_b32 s42, s41, 14
s_add_u32 s74, s74, s42
s_lshl_b32 s42, s38, 12
s_add_u32 s74, s74, s42
s_lshl_b32 s42, s43, 24
s_add_u32 s74, s74, s42
s_cmp_eq_u32 s43, 1
s_cbranch_scc1 Lpv_146
s_cmp_eq_u32 s43, 2
s_cbranch_scc1 Lpq_147
s_mov_b32 s16, s66
s_mov_b32 s17, s67
s_branch Lpe_145
Lpv_146:
s_mov_b32 s16, s68
s_mov_b32 s17, s69
s_mov_b32 s78, 1
s_branch Lpe_145
Lpq_147:
s_mov_b32 s16, s64
s_mov_b32 s17, s65
s_mov_b32 s79, 0x3e0293ee
s_mov_b32 s81, 16
s_branch Lpe_145
Lpb_144:
s_mov_b32 s16, s72
s_mov_b32 s17, s73
s_mov_b32 s18, 1572864
s_mov_b32 s80, 100688896
s_mov_b32 s81, 1
s_mov_b32 s22, 6144
s_sub_u32 s41, s41, 48
s_mov_b32 s76, 131072
s_lshl_b32 s74, s41, 20
s_lshl_b32 s42, s38, 18
s_add_u32 s74, s74, s42
s_add_u32 s74, s74, 71303168
s_cmp_lt_u32 s41, 4
s_cbranch_scc1 Lpc_148
s_mov_b32 s78, 1
s_mov_b32 s75, 2048
s_lshl_b32 s42, s40, 11
s_add_u32 s74, s74, s42
s_branch Lpe_145
Lpc_148:
s_mov_b32 s75, 1024
s_mov_b32 s77, 65536
s_lshl_b32 s42, s40, 10
s_add_u32 s74, s74, s42
s_cmp_lt_u32 s41, 2
s_cselect_b32 s79, 0x3eb8aa3b, 1.0
Lpe_145:
s_lshl_b32 s23, s22, 5
s_lshl_b32 s21, s41, 9
s_lshl_b32 s42, s22, 2
s_mul_i32 s42, s42, s36
s_add_u32 s21, s21, s42
s_mov_b32 s51, s52
s_mov_b32 s54, s52
s_mul_i32 s42, s52, s23
s_add_u32 s21, s21, s42
s_lshl_b32 s42, s52, 7
s_add_u32 s20, s20, s42
s_lshr_b32 s42, s22, 1
v_mad_u32_u24 v48, v53, s42, v52
v_xor_b32 v49, 128, v48
Lnos_143:
s_waitcnt lgkmcnt(0)
v_mfma_f32_32x32x16_bf16 v[128:143], v[64:67], v[80:83], v[128:143]
ds_read_b64_tr_b16 v[104:105], v44 offset:8192
ds_read_b64_tr_b16 v[106:107], v44 offset:10240
v_mfma_f32_32x32x16_bf16 v[144:159], v[64:67], v[84:87], v[144:159]
ds_read_b64_tr_b16 v[108:109], v45 offset:8192
s_add_u32 m0, s53, 0
s_add_u32 s40, s20, 0
s_cmp_eq_u32 s48, 0
s_cbranch_scc0 Lxs_149
buffer_load_dwordx4 v46, s[8:11], s40 offen lds
Lxs_149:
v_mfma_f32_32x32x16_bf16 v[160:175], v[68:71], v[80:83], v[160:175]
ds_read_b64_tr_b16 v[110:111], v45 offset:10240
ds_read_b128 v[88:91], v41 offset:0
v_mfma_f32_32x32x16_bf16 v[176:191], v[68:71], v[84:87], v[176:191]
ds_read_b128 v[92:95], v41 offset:4096
s_add_u32 m0, s53, 1024
s_add_u32 s40, s20, 8192
s_cmp_eq_u32 s48, 0
s_cbranch_scc0 Lxs_150
buffer_load_dwordx4 v47, s[8:11], s40 offen lds
Lxs_150:
v_mfma_f32_32x32x16_bf16 v[192:207], v[72:75], v[80:83], v[192:207]
ds_read_b128 v[96:99], v41 offset:8192
ds_read_b128 v[100:103], v41 offset:12288
v_mfma_f32_32x32x16_bf16 v[208:223], v[72:75], v[84:87], v[208:223]
v_mfma_f32_32x32x16_bf16 v[224:239], v[76:79], v[80:83], v[224:239]
v_mfma_f32_32x32x16_bf16 v[240:255], v[76:79], v[84:87], v[240:255]
s_waitcnt lgkmcnt(0)
v_mfma_f32_32x32x16_bf16 v[128:143], v[88:91], v[104:107], v[128:143]
ds_read_b64_tr_b16 v[80:81], v44 offset:16384
ds_read_b64_tr_b16 v[82:83], v44 offset:18432
v_mfma_f32_32x32x16_bf16 v[144:159], v[88:91], v[108:111], v[144:159]
ds_read_b64_tr_b16 v[84:85], v45 offset:16384
s_add_u32 m0, s53, 2048
s_add_u32 s40, s20, 16384
s_cmp_eq_u32 s48, 0
s_cbranch_scc0 Lxs_151
buffer_load_dwordx4 v46, s[8:11], s40 offen lds
Lxs_151:
v_mfma_f32_32x32x16_bf16 v[160:175], v[92:95], v[104:107], v[160:175]
ds_read_b64_tr_b16 v[86:87], v45 offset:18432
ds_read_b128 v[64:67], v42 offset:0
v_mfma_f32_32x32x16_bf16 v[176:191], v[92:95], v[108:111], v[176:191]
ds_read_b128 v[68:71], v42 offset:4096
ds_read_b128 v[72:75], v42 offset:8192
v_mfma_f32_32x32x16_bf16 v[192:207], v[96:99], v[104:107], v[192:207]
ds_read_b128 v[76:79], v42 offset:12288
v_mfma_f32_32x32x16_bf16 v[208:223], v[96:99], v[108:111], v[208:223]
v_mfma_f32_32x32x16_bf16 v[224:239], v[100:103], v[104:107], v[224:239]
v_mfma_f32_32x32x16_bf16 v[240:255], v[100:103], v[108:111], v[240:255]
s_waitcnt lgkmcnt(0)
v_mfma_f32_32x32x16_bf16 v[128:143], v[64:67], v[80:83], v[128:143]
ds_read_b64_tr_b16 v[104:105], v44 offset:24576
ds_read_b64_tr_b16 v[106:107], v44 offset:26624
v_mfma_f32_32x32x16_bf16 v[144:159], v[64:67], v[84:87], v[144:159]
ds_read_b64_tr_b16 v[108:109], v45 offset:24576
s_add_u32 m0, s53, 3072
s_add_u32 s40, s20, 24576
s_cmp_eq_u32 s48, 0
s_cbranch_scc0 Lxs_152
buffer_load_dwordx4 v47, s[8:11], s40 offen lds
Lxs_152:
s_add_u32 s54, s54, 1
s_cmp_eq_u32 s54, 8
s_cselect_b32 s40, -7, 1
s_lshl_b32 s40, s40, 7
s_add_u32 s20, s20, s40
s_add_u32 s53, s53, 32768
s_cmp_ge_u32 s53, 163840
s_cselect_b32 s40, 98304, 0
s_sub_u32 s53, s53, s40
v_mfma_f32_32x32x16_bf16 v[160:175], v[68:71], v[80:83], v[160:175]
ds_read_b64_tr_b16 v[110:111], v45 offset:26624
ds_read_b128 v[88:91], v43 offset:0
v_mfma_f32_32x32x16_bf16 v[176:191], v[68:71], v[84:87], v[176:191]
ds_read_b128 v[92:95], v43 offset:4096
ds_read_b128 v[96:99], v43 offset:8192
v_mfma_f32_32x32x16_bf16 v[192:207], v[72:75], v[80:83], v[192:207]
ds_read_b128 v[100:103], v43 offset:12288
v_mfma_f32_32x32x16_bf16 v[208:223], v[72:75], v[84:87], v[208:223]
v_mfma_f32_32x32x16_bf16 v[224:239], v[76:79], v[80:83], v[224:239]
v_mfma_f32_32x32x16_bf16 v[240:255], v[76:79], v[84:87], v[240:255]
s_add_u32 s56, s56, 1
s_cmp_eq_u32 s56, 3
s_cselect_b32 s56, 0, s56
s_cselect_b32 s55, -2, 1
s_lshl_b32 s55, s55, 15
v_add_u32 v40, s55, v40
v_add_u32 v41, s55, v41
v_add_u32 v42, s55, v42
v_add_u32 v43, s55, v43
v_xor_b32 v44, 32768, v44
v_xor_b32 v45, 32768, v45
s_cmp_eq_u32 s48, 0
s_cbranch_scc1 Lw1_154
s_waitcnt vmcnt(0)
Lw1_154:
s_waitcnt vmcnt(4) lgkmcnt(0)
s_barrier
s_cmp_eq_u32 s47, 0
s_cbranch_scc1 Lnsg_155
v_cmp_eq_u32 vcc, 0, v55
s_cbranch_vccz Lck_156
Lpl_157:
v_mov_b32 v55, 12
global_load_dword v55, v55, s[98:99] sc1
s_add_u32 s33, s33, 1
s_cmp_gt_u32 s33, 524288
s_cbranch_scc1 Lexit
s_waitcnt vmcnt(0)
v_cmp_eq_u32 vcc, 0, v55
s_cbranch_vccz Lpe_158
s_sleep 8
s_branch Lpl_157
Lpe_158:
Lck_156:
s_cmp_eq_u32 s36, 0
s_cbranch_scc0 Lsg_159
s_mov_b64 exec, 1
v_mov_b32 v51, s47
buffer_atomic_add v51, off, s[4:7], s46
s_mov_b64 exec, -1
Lsg_159:
s_cmp_eq_u32 s62, 0
s_cbranch_scc1 Ls2_160
s_mov_b32 s62, 100688896
s_cmp_eq_u32 s36, 0
s_cbranch_scc0 Lsg_161
s_mov_b64 exec, 1
v_mov_b32 v51, 1
buffer_atomic_add v51, off, s[4:7], s62
s_mov_b64 exec, -1
Lsg_161:
s_mov_b32 s62, 0
Ls2_160:
s_mov_b32 s47, 0
Lnsg_155:
v_mfma_f32_32x32x16_bf16 v[128:143], v[88:91], v[104:107], v[128:143]
s_add_u32 m0, s24, 0
s_mov_b32 s41, s21
buffer_load_dwordx4 v48, s[16:19], s41 offen lds
ds_read_b64_tr_b16 v[80:81], v44 offset:0
v_mfma_f32_32x32x16_bf16 v[144:159], v[88:91], v[108:111], v[144:159]
ds_read_b64_tr_b16 v[82:83], v44 offset:2048
s_add_u32 m0, s24, 1024
s_add_u32 s41, s41, s22
buffer_load_dwordx4 v49, s[16:19], s41 offen lds
v_mfma_f32_32x32x16_bf16 v[160:175], v[92:95], v[104:107], v[160:175]
ds_read_b64_tr_b16 v[84:85], v45 offset:0
ds_read_b64_tr_b16 v[86:87], v45 offset:2048
v_mfma_f32_32x32x16_bf16 v[176:191], v[92:95], v[108:111], v[176:191]
s_add_u32 m0, s24, 2048
s_add_u32 s41, s41, s22
buffer_load_dwordx4 v48, s[16:19], s41 offen lds
ds_read_b128 v[64:67], v40 offset:0
v_mfma_f32_32x32x16_bf16 v[192:207], v[96:99], v[104:107], v[192:207]
ds_read_b128 v[68:71], v40 offset:4096
s_add_u32 m0, s24, 3072
s_add_u32 s41, s41, s22
buffer_load_dwordx4 v49, s[16:19], s41 offen lds
s_add_u32 s51, s51, 1
s_cmp_eq_u32 s51, 8
s_cselect_b32 s40, -7, 1
s_mul_i32 s41, s40, s23
s_add_u32 s21, s21, s41
s_xor_b32 s24, s24, 32768
v_mfma_f32_32x32x16_bf16 v[208:223], v[96:99], v[108:111], v[208:223]
ds_read_b128 v[72:75], v40 offset:8192
ds_read_b128 v[76:79], v40 offset:12288
v_mfma_f32_32x32x16_bf16 v[224:239], v[100:103], v[104:107], v[224:239]
v_mfma_f32_32x32x16_bf16 v[240:255], v[100:103], v[108:111], v[240:255]
s_add_u32 s25, s25, 1
s_cmp_lt_u32 s25, 8
s_cbranch_scc1 Lvar_121
s_branch Lepi_118
Lvar_122:
s_cmp_eq_u32 s25, 6
s_cbranch_scc0 Lnos_162
s_cmp_lt_u32 s27, 65535
s_cselect_b32 s26, s27, s26
s_and_b32 s41, s26, 63
s_bfe_u32 s40, s26, 0x30006
s_bfe_u32 s49, s26, 0x10009
s_bfe_u32 s43, s26, 0x1000a
s_lshl_b32 s80, s40, 11
s_sub_u32 s81, 2, s49
s_lshl_b32 s40, s40, 3
s_lshl_b32 s43, s43, 2
s_add_u32 s40, s40, s43
s_lshl_b32 s42, s37, 2
s_lshr_b32 s42, s42, s49
s_add_u32 s40, s40, s42
s_add_u32 s20, s40, s38
s_lshl_b32 s20, s20, 15
s_lshr_b32 s48, s38, 1
s_and_b32 s48, s48, s49
s_mov_b32 s79, 1.0
s_mov_b32 s78, 0
s_mov_b32 s77, 1024
s_cmp_lt_u32 s41, 48
s_cbranch_scc0 Lpb_163
s_mov_b32 s22, 16384
s_mov_b32 s18, 4194304
s_mov_b32 s75, 262144
s_mov_b32 s76, 2048
s_lshr_b32 s43, s41, 4
s_and_b32 s41, s41, 15
s_lshl_b32 s42, s41, 7
s_add_u32 s80, s80, s42
s_add_u32 s80, s80, 100663296
s_lshl_b32 s74, s40, 18
s_lshl_b32 s42, s41, 14
s_add_u32 s74, s74, s42
s_lshl_b32 s42, s38, 12
s_add_u32 s74, s74, s42
s_lshl_b32 s42, s43, 24
s_add_u32 s74, s74, s42
s_cmp_eq_u32 s43, 1
s_cbranch_scc1 Lpv_165
s_cmp_eq_u32 s43, 2
s_cbranch_scc1 Lpq_166
s_mov_b32 s16, s66
s_mov_b32 s17, s67
s_branch Lpe_164
Lpv_165:
s_mov_b32 s16, s68
s_mov_b32 s17, s69
s_mov_b32 s78, 1
s_branch Lpe_164
Lpq_166:
s_mov_b32 s16, s64
s_mov_b32 s17, s65
s_mov_b32 s79, 0x3e0293ee
s_mov_b32 s81, 16
s_branch Lpe_164
Lpb_163:
s_mov_b32 s16, s72
s_mov_b32 s17, s73
s_mov_b32 s18, 1572864
s_mov_b32 s80, 100688896
s_mov_b32 s81, 1
s_mov_b32 s22, 6144
s_sub_u32 s41, s41, 48
s_mov_b32 s76, 131072
s_lshl_b32 s74, s41, 20
s_lshl_b32 s42, s38, 18
s_add_u32 s74, s74, s42
s_add_u32 s74, s74, 71303168
s_cmp_lt_u32 s41, 4
s_cbranch_scc1 Lpc_167
s_mov_b32 s78, 1
s_mov_b32 s75, 2048
s_lshl_b32 s42, s40, 11
s_add_u32 s74, s74, s42
s_branch Lpe_164
Lpc_167:
s_mov_b32 s75, 1024
s_mov_b32 s77, 65536
s_lshl_b32 s42, s40, 10
s_add_u32 s74, s74, s42
s_cmp_lt_u32 s41, 2
s_cselect_b32 s79, 0x3eb8aa3b, 1.0
Lpe_164:
s_lshl_b32 s23, s22, 5
s_lshl_b32 s21, s41, 9
s_lshl_b32 s42, s22, 2
s_mul_i32 s42, s42, s36
s_add_u32 s21, s21, s42
s_mov_b32 s51, s52
s_mov_b32 s54, s52
s_mul_i32 s42, s52, s23
s_add_u32 s21, s21, s42
s_lshl_b32 s42, s52, 7
s_add_u32 s20, s20, s42
s_lshr_b32 s42, s22, 1
v_mad_u32_u24 v48, v53, s42, v52
v_xor_b32 v49, 128, v48
Lnos_162:
s_waitcnt lgkmcnt(0)
v_mfma_f32_32x32x16_bf16 v[128:143], v[80:83], v[64:67], v[128:143]
ds_read_b64_tr_b16 v[104:105], v44 offset:8192
ds_read_b64_tr_b16 v[106:107], v44 offset:10240
v_mfma_f32_32x32x16_bf16 v[144:159], v[84:87], v[64:67], v[144:159]
ds_read_b64_tr_b16 v[108:109], v45 offset:8192
s_add_u32 m0, s53, 0
s_add_u32 s40, s20, 0
s_cmp_eq_u32 s48, 0
s_cbranch_scc0 Lxs_168
buffer_load_dwordx4 v46, s[8:11], s40 offen lds
Lxs_168:
v_mfma_f32_32x32x16_bf16 v[160:175], v[80:83], v[68:71], v[160:175]
ds_read_b64_tr_b16 v[110:111], v45 offset:10240
ds_read_b128 v[88:91], v41 offset:0
v_mfma_f32_32x32x16_bf16 v[176:191], v[84:87], v[68:71], v[176:191]
ds_read_b128 v[92:95], v41 offset:4096
s_add_u32 m0, s53, 1024
s_add_u32 s40, s20, 8192
s_cmp_eq_u32 s48, 0
s_cbranch_scc0 Lxs_169
buffer_load_dwordx4 v47, s[8:11], s40 offen lds
Lxs_169:
s_waitcnt lgkmcnt(0)
v_mfma_f32_32x32x16_bf16 v[128:143], v[104:107], v[88:91], v[128:143]
ds_read_b64_tr_b16 v[80:81], v44 offset:16384
ds_read_b64_tr_b16 v[82:83], v44 offset:18432
v_mfma_f32_32x32x16_bf16 v[144:159], v[108:111], v[88:91], v[144:159]
ds_read_b64_tr_b16 v[84:85], v45 offset:16384
s_add_u32 m0, s53, 2048
s_add_u32 s40, s20, 16384
s_cmp_eq_u32 s48, 0
s_cbranch_scc0 Lxs_170
buffer_load_dwordx4 v46, s[8:11], s40 offen lds
Lxs_170:
v_mfma_f32_32x32x16_bf16 v[160:175], v[104:107], v[92:95], v[160:175]
ds_read_b64_tr_b16 v[86:87], v45 offset:18432
ds_read_b128 v[64:67], v42 offset:0
v_mfma_f32_32x32x16_bf16 v[176:191], v[108:111], v[92:95], v[176:191]
ds_read_b128 v[68:71], v42 offset:4096
s_waitcnt lgkmcnt(0)
v_mfma_f32_32x32x16_bf16 v[128:143], v[80:83], v[64:67], v[128:143]
ds_read_b64_tr_b16 v[104:105], v44 offset:24576
ds_read_b64_tr_b16 v[106:107], v44 offset:26624
v_mfma_f32_32x32x16_bf16 v[144:159], v[84:87], v[64:67], v[144:159]
ds_read_b64_tr_b16 v[108:109], v45 offset:24576
s_add_u32 m0, s53, 3072
s_add_u32 s40, s20, 24576
s_cmp_eq_u32 s48, 0
s_cbranch_scc0 Lxs_171
buffer_load_dwordx4 v47, s[8:11], s40 offen lds
Lxs_171:
s_add_u32 s54, s54, 1
s_cmp_eq_u32 s54, 8
s_cselect_b32 s40, -7, 1
s_lshl_b32 s40, s40, 7
s_add_u32 s20, s20, s40
s_add_u32 s53, s53, 32768
s_cmp_ge_u32 s53, 163840
s_cselect_b32 s40, 98304, 0
s_sub_u32 s53, s53, s40
v_mfma_f32_32x32x16_bf16 v[160:175], v[80:83], v[68:71], v[160:175]
ds_read_b64_tr_b16 v[110:111], v45 offset:26624
ds_read_b128 v[88:91], v43 offset:0
v_mfma_f32_32x32x16_bf16 v[176:191], v[84:87], v[68:71], v[176:191]
ds_read_b128 v[92:95], v43 offset:4096
s_add_u32 s56, s56, 1
s_cmp_eq_u32 s56, 3
s_cselect_b32 s56, 0, s56
s_cselect_b32 s55, -2, 1
s_lshl_b32 s55, s55, 15
v_add_u32 v40, s55, v40
v_add_u32 v41, s55, v41
v_add_u32 v42, s55, v42
v_add_u32 v43, s55, v43
v_xor_b32 v44, 32768, v44
v_xor_b32 v45, 32768, v45
s_cmp_eq_u32 s48, 0
s_cbranch_scc1 Lw1_173
s_waitcnt vmcnt(0)
Lw1_173:
s_waitcnt vmcnt(4) lgkmcnt(0)
s_barrier
s_cmp_eq_u32 s47, 0
s_cbranch_scc1 Lnsg_174
v_cmp_eq_u32 vcc, 0, v55
s_cbranch_vccz Lck_175
Lpl_176:
v_mov_b32 v55, 12
global_load_dword v55, v55, s[98:99] sc1
s_add_u32 s33, s33, 1
s_cmp_gt_u32 s33, 524288
s_cbranch_scc1 Lexit
s_waitcnt vmcnt(0)
v_cmp_eq_u32 vcc, 0, v55
s_cbranch_vccz Lpe_177
s_sleep 8
s_branch Lpl_176
Lpe_177:
Lck_175:
s_cmp_eq_u32 s36, 0
s_cbranch_scc0 Lsg_178
s_mov_b64 exec, 1
v_mov_b32 v51, s47
buffer_atomic_add v51, off, s[4:7], s46
s_mov_b64 exec, -1
Lsg_178:
s_cmp_eq_u32 s62, 0
s_cbranch_scc1 Ls2_179
s_mov_b32 s62, 100688896
s_cmp_eq_u32 s36, 0
s_cbranch_scc0 Lsg_180
s_mov_b64 exec, 1
v_mov_b32 v51, 1
buffer_atomic_add v51, off, s[4:7], s62
s_mov_b64 exec, -1
Lsg_180:
s_mov_b32 s62, 0
Ls2_179:
s_mov_b32 s47, 0
Lnsg_174:
v_mfma_f32_32x32x16_bf16 v[128:143], v[104:107], v[88:91], v[128:143]
s_add_u32 m0, s24, 0
s_mov_b32 s41, s21
buffer_load_dwordx4 v48, s[16:19], s41 offen lds
ds_read_b64_tr_b16 v[80:81], v44 offset:0
ds_read_b64_tr_b16 v[82:83], v44 offset:2048
v_mfma_f32_32x32x16_bf16 v[144:159], v[108:111], v[88:91], v[144:159]
s_add_u32 m0, s24, 1024
s_add_u32 s41, s41, s22
buffer_load_dwordx4 v49, s[16:19], s41 offen lds
ds_read_b64_tr_b16 v[84:85], v45 offset:0
ds_read_b64_tr_b16 v[86:87], v45 offset:2048
v_mfma_f32_32x32x16_bf16 v[160:175], v[104:107], v[92:95], v[160:175]
s_add_u32 m0, s24, 2048
s_add_u32 s41, s41, s22
buffer_load_dwordx4 v48, s[16:19], s41 offen lds
ds_read_b128 v[64:67], v40 offset:0
ds_read_b128 v[68:71], v40 offset:4096
v_mfma_f32_32x32x16_bf16 v[176:191], v[108:111], v[92:95], v[176:191]
s_add_u32 m0, s24, 3072
s_add_u32 s41, s41, s22
buffer_load_dwordx4 v49, s[16:19], s41 offen lds
s_add_u32 s51, s51, 1
s_cmp_eq_u32 s51, 8
s_cselect_b32 s40, -7, 1
s_mul_i32 s41, s40, s23
s_add_u32 s21, s21, s41
s_xor_b32 s24, s24, 32768
ds_read_b128 v[72:75], v40 offset:8192
ds_read_b128 v[76:79], v40 offset:12288
s_add_u32 s25, s25, 1
s_cmp_lt_u32 s25, 8
s_cbranch_scc1 Lvar_122
s_branch Lepi_118
Lvar_123:
s_cmp_eq_u32 s25, 6
s_cbranch_scc0 Lnos_181
s_cmp_lt_u32 s27, 65535
s_cselect_b32 s26, s27, s26
s_and_b32 s41, s26, 63
s_bfe_u32 s40, s26, 0x30006
s_bfe_u32 s49, s26, 0x10009
s_bfe_u32 s43, s26, 0x1000a
s_lshl_b32 s80, s40, 11
s_sub_u32 s81, 2, s49
s_lshl_b32 s40, s40, 3
s_lshl_b32 s43, s43, 2
s_add_u32 s40, s40, s43
s_lshl_b32 s42, s37, 2
s_lshr_b32 s42, s42, s49
s_add_u32 s40, s40, s42
s_add_u32 s20, s40, s38
s_lshl_b32 s20, s20, 15
s_lshr_b32 s48, s38, 1
s_and_b32 s48, s48, s49
s_mov_b32 s79, 1.0
s_mov_b32 s78, 0
s_mov_b32 s77, 1024
s_cmp_lt_u32 s41, 48
s_cbranch_scc0 Lpb_182
s_mov_b32 s22, 16384
s_mov_b32 s18, 4194304
s_mov_b32 s75, 262144
s_mov_b32 s76, 2048
s_lshr_b32 s43, s41, 4
s_and_b32 s41, s41, 15
s_lshl_b32 s42, s41, 7
s_add_u32 s80, s80, s42
s_add_u32 s80, s80, 100663296
s_lshl_b32 s74, s40, 18
s_lshl_b32 s42, s41, 14
s_add_u32 s74, s74, s42
s_lshl_b32 s42, s38, 12
s_add_u32 s74, s74, s42
s_lshl_b32 s42, s43, 24
s_add_u32 s74, s74, s42
s_cmp_eq_u32 s43, 1
s_cbranch_scc1 Lpv_184
s_cmp_eq_u32 s43, 2
s_cbranch_scc1 Lpq_185
s_mov_b32 s16, s66
s_mov_b32 s17, s67
s_branch Lpe_183
Lpv_184:
s_mov_b32 s16, s68
s_mov_b32 s17, s69
s_mov_b32 s78, 1
s_branch Lpe_183
Lpq_185:
s_mov_b32 s16, s64
s_mov_b32 s17, s65
s_mov_b32 s79, 0x3e0293ee
s_mov_b32 s81, 16
s_branch Lpe_183
Lpb_182:
s_mov_b32 s16, s72
s_mov_b32 s17, s73
s_mov_b32 s18, 1572864
s_mov_b32 s80, 100688896
s_mov_b32 s81, 1
s_mov_b32 s22, 6144
s_sub_u32 s41, s41, 48
s_mov_b32 s76, 131072
s_lshl_b32 s74, s41, 20
s_lshl_b32 s42, s38, 18
s_add_u32 s74, s74, s42
s_add_u32 s74, s74, 71303168
s_cmp_lt_u32 s41, 4
s_cbranch_scc1 Lpc_186
s_mov_b32 s78, 1
s_mov_b32 s75, 2048
s_lshl_b32 s42, s40, 11
s_add_u32 s74, s74, s42
s_branch Lpe_183
Lpc_186:
s_mov_b32 s75, 1024
s_mov_b32 s77, 65536
s_lshl_b32 s42, s40, 10
s_add_u32 s74, s74, s42
s_cmp_lt_u32 s41, 2
s_cselect_b32 s79, 0x3eb8aa3b, 1.0
Lpe_183:
s_lshl_b32 s23, s22, 5
s_lshl_b32 s21, s41, 9
s_lshl_b32 s42, s22, 2
s_mul_i32 s42, s42, s36
s_add_u32 s21, s21, s42
s_mov_b32 s51, s52
s_mov_b32 s54, s52
s_mul_i32 s42, s52, s23
s_add_u32 s21, s21, s42
s_lshl_b32 s42, s52, 7
s_add_u32 s20, s20, s42
s_lshr_b32 s42, s22, 1
v_mad_u32_u24 v48, v53, s42, v52
v_xor_b32 v49, 128, v48
Lnos_181:
s_waitcnt lgkmcnt(0)
v_mfma_f32_32x32x16_bf16 v[128:143], v[64:67], v[80:83], v[128:143]
ds_read_b64_tr_b16 v[104:105], v44 offset:8192
ds_read_b64_tr_b16 v[106:107], v44 offset:10240
v_mfma_f32_32x32x16_bf16 v[144:159], v[64:67], v[84:87], v[144:159]
ds_read_b64_tr_b16 v[108:109], v45 offset:8192
s_add_u32 m0, s53, 0
s_add_u32 s40, s20, 0
s_cmp_eq_u32 s48, 0
s_cbranch_scc0 Lxs_187
buffer_load_dwordx4 v46, s[8:11], s40 offen lds
Lxs_187:
v_mfma_f32_32x32x16_bf16 v[160:175], v[68:71], v[80:83], v[160:175]
ds_read_b64_tr_b16 v[110:111], v45 offset:10240
ds_read_b128 v[88:91], v41 offset:0
v_mfma_f32_32x32x16_bf16 v[176:191], v[68:71], v[84:87], v[176:191]
ds_read_b128 v[92:95], v41 offset:4096
s_add_u32 m0, s53, 1024
s_add_u32 s40, s20, 8192
s_cmp_eq_u32 s48, 0
s_cbranch_scc0 Lxs_188
buffer_load_dwordx4 v47, s[8:11], s40 offen lds
Lxs_188:
s_waitcnt lgkmcnt(0)
v_mfma_f32_32x32x16_bf16 v[128:143], v[88:91], v[104:107], v[128:143]
ds_read_b64_tr_b16 v[80:81], v44 offset:16384
ds_read_b64_tr_b16 v[82:83], v44 offset:18432
v_mfma_f32_32x32x16_bf16 v[144:159], v[88:91], v[108:111], v[144:159]
ds_read_b64_tr_b16 v[84:85], v45 offset:16384
s_add_u32 m0, s53, 2048
s_add_u32 s40, s20, 16384
s_cmp_eq_u32 s48, 0
s_cbranch_scc0 Lxs_189
buffer_load_dwordx4 v46, s[8:11], s40 offen lds
Lxs_189:
v_mfma_f32_32x32x16_bf16 v[160:175], v[92:95], v[104:107], v[160:175]
ds_read_b64_tr_b16 v[86:87], v45 offset:18432
ds_read_b128 v[64:67], v42 offset:0
v_mfma_f32_32x32x16_bf16 v[176:191], v[92:95], v[108:111], v[176:191]
ds_read_b128 v[68:71], v42 offset:4096
s_waitcnt lgkmcnt(0)
v_mfma_f32_32x32x16_bf16 v[128:143], v[64:67], v[80:83], v[128:143]
ds_read_b64_tr_b16 v[104:105], v44 offset:24576
ds_read_b64_tr_b16 v[106:107], v44 offset:26624
v_mfma_f32_32x32x16_bf16 v[144:159], v[64:67], v[84:87], v[144:159]
ds_read_b64_tr_b16 v[108:109], v45 offset:24576
s_add_u32 m0, s53, 3072
s_add_u32 s40, s20, 24576
s_cmp_eq_u32 s48, 0
s_cbranch_scc0 Lxs_190
buffer_load_dwordx4 v47, s[8:11], s40 offen lds
Lxs_190:
s_add_u32 s54, s54, 1
s_cmp_eq_u32 s54, 8
s_cselect_b32 s40, -7, 1
s_lshl_b32 s40, s40, 7
s_add_u32 s20, s20, s40
s_add_u32 s53, s53, 32768
s_cmp_ge_u32 s53, 163840
s_cselect_b32 s40, 98304, 0
s_sub_u32 s53, s53, s40
v_mfma_f32_32x32x16_bf16 v[160:175], v[68:71], v[80:83], v[160:175]
ds_read_b64_tr_b16 v[110:111], v45 offset:26624
ds_read_b128 v[88:91], v43 offset:0
v_mfma_f32_32x32x16_bf16 v[176:191], v[68:71], v[84:87], v[176:191]
ds_read_b128 v[92:95], v43 offset:4096
s_add_u32 s56, s56, 1
s_cmp_eq_u32 s56, 3
s_cselect_b32 s56, 0, s56
s_cselect_b32 s55, -2, 1
s_lshl_b32 s55, s55, 15
v_add_u32 v40, s55, v40
v_add_u32 v41, s55, v41
v_add_u32 v42, s55, v42
v_add_u32 v43, s55, v43
v_xor_b32 v44, 32768, v44
v_xor_b32 v45, 32768, v45
s_cmp_eq_u32 s48, 0
s_cbranch_scc1 Lw1_192
s_waitcnt vmcnt(0)
Lw1_192:
s_waitcnt vmcnt(4) lgkmcnt(0)
s_barrier
s_cmp_eq_u32 s47, 0
s_cbranch_scc1 Lnsg_193
v_cmp_eq_u32 vcc, 0, v55
s_cbranch_vccz Lck_194
Lpl_195:
v_mov_b32 v55, 12
global_load_dword v55, v55, s[98:99] sc1
s_add_u32 s33, s33, 1
s_cmp_gt_u32 s33, 524288
s_cbranch_scc1 Lexit
s_waitcnt vmcnt(0)
v_cmp_eq_u32 vcc, 0, v55
s_cbranch_vccz Lpe_196
s_sleep 8
s_branch Lpl_195
Lpe_196:
Lck_194:
s_cmp_eq_u32 s36, 0
s_cbranch_scc0 Lsg_197
s_mov_b64 exec, 1
v_mov_b32 v51, s47
buffer_atomic_add v51, off, s[4:7], s46
s_mov_b64 exec, -1
Lsg_197:
s_cmp_eq_u32 s62, 0
s_cbranch_scc1 Ls2_198
s_mov_b32 s62, 100688896
s_cmp_eq_u32 s36, 0
s_cbranch_scc0 Lsg_199
s_mov_b64 exec, 1
v_mov_b32 v51, 1
buffer_atomic_add v51, off, s[4:7], s62
s_mov_b64 exec, -1
Lsg_199:
s_mov_b32 s62, 0
Ls2_198:
s_mov_b32 s47, 0
Lnsg_193:
v_mfma_f32_32x32x16_bf16 v[128:143], v[88:91], v[104:107], v[128:143]
s_add_u32 m0, s24, 0
s_mov_b32 s41, s21
buffer_load_dwordx4 v48, s[16:19], s41 offen lds
ds_read_b64_tr_b16 v[80:81], v44 offset:0
ds_read_b64_tr_b16 v[82:83], v44 offset:2048
v_mfma_f32_32x32x16_bf16 v[144:159], v[88:91], v[108:111], v[144:159]
s_add_u32 m0, s24, 1024
s_add_u32 s41, s41, s22
buffer_load_dwordx4 v49, s[16:19], s41 offen lds
ds_read_b64_tr_b16 v[84:85], v45 offset:0
ds_read_b64_tr_b16 v[86:87], v45 offset:2048
v_mfma_f32_32x32x16_bf16 v[160:175], v[92:95], v[104:107], v[160:175]
s_add_u32 m0, s24, 2048
s_add_u32 s41, s41, s22
buffer_load_dwordx4 v48, s[16:19], s41 offen lds
ds_read_b128 v[64:67], v40 offset:0
ds_read_b128 v[68:71], v40 offset:4096
v_mfma_f32_32x32x16_bf16 v[176:191], v[92:95], v[108:111], v[176:191]
s_add_u32 m0, s24, 3072
s_add_u32 s41, s41, s22
buffer_load_dwordx4 v49, s[16:19], s41 offen lds
s_add_u32 s51, s51, 1
s_cmp_eq_u32 s51, 8
s_cselect_b32 s40, -7, 1
s_mul_i32 s41, s40, s23
s_add_u32 s21, s21, s41
s_xor_b32 s24, s24, 32768
ds_read_b128 v[72:75], v40 offset:8192
ds_read_b128 v[76:79], v40 offset:12288
s_add_u32 s25, s25, 1
s_cmp_lt_u32 s25, 8
s_cbranch_scc1 Lvar_123
Lepi_118:
s_cmp_eq_u32 s63, 0
s_cbranch_scc1 Lnc_200
s_mov_b32 s63, 0
v_mov_b32 v61, 98304
s_cmp_eq_u32 s36, 0
s_cbranch_scc0 Lcf_201
s_waitcnt vmcnt(63)
s_mov_b64 exec, 1
ds_write_b32 v61, v62
s_mov_b64 exec, -1
s_waitcnt lgkmcnt(0)
Lcf_201:
s_barrier
ds_read_b32 v61, v61
s_waitcnt lgkmcnt(0)
v_readfirstlane_b32 s91, v61
s_bitcmp1_b32 s91, s95
s_cbranch_scc1 Lreclaim
s_barrier
Lnc_200:
v_mov_b32 v55, 12
global_load_dword v55, v55, s[98:99] sc1
v_pk_mul_f32 v[128:129], v[128:129], s[34:35]
v_pk_mul_f32 v[130:131], v[130:131], s[34:35]
v_pk_mul_f32 v[132:133], v[132:133], s[34:35]
v_pk_mul_f32 v[134:135], v[134:135], s[34:35]
v_pk_mul_f32 v[136:137], v[136:137], s[34:35]
v_pk_mul_f32 v[138:139], v[138:139], s[34:35]
v_pk_mul_f32 v[140:141], v[140:141], s[34:35]
v_pk_mul_f32 v[142:143], v[142:143], s[34:35]
v_cvt_pk_bf16_f32 v0, v128, v129
v_cvt_pk_bf16_f32 v1, v130, v131
v_cvt_pk_bf16_f32 v2, v132, v133
v_cvt_pk_bf16_f32 v3, v134, v135
v_cvt_pk_bf16_f32 v4, v136, v137
v_cvt_pk_bf16_f32 v5, v138, v139
v_cvt_pk_bf16_f32 v6, v140, v141
v_cvt_pk_bf16_f32 v7, v142, v143
s_mov_b32 s40, s28
s_add_u32 s41, s40, s31
buffer_store_dwordx4 v[0:3], v50, s[4:7], s40 offen sc1
buffer_store_dwordx4 v[4:7], v50, s[4:7], s41 offen sc1
v_mov_b64 v[128:129], 0
v_mov_b64 v[130:131], 0
v_mov_b64 v[132:133], 0
v_mov_b64 v[134:135], 0
v_mov_b64 v[136:137], 0
v_mov_b64 v[138:139], 0
v_mov_b64 v[140:141], 0
v_mov_b64 v[142:143], 0
v_pk_mul_f32 v[144:145], v[144:145], s[34:35]
v_pk_mul_f32 v[146:147], v[146:147], s[34:35]
v_pk_mul_f32 v[148:149], v[148:149], s[34:35]
v_pk_mul_f32 v[150:151], v[150:151], s[34:35]
v_pk_mul_f32 v[152:153], v[152:153], s[34:35]
v_pk_mul_f32 v[154:155], v[154:155], s[34:35]
v_pk_mul_f32 v[156:157], v[156:157], s[34:35]
v_pk_mul_f32 v[158:159], v[158:159], s[34:35]
v_cvt_pk_bf16_f32 v8, v144, v145
v_cvt_pk_bf16_f32 v9, v146, v147
v_cvt_pk_bf16_f32 v10, v148, v149
v_cvt_pk_bf16_f32 v11, v150, v151
v_cvt_pk_bf16_f32 v12, v152, v153
v_cvt_pk_bf16_f32 v13, v154, v155
v_cvt_pk_bf16_f32 v14, v156, v157
v_cvt_pk_bf16_f32 v15, v158, v159
s_add_u32 s40, s28, s30
s_add_u32 s28, s28, s29
s_add_u32 s41, s40, s31
buffer_store_dwordx4 v[8:11], v50, s[4:7], s40 offen sc1
buffer_store_dwordx4 v[12:15], v50, s[4:7], s41 offen sc1
v_mov_b64 v[144:145], 0
v_mov_b64 v[146:147], 0
v_mov_b64 v[148:149], 0
v_mov_b64 v[150:151], 0
v_mov_b64 v[152:153], 0
v_mov_b64 v[154:155], 0
v_mov_b64 v[156:157], 0
v_mov_b64 v[158:159], 0
v_pk_mul_f32 v[160:161], v[160:161], s[34:35]
v_pk_mul_f32 v[162:163], v[162:163], s[34:35]
v_pk_mul_f32 v[164:165], v[164:165], s[34:35]
v_pk_mul_f32 v[166:167], v[166:167], s[34:35]
v_pk_mul_f32 v[168:169], v[168:169], s[34:35]
v_pk_mul_f32 v[170:171], v[170:171], s[34:35]
v_pk_mul_f32 v[172:173], v[172:173], s[34:35]
v_pk_mul_f32 v[174:175], v[174:175], s[34:35]
v_cvt_pk_bf16_f32 v0, v160, v161
v_cvt_pk_bf16_f32 v1, v162, v163
v_cvt_pk_bf16_f32 v2, v164, v165
v_cvt_pk_bf16_f32 v3, v166, v167
v_cvt_pk_bf16_f32 v4, v168, v169
v_cvt_pk_bf16_f32 v5, v170, v171
v_cvt_pk_bf16_f32 v6, v172, v173
v_cvt_pk_bf16_f32 v7, v174, v175
s_mov_b32 s40, s28
s_add_u32 s41, s40, s31
buffer_store_dwordx4 v[0:3], v50, s[4:7], s40 offen sc1
buffer_store_dwordx4 v[4:7], v50, s[4:7], s41 offen sc1
v_mov_b64 v[160:161], 0
v_mov_b64 v[162:163], 0
v_mov_b64 v[164:165], 0
v_mov_b64 v[166:167], 0
v_mov_b64 v[168:169], 0
v_mov_b64 v[170:171], 0
v_mov_b64 v[172:173], 0
v_mov_b64 v[174:175], 0
v_pk_mul_f32 v[176:177], v[176:177], s[34:35]
v_pk_mul_f32 v[178:179], v[178:179], s[34:35]
v_pk_mul_f32 v[180:181], v[180:181], s[34:35]
v_pk_mul_f32 v[182:183], v[182:183], s[34:35]
v_pk_mul_f32 v[184:185], v[184:185], s[34:35]
v_pk_mul_f32 v[186:187], v[186:187], s[34:35]
v_pk_mul_f32 v[188:189], v[188:189], s[34:35]
v_pk_mul_f32 v[190:191], v[190:191], s[34:35]
v_cvt_pk_bf16_f32 v8, v176, v177
v_cvt_pk_bf16_f32 v9, v178, v179
v_cvt_pk_bf16_f32 v10, v180, v181
v_cvt_pk_bf16_f32 v11, v182, v183
v_cvt_pk_bf16_f32 v12, v184, v185
v_cvt_pk_bf16_f32 v13, v186, v187
v_cvt_pk_bf16_f32 v14, v188, v189
v_cvt_pk_bf16_f32 v15, v190, v191
s_add_u32 s40, s28, s30
s_add_u32 s28, s28, s29
s_add_u32 s41, s40, s31
buffer_store_dwordx4 v[8:11], v50, s[4:7], s40 offen sc1
buffer_store_dwordx4 v[12:15], v50, s[4:7], s41 offen sc1
v_mov_b64 v[176:177], 0
v_mov_b64 v[178:179], 0
v_mov_b64 v[180:181], 0
v_mov_b64 v[182:183], 0
v_mov_b64 v[184:185], 0
v_mov_b64 v[186:187], 0
v_mov_b64 v[188:189], 0
v_mov_b64 v[190:191], 0
s_cmp_eq_u32 s50, 0
s_cbranch_scc0 Lepe_119
v_pk_mul_f32 v[192:193], v[192:193], s[34:35]
v_pk_mul_f32 v[194:195], v[194:195], s[34:35]
v_pk_mul_f32 v[196:197], v[196:197], s[34:35]
v_pk_mul_f32 v[198:199], v[198:199], s[34:35]
v_pk_mul_f32 v[200:201], v[200:201], s[34:35]
v_pk_mul_f32 v[202:203], v[202:203], s[34:35]
v_pk_mul_f32 v[204:205], v[204:205], s[34:35]
v_pk_mul_f32 v[206:207], v[206:207], s[34:35]
v_cvt_pk_bf16_f32 v0, v192, v193
v_cvt_pk_bf16_f32 v1, v194, v195
v_cvt_pk_bf16_f32 v2, v196, v197
v_cvt_pk_bf16_f32 v3, v198, v199
v_cvt_pk_bf16_f32 v4, v200, v201
v_cvt_pk_bf16_f32 v5, v202, v203
v_cvt_pk_bf16_f32 v6, v204, v205
v_cvt_pk_bf16_f32 v7, v206, v207
s_mov_b32 s40, s28
s_add_u32 s41, s40, s31
buffer_store_dwordx4 v[0:3], v50, s[4:7], s40 offen sc1
buffer_store_dwordx4 v[4:7], v50, s[4:7], s41 offen sc1
v_mov_b64 v[192:193], 0
v_mov_b64 v[194:195], 0
v_mov_b64 v[196:197], 0
v_mov_b64 v[198:199], 0
v_mov_b64 v[200:201], 0
v_mov_b64 v[202:203], 0
v_mov_b64 v[204:205], 0
v_mov_b64 v[206:207], 0
v_pk_mul_f32 v[208:209], v[208:209], s[34:35]
v_pk_mul_f32 v[210:211], v[210:211], s[34:35]
v_pk_mul_f32 v[212:213], v[212:213], s[34:35]
v_pk_mul_f32 v[214:215], v[214:215], s[34:35]
v_pk_mul_f32 v[216:217], v[216:217], s[34:35]
v_pk_mul_f32 v[218:219], v[218:219], s[34:35]
v_pk_mul_f32 v[220:221], v[220:221], s[34:35]
v_pk_mul_f32 v[222:223], v[222:223], s[34:35]
v_cvt_pk_bf16_f32 v8, v208, v209
v_cvt_pk_bf16_f32 v9, v210, v211
v_cvt_pk_bf16_f32 v10, v212, v213
v_cvt_pk_bf16_f32 v11, v214, v215
v_cvt_pk_bf16_f32 v12, v216, v217
v_cvt_pk_bf16_f32 v13, v218, v219
v_cvt_pk_bf16_f32 v14, v220, v221
v_cvt_pk_bf16_f32 v15, v222, v223
s_add_u32 s40, s28, s30
s_add_u32 s28, s28, s29
s_add_u32 s41, s40, s31
buffer_store_dwordx4 v[8:11], v50, s[4:7], s40 offen sc1
buffer_store_dwordx4 v[12:15], v50, s[4:7], s41 offen sc1
v_mov_b64 v[208:209], 0
v_mov_b64 v[210:211], 0
v_mov_b64 v[212:213], 0
v_mov_b64 v[214:215], 0
v_mov_b64 v[216:217], 0
v_mov_b64 v[218:219], 0
v_mov_b64 v[220:221], 0
v_mov_b64 v[222:223], 0
v_pk_mul_f32 v[224:225], v[224:225], s[34:35]
v_pk_mul_f32 v[226:227], v[226:227], s[34:35]
v_pk_mul_f32 v[228:229], v[228:229], s[34:35]
v_pk_mul_f32 v[230:231], v[230:231], s[34:35]
v_pk_mul_f32 v[232:233], v[232:233], s[34:35]
v_pk_mul_f32 v[234:235], v[234:235], s[34:35]
v_pk_mul_f32 v[236:237], v[236:237], s[34:35]
v_pk_mul_f32 v[238:239], v[238:239], s[34:35]
v_cvt_pk_bf16_f32 v0, v224, v225
v_cvt_pk_bf16_f32 v1, v226, v227
v_cvt_pk_bf16_f32 v2, v228, v229
v_cvt_pk_bf16_f32 v3, v230, v231
v_cvt_pk_bf16_f32 v4, v232, v233
v_cvt_pk_bf16_f32 v5, v234, v235
v_cvt_pk_bf16_f32 v6, v236, v237
v_cvt_pk_bf16_f32 v7, v238, v239
s_mov_b32 s40, s28
s_add_u32 s41, s40, s31
buffer_store_dwordx4 v[0:3], v50, s[4:7], s40 offen sc1
buffer_store_dwordx4 v[4:7], v50, s[4:7], s41 offen sc1
v_mov_b64 v[224:225], 0
v_mov_b64 v[226:227], 0
v_mov_b64 v[228:229], 0
v_mov_b64 v[230:231], 0
v_mov_b64 v[232:233], 0
v_mov_b64 v[234:235], 0
v_mov_b64 v[236:237], 0
v_mov_b64 v[238:239], 0
v_pk_mul_f32 v[240:241], v[240:241], s[34:35]
v_pk_mul_f32 v[242:243], v[242:243], s[34:35]
v_pk_mul_f32 v[244:245], v[244:245], s[34:35]
v_pk_mul_f32 v[246:247], v[246:247], s[34:35]
v_pk_mul_f32 v[248:249], v[248:249], s[34:35]
v_pk_mul_f32 v[250:251], v[250:251], s[34:35]
v_pk_mul_f32 v[252:253], v[252:253], s[34:35]
v_pk_mul_f32 v[254:255], v[254:255], s[34:35]
v_cvt_pk_bf16_f32 v8, v240, v241
v_cvt_pk_bf16_f32 v9, v242, v243
v_cvt_pk_bf16_f32 v10, v244, v245
v_cvt_pk_bf16_f32 v11, v246, v247
v_cvt_pk_bf16_f32 v12, v248, v249
v_cvt_pk_bf16_f32 v13, v250, v251
v_cvt_pk_bf16_f32 v14, v252, v253
v_cvt_pk_bf16_f32 v15, v254, v255
s_add_u32 s40, s28, s30
s_add_u32 s28, s28, s29
s_add_u32 s41, s40, s31
buffer_store_dwordx4 v[8:11], v50, s[4:7], s40 offen sc1
buffer_store_dwordx4 v[12:15], v50, s[4:7], s41 offen sc1
v_mov_b64 v[240:241], 0
v_mov_b64 v[242:243], 0
v_mov_b64 v[244:245], 0
v_mov_b64 v[246:247], 0
v_mov_b64 v[248:249], 0
v_mov_b64 v[250:251], 0
v_mov_b64 v[252:253], 0
v_mov_b64 v[254:255], 0
Lepe_119:
s_mov_b32 s46, s44
s_mov_b32 s47, s45
s_cmp_eq_u32 s50, 0
s_cbranch_scc1 Lnu_202
s_waitcnt vmcnt(0)
s_barrier
v_cmp_eq_u32 vcc, 0, v55
s_cbranch_vccz Lck_203
Lpl_204:
v_mov_b32 v55, 12
global_load_dword v55, v55, s[98:99] sc1
s_add_u32 s33, s33, 1
s_cmp_gt_u32 s33, 524288
s_cbranch_scc1 Lexit
s_waitcnt vmcnt(0)
v_cmp_eq_u32 vcc, 0, v55
s_cbranch_vccz Lpe_205
s_sleep 8
s_branch Lpl_204
Lpe_205:
Lck_203:
s_cmp_eq_u32 s36, 0
s_cbranch_scc0 Lsg_206
s_mov_b64 exec, 1
v_mov_b32 v51, s47
buffer_atomic_add v51, off, s[4:7], s46
s_mov_b64 exec, -1
Lsg_206:
s_mov_b32 s47, 0
Lnu_202:
s_nop 0
s_cmp_lt_u32 s27, 65535
s_cbranch_scc1 Ltile_117
s_waitcnt vmcnt(0) lgkmcnt(0)
s_barrier
v_cmp_eq_u32 vcc, 0, v55
s_cbranch_vccz Lck_207
Lpl_208:
v_mov_b32 v55, 12
global_load_dword v55, v55, s[98:99] sc1
s_add_u32 s33, s33, 1
s_cmp_gt_u32 s33, 524288
s_cbranch_scc1 Lexit
s_waitcnt vmcnt(0)
v_cmp_eq_u32 vcc, 0, v55
s_cbranch_vccz Lpe_209
s_sleep 8
s_branch Lpl_208
Lpe_209:
Lck_207:
s_cmp_eq_u32 s36, 0
s_cbranch_scc0 Lsg_210
s_mov_b64 exec, 1
v_mov_b32 v51, s47
buffer_atomic_add v51, off, s[4:7], s46
s_mov_b64 exec, -1
Lsg_210:
s_cmp_eq_u32 s62, 0
s_cbranch_scc1 Ls2_211
s_mov_b32 s62, 100688896
s_cmp_eq_u32 s36, 0
s_cbranch_scc0 Lsg_212
s_mov_b64 exec, 1
v_mov_b32 v51, 1
buffer_atomic_add v51, off, s[4:7], s62
s_mov_b64 exec, -1
Lsg_212:
s_mov_b32 s62, 0
Ls2_211:
v_mov_b32 v0, v63
v_and_b32 v1, 63, v0
v_lshlrev_b32 v50, 4, v1
v_and_b32 v2, 15, v1
v_lshrrev_b32 v3, 5, v1
v_lshlrev_b32 v52, 4, v2
v_lshl_add_u32 v52, v3, 8, v52
v_add_u32 v52, 65536, v52
v_lshrrev_b32 v3, 4, v1
v_lshlrev_b32 v53, 4, v2
v_lshl_add_u32 v53, v3, 9, v53
s_mov_b32 s24, 0xffff
s_mov_b32 s25, 0xffff
s_mov_b32 s26, 0x100
s_mov_b32 s27, 128
s_mov_b32 s40, 100688896
s_mov_b32 s41, 208
s_cmp_eq_u32 s36, 0
s_cbranch_scc0 Lpe_214
Lpl_213:
buffer_load_dword v1, off, s[4:7], s40 sc1
s_add_u32 s33, s33, 1
s_cmp_gt_u32 s33, 524288
s_cbranch_scc1 Lexit
s_waitcnt vmcnt(0)
v_cmp_gt_u32 vcc, s41, v1
s_cbranch_vccz Lpe_214
s_sleep 24
s_branch Lpl_213
Lpe_214:
s_cmp_eq_u32 s36, 0
s_cbranch_scc0 Lnoinv
s_cmp_lt_u32 s100, 32
s_cbranch_scc1 Lnoinv
buffer_inv sc1
s_waitcnt vmcnt(0)
Lnoinv:
s_barrier
s_bfe_u32 s31, s101, 0x80008
s_bfe_u32 s60, s101, 0x80010
s_lshr_b32 s100, s101, 24
s_and_b32 s30, s101, 0xff
s_cmp_eq_u32 s31, 0
s_cbranch_scc1 Lattn
Lbloop:
s_lshr_b32 s20, s30, 3
s_and_b32 s21, s30, 7
s_lshl_b32 s21, s21, 3
s_add_u32 s21, s21, s36
s_lshl_b32 s40, s20, 16
s_lshl_b32 s41, s21, 10
s_add_u32 s41, s41, s40
s_add_u32 s41, s41, 71303168
buffer_load_dwordx4 v[56:59], v50, s[4:7], s41 offen sc1
s_lshl_b32 s41, s21, 7
s_add_u32 s41, s41, 77594624
v_bfe_u32 v1, v50, 4, 5
v_lshlrev_b32 v1, 2, v1
buffer_load_dword v55, v1, s[4:7], s41 offen sc1
s_lshl_b32 s43, s36, 13
s_add_u32 s40, s40, s43
s_add_u32 s40, s40, 73400320
s_add_u32 m0, s43, 0
s_nop 0
buffer_load_dwordx4 v50, s[4:7], s40 offen offset:0 sc1 lds
buffer_load_dwordx4 v50, s[4:7], s40 offen offset:1024 sc1 lds
buffer_load_dwordx4 v50, s[4:7], s40 offen offset:2048 sc1 lds
buffer_load_dwordx4 v50, s[4:7], s40 offen offset:3072 sc1 lds
s_add_u32 s40, s40, 4096
s_add_u32 m0, s43, 4096
s_nop 0
buffer_load_dwordx4 v50, s[4:7], s40 offen offset:0 sc1 lds
buffer_load_dwordx4 v50, s[4:7], s40 offen offset:1024 sc1 lds
buffer_load_dwordx4 v50, s[4:7], s40 offen offset:2048 sc1 lds
buffer_load_dwordx4 v50, s[4:7], s40 offen offset:3072 sc1 lds
s_lshr_b32 s40, s20, 1
s_lshl_b32 s40, s40, 17
s_and_b32 s41, s20, 1
s_lshl_b32 s41, s41, 8
s_add_u32 s40, s40, s41
s_lshl_b32 s41, s36, 14
s_add_u32 s40, s40, s41
s_add_u32 s40, s40, 75497472
s_add_u32 m0, s43, 65536
s_nop 0
buffer_load_dwordx4 v53, s[4:7], s40 offen sc1 lds
s_add_u32 s40, s40, 2048
s_add_u32 m0, s43, 66560
s_nop 0
buffer_load_dwordx4 v53, s[4:7], s40 offen sc1 lds
s_add_u32 s40, s40, 2048
s_add_u32 m0, s43, 67584
s_nop 0
buffer_load_dwordx4 v53, s[4:7], s40 offen sc1 lds
s_add_u32 s40, s40, 2048
s_add_u32 m0, s43, 68608
s_nop 0
buffer_load_dwordx4 v53, s[4:7], s40 offen sc1 lds
s_add_u32 s40, s40, 2048
s_add_u32 m0, s43, 69632
s_nop 0
buffer_load_dwordx4 v53, s[4:7], s40 offen sc1 lds
s_add_u32 s40, s40, 2048
s_add_u32 m0, s43, 70656
s_nop 0
buffer_load_dwordx4 v53, s[4:7], s40 offen sc1 lds
s_add_u32 s40, s40, 2048
s_add_u32 m0, s43, 71680
s_nop 0
buffer_load_dwordx4 v53, s[4:7], s40 offen sc1 lds
s_add_u32 s40, s40, 2048
s_add_u32 m0, s43, 72704
s_nop 0
buffer_load_dwordx4 v53, s[4:7], s40 offen sc1 lds
v_mov_b32 v76, 0x3f803f80
v_mov_b32 v77, 0x3f803f80
v_mov_b32 v78, 0x3f803f80
v_mov_b32 v79, 0x3f803f80
v_mov_b32 v80, 0x3f803f80
v_mov_b32 v81, 0x3f803f80
v_mov_b32 v82, 0x3f803f80
v_mov_b32 v83, 0x3f803f80
v_mov_b32 v84, 0x3f803f80
v_mov_b32 v85, 0x3f803f80
v_mov_b32 v86, 0x3f803f80
v_mov_b32 v87, 0x3f803f80
v_mov_b32 v88, 0x3f803f80
v_mov_b32 v89, 0x3f803f80
v_mov_b32 v90, 0x3f803f80
v_mov_b32 v91, 0x3f803f80
v_mov_b64 v[96:97], 0
v_mov_b64 v[98:99], 0
v_mov_b64 v[100:101], 0
v_mov_b64 v[102:103], 0
v_mov_b64 v[104:105], 0
v_mov_b64 v[106:107], 0
v_mov_b64 v[108:109], 0
v_mov_b64 v[110:111], 0
s_mov_b32 s23, 0
s_waitcnt vmcnt(0)
s_barrier
Lb2s_215:
v_mov_b64 v[192:193], 0
v_mov_b64 v[194:195], 0
v_mov_b64 v[196:197], 0
v_mov_b64 v[198:199], 0
v_mov_b64 v[200:201], 0
v_mov_b64 v[202:203], 0
v_mov_b64 v[204:205], 0
v_mov_b64 v[206:207], 0
v_mov_b32 v51, v50
v_mov_b32 v2, v52
ds_read_b128 v[60:63], v51 offset:0
ds_read_b128 v[64:67], v51 offset:1024
ds_read_b128 v[68:71], v51 offset:2048
ds_read_b128 v[72:75], v51 offset:3072
s_mov_b64 exec, s[24:25]
ds_read_b128 v[76:79], v2 offset:0
ds_read_b128 v[80:83], v2 offset:512
s_mov_b64 exec, -1
s_mov_b64 exec, s[24:25]
ds_read_b128 v[84:87], v2 offset:1024
ds_read_b128 v[88:91], v2 offset:1536
s_mov_b64 exec, -1
s_waitcnt lgkmcnt(6)
v_mfma_f32_32x32x16_bf16 v[112:127], v[60:63], v[56:59], v[96:111]
v_mfma_f32_32x32x16_bf16 v[128:143], v[64:67], v[56:59], v[96:111]
ds_read_b128 v[60:63], v51 offset:4096
ds_read_b128 v[64:67], v51 offset:5120
s_mov_b32 s22, 0
Lb2_217:
s_waitcnt lgkmcnt(3)
v_mfma_f32_32x32x16_bf16 v[144:159], v[68:71], v[56:59], v[96:111]
ds_read_b128 v[68:71], v51 offset:6144
v_exp_f32 v112, v112
v_exp_f32 v113, v113
v_exp_f32 v114, v114
v_exp_f32 v115, v115
v_exp_f32 v116, v116
v_exp_f32 v117, v117
v_exp_f32 v118, v118
v_exp_f32 v119, v119
v_exp_f32 v120, v120
v_cvt_pk_bf16_f32 v176, v112, v113
v_cvt_pk_bf16_f32 v177, v114, v115
v_cvt_pk_bf16_f32 v178, v116, v117
v_cvt_pk_bf16_f32 v179, v118, v119
v_exp_f32 v121, v121
v_exp_f32 v122, v122
v_mfma_f32_32x32x16_bf16 v[192:207], v[76:79], v[176:179], v[192:207]
v_exp_f32 v123, v123
v_exp_f32 v124, v124
v_exp_f32 v125, v125
v_exp_f32 v126, v126
v_exp_f32 v127, v127
v_cvt_pk_bf16_f32 v180, v120, v121
v_cvt_pk_bf16_f32 v181, v122, v123
v_cvt_pk_bf16_f32 v182, v124, v125
v_cvt_pk_bf16_f32 v183, v126, v127
s_nop 1
v_mfma_f32_32x32x16_bf16 v[192:207], v[80:83], v[180:183], v[192:207]
s_mov_b64 exec, s[24:25]
ds_read_b128 v[76:79], v2 offset:2048
ds_read_b128 v[80:83], v2 offset:2560
s_mov_b64 exec, -1
s_waitcnt lgkmcnt(3)
v_mfma_f32_32x32x16_bf16 v[160:175], v[72:75], v[56:59], v[96:111]
ds_read_b128 v[72:75], v51 offset:7168
v_exp_f32 v128, v128
v_exp_f32 v129, v129
v_exp_f32 v130, v130
v_exp_f32 v131, v131
v_exp_f32 v132, v132
v_exp_f32 v133, v133
v_exp_f32 v134, v134
v_exp_f32 v135, v135
v_exp_f32 v136, v136
v_cvt_pk_bf16_f32 v184, v128, v129
v_cvt_pk_bf16_f32 v185, v130, v131
v_cvt_pk_bf16_f32 v186, v132, v133
v_cvt_pk_bf16_f32 v187, v134, v135
v_exp_f32 v137, v137
v_exp_f32 v138, v138
v_mfma_f32_32x32x16_bf16 v[192:207], v[84:87], v[184:187], v[192:207]
v_exp_f32 v139, v139
v_exp_f32 v140, v140
v_exp_f32 v141, v141
v_exp_f32 v142, v142
v_exp_f32 v143, v143
v_cvt_pk_bf16_f32 v188, v136, v137
v_cvt_pk_bf16_f32 v189, v138, v139
v_cvt_pk_bf16_f32 v190, v140, v141
v_cvt_pk_bf16_f32 v191, v142, v143
s_nop 1
v_mfma_f32_32x32x16_bf16 v[192:207], v[88:91], v[188:191], v[192:207]
s_mov_b64 exec, s[24:25]
ds_read_b128 v[84:87], v2 offset:3072
ds_read_b128 v[88:91], v2 offset:3584
s_mov_b64 exec, -1
s_waitcnt lgkmcnt(3)
v_mfma_f32_32x32x16_bf16 v[112:127], v[60:63], v[56:59], v[96:111]
ds_read_b128 v[60:63], v51 offset:8192
v_exp_f32 v144, v144
v_exp_f32 v145, v145
v_exp_f32 v146, v146
v_exp_f32 v147, v147
v_exp_f32 v148, v148
v_exp_f32 v149, v149
v_exp_f32 v150, v150
v_exp_f32 v151, v151
v_exp_f32 v152, v152
v_cvt_pk_bf16_f32 v176, v144, v145
v_cvt_pk_bf16_f32 v177, v146, v147
v_cvt_pk_bf16_f32 v178, v148, v149
v_cvt_pk_bf16_f32 v179, v150, v151
v_exp_f32 v153, v153
v_exp_f32 v154, v154
v_mfma_f32_32x32x16_bf16 v[192:207], v[76:79], v[176:179], v[192:207]
v_exp_f32 v155, v155
v_exp_f32 v156, v156
v_exp_f32 v157, v157
v_exp_f32 v158, v158
v_exp_f32 v159, v159
v_cvt_pk_bf16_f32 v180, v152, v153
v_cvt_pk_bf16_f32 v181, v154, v155
v_cvt_pk_bf16_f32 v182, v156, v157
v_cvt_pk_bf16_f32 v183, v158, v159
s_nop 1
v_mfma_f32_32x32x16_bf16 v[192:207], v[80:83], v[180:183], v[192:207]
s_mov_b64 exec, s[24:25]
ds_read_b128 v[76:79], v2 offset:4096
ds_read_b128 v[80:83], v2 offset:4608
s_mov_b64 exec, -1
s_waitcnt lgkmcnt(3)
v_mfma_f32_32x32x16_bf16 v[128:143], v[64:67], v[56:59], v[96:111]
ds_read_b128 v[64:67], v51 offset:9216
v_exp_f32 v160, v160
v_exp_f32 v161, v161
v_exp_f32 v162, v162
v_exp_f32 v163, v163
v_exp_f32 v164, v164
v_exp_f32 v165, v165
v_exp_f32 v166, v166
v_exp_f32 v167, v167
v_exp_f32 v168, v168
v_cvt_pk_bf16_f32 v184, v160, v161
v_cvt_pk_bf16_f32 v185, v162, v163
v_cvt_pk_bf16_f32 v186, v164, v165
v_cvt_pk_bf16_f32 v187, v166, v167
v_exp_f32 v169, v169
v_exp_f32 v170, v170
v_mfma_f32_32x32x16_bf16 v[192:207], v[84:87], v[184:187], v[192:207]
v_exp_f32 v171, v171
v_exp_f32 v172, v172
v_exp_f32 v173, v173
v_exp_f32 v174, v174
v_exp_f32 v175, v175
v_cvt_pk_bf16_f32 v188, v168, v169
v_cvt_pk_bf16_f32 v189, v170, v171
v_cvt_pk_bf16_f32 v190, v172, v173
v_cvt_pk_bf16_f32 v191, v174, v175
s_nop 1
v_mfma_f32_32x32x16_bf16 v[192:207], v[88:91], v[188:191], v[192:207]
s_mov_b64 exec, s[24:25]
ds_read_b128 v[84:87], v2 offset:5120
ds_read_b128 v[88:91], v2 offset:5632
s_mov_b64 exec, -1
v_add_u32 v51, 4096, v51
v_add_u32 v2, 4096, v2
s_add_u32 s22, s22, 1
s_cmp_lt_u32 s22, 16
s_cbranch_scc1 Lb2_217
s_waitcnt lgkmcnt(0)
s_nop 1
v_frexp_exp_i32_f32 v1, v200
v_cmp_class_f32 vcc, v200, s26
v_add_u32 v1, 64, v1
v_cmp_gt_u32 s[28:29], s27, v1
s_and_b64 vcc, vcc, s[28:29]
s_cmp_eq_u64 vcc, -1
s_cbranch_scc1 Lb2g_216
s_cmp_eq_u32 s23, 0
s_cbranch_scc0 Lb2g_216
s_mov_b32 s23, 1
v_mov_b32 v54, 0xff800000
v_mov_b32 v51, v50
ds_read_b128 v[60:63], v51 offset:0
ds_read_b128 v[64:67], v51 offset:1024
ds_read_b128 v[68:71], v51 offset:2048
ds_read_b128 v[72:75], v51 offset:3072
s_mov_b32 s22, 0
v_mov_b32 v144, v54
v_mov_b32 v145, v54
v_mov_b32 v146, v54
v_mov_b32 v147, v54
v_mov_b32 v148, v54
v_mov_b32 v149, v54
v_mov_b32 v150, v54
v_mov_b32 v151, v54
v_mov_b32 v152, v54
v_mov_b32 v153, v54
v_mov_b32 v154, v54
v_mov_b32 v155, v54
v_mov_b32 v156, v54
v_mov_b32 v157, v54
v_mov_b32 v158, v54
v_mov_b32 v159, v54
v_mov_b32 v160, v54
v_mov_b32 v161, v54
v_mov_b32 v162, v54
v_mov_b32 v163, v54
v_mov_b32 v164, v54
v_mov_b32 v165, v54
v_mov_b32 v166, v54
v_mov_b32 v167, v54
v_mov_b32 v168, v54
v_mov_b32 v169, v54
v_mov_b32 v170, v54
v_mov_b32 v171, v54
v_mov_b32 v172, v54
v_mov_b32 v173, v54
v_mov_b32 v174, v54
v_mov_b32 v175, v54
Lb1_218:
s_waitcnt lgkmcnt(3)
v_mfma_f32_32x32x16_bf16 v[112:127], v[60:63], v[56:59], 0
ds_read_b128 v[60:63], v51 offset:4096
v_max3_f32 v54, v54, v144, v145
v_max3_f32 v54, v54, v146, v147
v_max3_f32 v54, v54, v148, v149
v_max3_f32 v54, v54, v150, v151
v_max3_f32 v54, v54, v152, v153
v_max3_f32 v54, v54, v154, v155
v_max3_f32 v54, v54, v156, v157
v_max3_f32 v54, v54, v158, v159
s_waitcnt lgkmcnt(3)
v_mfma_f32_32x32x16_bf16 v[128:143], v[64:67], v[56:59], 0
ds_read_b128 v[64:67], v51 offset:5120
v_max3_f32 v54, v54, v160, v161
v_max3_f32 v54, v54, v162, v163
v_max3_f32 v54, v54, v164, v165
v_max3_f32 v54, v54, v166, v167
v_max3_f32 v54, v54, v168, v169
v_max3_f32 v54, v54, v170, v171
v_max3_f32 v54, v54, v172, v173
v_max3_f32 v54, v54, v174, v175
s_waitcnt lgkmcnt(3)
v_mfma_f32_32x32x16_bf16 v[144:159], v[68:71], v[56:59], 0
ds_read_b128 v[68:71], v51 offset:6144
v_max3_f32 v54, v54, v112, v113
v_max3_f32 v54, v54, v114, v115
v_max3_f32 v54, v54, v116, v117
v_max3_f32 v54, v54, v118, v119
v_max3_f32 v54, v54, v120, v121
v_max3_f32 v54, v54, v122, v123
v_max3_f32 v54, v54, v124, v125
v_max3_f32 v54, v54, v126, v127
s_waitcnt lgkmcnt(3)
v_mfma_f32_32x32x16_bf16 v[160:175], v[72:75], v[56:59], 0
ds_read_b128 v[72:75], v51 offset:7168
v_max3_f32 v54, v54, v128, v129
v_max3_f32 v54, v54, v130, v131
v_max3_f32 v54, v54, v132, v133
v_max3_f32 v54, v54, v134, v135
v_max3_f32 v54, v54, v136, v137
v_max3_f32 v54, v54, v138, v139
v_max3_f32 v54, v54, v140, v141
v_max3_f32 v54, v54, v142, v143
v_add_u32 v51, 4096, v51
s_add_u32 s22, s22, 1
s_cmp_lt_u32 s22, 16
s_cbranch_scc1 Lb1_218
v_max3_f32 v54, v54, v144, v145
v_max3_f32 v54, v54, v146, v147
v_max3_f32 v54, v54, v148, v149
v_max3_f32 v54, v54, v150, v151
v_max3_f32 v54, v54, v152, v153
v_max3_f32 v54, v54, v154, v155
v_max3_f32 v54, v54, v156, v157
v_max3_f32 v54, v54, v158, v159
v_max3_f32 v54, v54, v160, v161
v_max3_f32 v54, v54, v162, v163
v_max3_f32 v54, v54, v164, v165
v_max3_f32 v54, v54, v166, v167
v_max3_f32 v54, v54, v168, v169
v_max3_f32 v54, v54, v170, v171
v_max3_f32 v54, v54, v172, v173
v_max3_f32 v54, v54, v174, v175
v_mov_b32 v1, v54
s_waitcnt lgkmcnt(0)
s_nop 0
v_permlane32_swap_b32 v54, v1
v_max_f32 v54, v54, v1
v_sub_f32 v96, 0, v54
v_sub_f32 v97, 0, v54
v_sub_f32 v98, 0, v54
v_sub_f32 v99, 0, v54
v_sub_f32 v100, 0, v54
v_sub_f32 v101, 0, v54
v_sub_f32 v102, 0, v54
v_sub_f32 v103, 0, v54
v_sub_f32 v104, 0, v54
v_sub_f32 v105, 0, v54
v_sub_f32 v106, 0, v54
v_sub_f32 v107, 0, v54
v_sub_f32 v108, 0, v54
v_sub_f32 v109, 0, v54
v_sub_f32 v110, 0, v54
v_sub_f32 v111, 0, v54
s_nop 1
s_branch Lb2s_215
Lb2g_216:
v_sub_f32 v55, 1.0, v55
s_mul_i32 s40, s21, 294912
s_lshl_b32 s41, s20, 10
s_add_u32 s40, s40, s41
s_add_u32 s40, s40, 79953920
v_rcp_f32 v1, v200
s_nop 0
v_mul_f32 v1, v1, v55
v_mul_f32 v192, v192, v1
v_mul_f32 v193, v193, v1
v_mul_f32 v194, v194, v1
v_mul_f32 v195, v195, v1
v_mul_f32 v196, v196, v1
v_mul_f32 v197, v197, v1
v_mul_f32 v198, v198, v1
v_mul_f32 v199, v199, v1
v_cvt_pk_bf16_f32 v4, v192, v193
v_cvt_pk_bf16_f32 v5, v194, v195
v_cvt_pk_bf16_f32 v6, v196, v197
v_cvt_pk_bf16_f32 v7, v198, v199
buffer_store_dwordx4 v[4:7], v50, s[4:7], s40 offen sc1
s_waitcnt vmcnt(0) lgkmcnt(0)
s_barrier
s_and_b32 s40, s30, 7
s_lshl_b32 s40, s40, 7
s_add_u32 s40, s40, 100687872
s_cmp_eq_u32 s36, 0
s_cbranch_scc0 Lsg_219
s_mov_b64 exec, 1
v_mov_b32 v1, 1
buffer_atomic_add v1, off, s[4:7], s40
s_mov_b64 exec, -1
Lsg_219:
s_sub_u32 s31, s31, 1
s_or_b32 s30, s30, 7
s_add_u32 s30, s30, 1
s_sub_u32 s30, s30, s31
s_cmp_eq_u32 s31, 0
s_cbranch_scc0 Lbloop
s_cmp_eq_u32 s60, 1
s_cbranch_scc1 Lfinal
Lattn:
v_and_b32 v1, 63, v0
v_lshlrev_b32 v8, 4, v1
v_lshrrev_b32 v2, 5, v1
v_and_b32 v3, 7, v1
v_lshlrev_b32 v9, 8, v2
v_lshl_add_u32 v10, v3, 4, v9
v_add_u32 v9, 128, v10
v_bfe_u32 v3, v1, 4, 1
v_lshl_add_u32 v10, v3, 7, v10
v_and_b32 v3, 8, v1
v_add_u32 v10, v10, v3
v_and_b32 v3, 31, v1
v_lshlrev_b32 v11, 2, v3
v_lshlrev_b32 v2, 2, v2
v_sub_u32 v3, v3, v2
v_mov_b32 v13, 0xff800000
v_cmp_le_i32 s[64:65], 0, v3
v_cmp_le_i32 s[66:67], 1, v3
v_cmp_le_i32 s[68:69], 2, v3
v_cmp_le_i32 s[70:71], 3, v3
v_cmp_le_i32 s[72:73], 8, v3
v_cmp_le_i32 s[74:75], 9, v3
v_cmp_le_i32 s[76:77], 10, v3
v_cmp_le_i32 s[78:79], 11, v3
v_cmp_le_i32 s[80:81], 16, v3
v_cmp_le_i32 s[82:83], 17, v3
v_cmp_le_i32 s[84:85], 18, v3
v_cmp_le_i32 s[86:87], 19, v3
v_cmp_le_i32 s[88:89], 24, v3
v_cmp_le_i32 s[90:91], 25, v3
v_cmp_le_i32 s[92:93], 26, v3
v_cmp_le_i32 s[94:95], 27, v3
s_lshl_b32 s20, s100, 3
s_add_u32 s20, s20, s36
s_mov_b32 s26, 4
s_mov_b32 s27, 8
s_mov_b32 s28, 256
s_mov_b32 s29, 1920
s_cmp_eq_u32 s60, 0
s_cbranch_scc1 Laloop
s_mov_b32 s26, 1
s_mov_b32 s27, 2
s_lshl_b32 s20, s100, 1
s_and_b32 s40, s36, 1
s_add_u32 s20, s20, s40
s_add_u32 s20, s20, 1920
s_mov_b32 s28, 128
s_mov_b32 s29, 2048
Laloop:
s_and_b32 s21, s20, 31
s_lshl_b32 s22, s21, 7
s_add_u32 s22, s22, 100696064
s_lshr_b32 s21, s21, 1
s_lshl_b32 s21, s21, 7
s_add_u32 s21, s21, 100663296
s_lshr_b32 s23, s20, 8
s_lshl_b32 s23, s23, 11
s_add_u32 s23, s23, s21
s_lshr_b32 s24, s20, 5
s_cmp_lt_u32 s36, s27
s_cbranch_scc1 Lawork
s_barrier
s_branch Lajoin
Lawork:
Lpl_220:
buffer_load_dword v1, off, s[4:7], s23 sc1
s_add_u32 s33, s33, 1
s_cmp_gt_u32 s33, 524288
s_cbranch_scc1 Lexit
s_waitcnt vmcnt(0)
v_cmp_gt_u32 vcc, 20, v1
s_cbranch_vccz Lpe_221
s_sleep 32
s_branch Lpl_220
Lpe_221:
s_lshl_b32 s40, s20, 13
s_add_u32 s41, s40, 0
buffer_load_dwordx4 v[48:51], v8, s[4:7], s41 offen offset:0 sc1
buffer_load_dwordx4 v[52:55], v8, s[4:7], s41 offen offset:1024 sc1
buffer_load_dwordx4 v[56:59], v8, s[4:7], s41 offen offset:2048 sc1
buffer_load_dwordx4 v[60:63], v8, s[4:7], s41 offen offset:3072 sc1
s_add_u32 s41, s40, 4096
buffer_load_dwordx4 v[64:67], v8, s[4:7], s41 offen offset:0 sc1
buffer_load_dwordx4 v[68:71], v8, s[4:7], s41 offen offset:1024 sc1
buffer_load_dwordx4 v[72:75], v8, s[4:7], s41 offen offset:2048 sc1
buffer_load_dwordx4 v[76:79], v8, s[4:7], s41 offen offset:3072 sc1
s_add_u32 s41, s40, 33554432
buffer_load_dwordx4 v[16:19], v8, s[4:7], s41 offen offset:0 sc1
buffer_load_dwordx4 v[20:23], v8, s[4:7], s41 offen offset:1024 sc1
buffer_load_dwordx4 v[24:27], v8, s[4:7], s41 offen offset:2048 sc1
buffer_load_dwordx4 v[28:31], v8, s[4:7], s41 offen offset:3072 sc1
s_add_u32 s41, s40, 33558528
buffer_load_dwordx4 v[32:35], v8, s[4:7], s41 offen offset:0 sc1
buffer_load_dwordx4 v[36:39], v8, s[4:7], s41 offen offset:1024 sc1
buffer_load_dwordx4 v[40:43], v8, s[4:7], s41 offen offset:2048 sc1
buffer_load_dwordx4 v[44:47], v8, s[4:7], s41 offen offset:3072 sc1
s_add_u32 s41, s40, 16777216
buffer_load_dwordx4 v[112:115], v8, s[4:7], s41 offen offset:0 sc1
buffer_load_dwordx4 v[116:119], v8, s[4:7], s41 offen offset:1024 sc1
buffer_load_dwordx4 v[120:123], v8, s[4:7], s41 offen offset:2048 sc1
buffer_load_dwordx4 v[124:127], v8, s[4:7], s41 offen offset:3072 sc1
s_add_u32 s41, s40, 16781312
buffer_load_dwordx4 v[128:131], v8, s[4:7], s41 offen offset:0 sc1
buffer_load_dwordx4 v[132:135], v8, s[4:7], s41 offen offset:1024 sc1
buffer_load_dwordx4 v[136:139], v8, s[4:7], s41 offen offset:2048 sc1
buffer_load_dwordx4 v[140:143], v8, s[4:7], s41 offen offset:3072 sc1
s_lshr_b32 s41, s20, 5
s_lshl_b32 s41, s41, 7
s_add_u32 s41, s41, 77594624
buffer_load_dword v12, v11, s[4:7], s41 offen sc1
s_waitcnt vmcnt(0)
v_mfma_f32_32x32x16_bf16 v[160:175], v[48:51], v[16:19], 0
v_mfma_f32_32x32x16_bf16 v[160:175], v[52:55], v[20:23], v[160:175]
v_mfma_f32_32x32x16_bf16 v[160:175], v[56:59], v[24:27], v[160:175]
v_mfma_f32_32x32x16_bf16 v[160:175], v[60:63], v[28:31], v[160:175]
v_mfma_f32_32x32x16_bf16 v[160:175], v[64:67], v[32:35], v[160:175]
v_mfma_f32_32x32x16_bf16 v[160:175], v[68:71], v[36:39], v[160:175]
v_mfma_f32_32x32x16_bf16 v[160:175], v[72:75], v[40:43], v[160:175]
v_mfma_f32_32x32x16_bf16 v[160:175], v[76:79], v[44:47], v[160:175]
s_nop 11
v_cndmask_b32 v160, v13, v160, s[64:65]
v_cndmask_b32 v161, v13, v161, s[66:67]
v_cndmask_b32 v162, v13, v162, s[68:69]
v_cndmask_b32 v163, v13, v163, s[70:71]
v_cndmask_b32 v164, v13, v164, s[72:73]
v_cndmask_b32 v165, v13, v165, s[74:75]
v_cndmask_b32 v166, v13, v166, s[76:77]
v_cndmask_b32 v167, v13, v167, s[78:79]
v_cndmask_b32 v168, v13, v168, s[80:81]
v_cndmask_b32 v169, v13, v169, s[82:83]
v_cndmask_b32 v170, v13, v170, s[84:85]
v_cndmask_b32 v171, v13, v171, s[86:87]
v_cndmask_b32 v172, v13, v172, s[88:89]
v_cndmask_b32 v173, v13, v173, s[90:91]
v_cndmask_b32 v174, v13, v174, s[92:93]
v_cndmask_b32 v175, v13, v175, s[94:95]
v_max_f32 v14, v160, v161
v_max3_f32 v14, v14, v162, v163
v_max3_f32 v14, v14, v164, v165
v_max3_f32 v14, v14, v166, v167
v_max3_f32 v14, v14, v168, v169
v_max3_f32 v14, v14, v170, v171
v_max3_f32 v14, v14, v172, v173
v_max3_f32 v14, v14, v174, v175
s_sub_u32 s25, s24, 3
s_max_i32 s25, s25, 0
s_cmp_eq_u32 s36, 0
s_cbranch_scc0 Lpe_223
Lpl_222:
buffer_load_dwordx4 v[4:7], off, s[4:7], s22 sc1
s_add_u32 s33, s33, 1
s_cmp_gt_u32 s33, 524288
s_cbranch_scc1 Lexit
s_waitcnt vmcnt(0)
v_min3_u32 v4, v4, v5, v6
v_min_u32 v4, v4, v7
v_cmp_gt_u32 vcc, s25, v4
s_cbranch_vccz Lpe_223
s_sleep 64
s_branch Lpl_222
Lpe_223:
s_barrier
s_sub_u32 s25, s24, 2
s_cmp_ge_u32 s24, 63
s_cselect_b32 s25, s25, s24
Lpl_224:
buffer_load_dwordx4 v[4:7], off, s[4:7], s22 sc1
s_add_u32 s33, s33, 1
s_cmp_gt_u32 s33, 524288
s_cbranch_scc1 Lexit
s_waitcnt vmcnt(0)
v_min3_u32 v4, v4, v5, v6
v_min_u32 v4, v4, v7
v_cmp_ge_u32 vcc, s25, v4
s_cbranch_vccz Lpe_225
s_sleep 3
s_branch Lpl_224
Lpe_225:
Laget:
s_lshl_b32 s40, s20, 12
s_add_u32 s41, s40, 50331648
buffer_load_dwordx4 v[80:83], v9, s[4:7], s41 offen offset:0 sc1
buffer_load_dwordx4 v[84:87], v9, s[4:7], s41 offen offset:512 sc1
buffer_load_dwordx4 v[88:91], v9, s[4:7], s41 offen offset:1024 sc1
buffer_load_dwordx4 v[92:95], v9, s[4:7], s41 offen offset:1536 sc1
buffer_load_dwordx4 v[96:99], v9, s[4:7], s41 offen offset:2048 sc1
buffer_load_dwordx4 v[100:103], v9, s[4:7], s41 offen offset:2560 sc1
buffer_load_dwordx4 v[104:107], v9, s[4:7], s41 offen offset:3072 sc1
buffer_load_dwordx4 v[108:111], v9, s[4:7], s41 offen offset:3584 sc1
s_add_u32 s41, s40, 58720256
buffer_load_dwordx2 v[144:145], v10, s[4:7], s41 offen offset:0 sc1
buffer_load_dwordx2 v[146:147], v10, s[4:7], s41 offen offset:512 sc1
buffer_load_dwordx2 v[148:149], v10, s[4:7], s41 offen offset:1024 sc1
buffer_load_dwordx2 v[150:151], v10, s[4:7], s41 offen offset:1536 sc1
buffer_load_dwordx2 v[152:153], v10, s[4:7], s41 offen offset:2048 sc1
buffer_load_dwordx2 v[154:155], v10, s[4:7], s41 offen offset:2560 sc1
buffer_load_dwordx2 v[156:157], v10, s[4:7], s41 offen offset:3072 sc1
buffer_load_dwordx2 v[158:159], v10, s[4:7], s41 offen offset:3584 sc1
s_cmp_ge_u32 s24, 63
s_cbranch_scc0 Lagot
s_add_u32 s33, s33, 1
s_cmp_gt_u32 s33, 524288
s_cbranch_scc1 Lexit
s_waitcnt vmcnt(8)
v_max_u32 v4, v80, v81
v_max3_u32 v4, v4, v82, v83
v_max3_u32 v4, v4, v84, v85
v_max3_u32 v4, v4, v86, v87
v_max3_u32 v4, v4, v88, v89
v_max3_u32 v4, v4, v90, v91
v_max3_u32 v4, v4, v92, v93
v_max3_u32 v4, v4, v94, v95
v_max3_u32 v4, v4, v96, v97
v_max3_u32 v4, v4, v98, v99
v_max3_u32 v4, v4, v100, v101
v_max3_u32 v4, v4, v102, v103
v_max3_u32 v4, v4, v104, v105
v_max3_u32 v4, v4, v106, v107
v_max3_u32 v4, v4, v108, v109
v_max3_u32 v4, v4, v110, v111
s_waitcnt vmcnt(0)
v_max3_u32 v4, v4, v144, v145
v_max3_u32 v4, v4, v146, v147
v_max3_u32 v4, v4, v148, v149
v_max3_u32 v4, v4, v150, v151
v_max3_u32 v4, v4, v152, v153
v_max3_u32 v4, v4, v154, v155
v_max3_u32 v4, v4, v156, v157
v_max3_u32 v4, v4, v158, v159
v_cmp_eq_u32 vcc, -1, v4
s_cbranch_vccnz Laget
Lagot:
s_waitcnt vmcnt(15)
v_mfma_f32_32x32x16_bf16 v[176:191], v[80:83], v[16:19], 0
s_waitcnt vmcnt(14)
v_mfma_f32_32x32x16_bf16 v[176:191], v[84:87], v[20:23], v[176:191]
s_waitcnt vmcnt(13)
v_mfma_f32_32x32x16_bf16 v[176:191], v[88:91], v[24:27], v[176:191]
s_waitcnt vmcnt(12)
v_mfma_f32_32x32x16_bf16 v[176:191], v[92:95], v[28:31], v[176:191]
s_waitcnt vmcnt(11)
v_mfma_f32_32x32x16_bf16 v[176:191], v[96:99], v[32:35], v[176:191]
s_waitcnt vmcnt(10)
v_mfma_f32_32x32x16_bf16 v[176:191], v[100:103], v[36:39], v[176:191]
s_waitcnt vmcnt(9)
v_mfma_f32_32x32x16_bf16 v[176:191], v[104:107], v[40:43], v[176:191]
s_waitcnt vmcnt(8)
v_mfma_f32_32x32x16_bf16 v[176:191], v[108:111], v[44:47], v[176:191]
v_mov_b32 v1, v14
s_nop 10
v_max3_f32 v1, v1, v176, v177
v_max3_f32 v1, v1, v178, v179
v_mov_b32 v2, v1
s_nop 1
v_permlane32_swap_b32 v1, v2
v_max_f32 v1, v1, v2
v_sub_f32 v160, v160, v1
v_sub_f32 v161, v161, v1
v_sub_f32 v162, v162, v1
v_sub_f32 v163, v163, v1
v_sub_f32 v164, v164, v1
v_sub_f32 v165, v165, v1
v_sub_f32 v166, v166, v1
v_sub_f32 v167, v167, v1
v_sub_f32 v168, v168, v1
v_sub_f32 v169, v169, v1
v_sub_f32 v170, v170, v1
v_sub_f32 v171, v171, v1
v_sub_f32 v172, v172, v1
v_sub_f32 v173, v173, v1
v_sub_f32 v174, v174, v1
v_sub_f32 v175, v175, v1
v_sub_f32 v176, v176, v1
v_sub_f32 v177, v177, v1
v_sub_f32 v178, v178, v1
v_sub_f32 v179, v179, v1
v_exp_f32 v160, v160
v_exp_f32 v161, v161
v_exp_f32 v162, v162
v_exp_f32 v163, v163
v_exp_f32 v164, v164
v_exp_f32 v165, v165
v_exp_f32 v166, v166
v_exp_f32 v167, v167
v_exp_f32 v168, v168
v_exp_f32 v169, v169
v_exp_f32 v170, v170
v_exp_f32 v171, v171
v_exp_f32 v172, v172
v_exp_f32 v173, v173
v_exp_f32 v174, v174
v_exp_f32 v175, v175
v_exp_f32 v176, v176
v_exp_f32 v177, v177
v_exp_f32 v178, v178
v_exp_f32 v179, v179
v_cvt_pk_bf16_f32 v192, v160, v161
v_cvt_pk_bf16_f32 v193, v162, v163
v_cvt_pk_bf16_f32 v194, v164, v165
v_cvt_pk_bf16_f32 v195, v166, v167
v_cvt_pk_bf16_f32 v196, v168, v169
v_cvt_pk_bf16_f32 v197, v170, v171
v_cvt_pk_bf16_f32 v198, v172, v173
v_cvt_pk_bf16_f32 v199, v174, v175
v_cvt_pk_bf16_f32 v200, v176, v177
v_cvt_pk_bf16_f32 v201, v178, v179
v_cvt_pk_bf16_f32 v202, v176, v177
v_cvt_pk_bf16_f32 v203, v178, v179
s_waitcnt vmcnt(0)
v_mfma_f32_32x32x16_bf16 v[16:31], v[112:115], v[192:195], 0
v_mfma_f32_32x32x16_bf16 v[16:31], v[116:119], v[196:199], v[16:31]
v_mfma_f32_32x32x16_bf16 v[16:31], v[144:147], v[200:203], v[16:31]
v_pk_add_f32 v[2:3], v[160:161], v[162:163]
v_pk_add_f32 v[2:3], v[2:3], v[164:165]
v_pk_add_f32 v[2:3], v[2:3], v[166:167]
v_pk_add_f32 v[2:3], v[2:3], v[168:169]
v_pk_add_f32 v[2:3], v[2:3], v[170:171]
v_pk_add_f32 v[2:3], v[2:3], v[172:173]
v_pk_add_f32 v[2:3], v[2:3], v[174:175]
v_pk_add_f32 v[2:3], v[2:3], v[176:177]
v_pk_add_f32 v[2:3], v[2:3], v[178:179]
v_add_f32 v2, v2, v3
v_mov_b32 v3, v2
s_nop 1
v_permlane32_swap_b32 v2, v3
v_add_f32 v2, v2, v3
v_rcp_f32 v2, v2
s_nop 0
v_mul_f32 v2, v2, v12
v_mfma_f32_32x32x16_bf16 v[32:47], v[120:123], v[192:195], 0
v_mfma_f32_32x32x16_bf16 v[32:47], v[124:127], v[196:199], v[32:47]
v_mfma_f32_32x32x16_bf16 v[32:47], v[148:151], v[200:203], v[32:47]
v_mfma_f32_32x32x16_bf16 v[48:63], v[128:131], v[192:195], 0
v_mfma_f32_32x32x16_bf16 v[48:63], v[132:135], v[196:199], v[48:63]
v_mfma_f32_32x32x16_bf16 v[48:63], v[152:155], v[200:203], v[48:63]
v_mfma_f32_32x32x16_bf16 v[64:79], v[136:139], v[192:195], 0
v_mfma_f32_32x32x16_bf16 v[64:79], v[140:143], v[196:199], v[64:79]
v_mfma_f32_32x32x16_bf16 v[64:79], v[156:159], v[200:203], v[64:79]
s_lshr_b32 s40, s20, 5
s_mul_i32 s40, s40, 294912
s_and_b32 s41, s20, 31
s_lshl_b32 s41, s41, 13
s_add_u32 s40, s40, s41
s_add_u32 s40, s40, 79691776
s_add_u32 s41, s40, 4096
v_pk_mul_f32 v[16:17], v[16:17], v[2:3] op_sel_hi:[1,0]
v_pk_mul_f32 v[18:19], v[18:19], v[2:3] op_sel_hi:[1,0]
v_pk_mul_f32 v[20:21], v[20:21], v[2:3] op_sel_hi:[1,0]
v_pk_mul_f32 v[22:23], v[22:23], v[2:3] op_sel_hi:[1,0]
v_pk_mul_f32 v[24:25], v[24:25], v[2:3] op_sel_hi:[1,0]
v_pk_mul_f32 v[26:27], v[26:27], v[2:3] op_sel_hi:[1,0]
v_pk_mul_f32 v[28:29], v[28:29], v[2:3] op_sel_hi:[1,0]
v_pk_mul_f32 v[30:31], v[30:31], v[2:3] op_sel_hi:[1,0]
v_cvt_pk_bf16_f32 v16, v16, v17
v_cvt_pk_bf16_f32 v17, v18, v19
v_cvt_pk_bf16_f32 v18, v20, v21
v_cvt_pk_bf16_f32 v19, v22, v23
v_cvt_pk_bf16_f32 v20, v24, v25
v_cvt_pk_bf16_f32 v21, v26, v27
v_cvt_pk_bf16_f32 v22, v28, v29
v_cvt_pk_bf16_f32 v23, v30, v31
buffer_store_dwordx4 v[16:19], v8, s[4:7], s40 offen offset:0 sc1
buffer_store_dwordx4 v[20:23], v8, s[4:7], s40 offen offset:1024 sc1
v_pk_mul_f32 v[32:33], v[32:33], v[2:3] op_sel_hi:[1,0]
v_pk_mul_f32 v[34:35], v[34:35], v[2:3] op_sel_hi:[1,0]
v_pk_mul_f32 v[36:37], v[36:37], v[2:3] op_sel_hi:[1,0]
v_pk_mul_f32 v[38:39], v[38:39], v[2:3] op_sel_hi:[1,0]
v_pk_mul_f32 v[40:41], v[40:41], v[2:3] op_sel_hi:[1,0]
v_pk_mul_f32 v[42:43], v[42:43], v[2:3] op_sel_hi:[1,0]
v_pk_mul_f32 v[44:45], v[44:45], v[2:3] op_sel_hi:[1,0]
v_pk_mul_f32 v[46:47], v[46:47], v[2:3] op_sel_hi:[1,0]
v_cvt_pk_bf16_f32 v32, v32, v33
v_cvt_pk_bf16_f32 v33, v34, v35
v_cvt_pk_bf16_f32 v34, v36, v37
v_cvt_pk_bf16_f32 v35, v38, v39
v_cvt_pk_bf16_f32 v36, v40, v41
v_cvt_pk_bf16_f32 v37, v42, v43
v_cvt_pk_bf16_f32 v38, v44, v45
v_cvt_pk_bf16_f32 v39, v46, v47
buffer_store_dwordx4 v[32:35], v8, s[4:7], s40 offen offset:2048 sc1
buffer_store_dwordx4 v[36:39], v8, s[4:7], s40 offen offset:3072 sc1
v_pk_mul_f32 v[48:49], v[48:49], v[2:3] op_sel_hi:[1,0]
v_pk_mul_f32 v[50:51], v[50:51], v[2:3] op_sel_hi:[1,0]
v_pk_mul_f32 v[52:53], v[52:53], v[2:3] op_sel_hi:[1,0]
v_pk_mul_f32 v[54:55], v[54:55], v[2:3] op_sel_hi:[1,0]
v_pk_mul_f32 v[56:57], v[56:57], v[2:3] op_sel_hi:[1,0]
v_pk_mul_f32 v[58:59], v[58:59], v[2:3] op_sel_hi:[1,0]
v_pk_mul_f32 v[60:61], v[60:61], v[2:3] op_sel_hi:[1,0]
v_pk_mul_f32 v[62:63], v[62:63], v[2:3] op_sel_hi:[1,0]
v_cvt_pk_bf16_f32 v48, v48, v49
v_cvt_pk_bf16_f32 v49, v50, v51
v_cvt_pk_bf16_f32 v50, v52, v53
v_cvt_pk_bf16_f32 v51, v54, v55
v_cvt_pk_bf16_f32 v52, v56, v57
v_cvt_pk_bf16_f32 v53, v58, v59
v_cvt_pk_bf16_f32 v54, v60, v61
v_cvt_pk_bf16_f32 v55, v62, v63
buffer_store_dwordx4 v[48:51], v8, s[4:7], s41 offen offset:0 sc1
buffer_store_dwordx4 v[52:55], v8, s[4:7], s41 offen offset:1024 sc1
v_pk_mul_f32 v[64:65], v[64:65], v[2:3] op_sel_hi:[1,0]
v_pk_mul_f32 v[66:67], v[66:67], v[2:3] op_sel_hi:[1,0]
v_pk_mul_f32 v[68:69], v[68:69], v[2:3] op_sel_hi:[1,0]
v_pk_mul_f32 v[70:71], v[70:71], v[2:3] op_sel_hi:[1,0]
v_pk_mul_f32 v[72:73], v[72:73], v[2:3] op_sel_hi:[1,0]
v_pk_mul_f32 v[74:75], v[74:75], v[2:3] op_sel_hi:[1,0]
v_pk_mul_f32 v[76:77], v[76:77], v[2:3] op_sel_hi:[1,0]
v_pk_mul_f32 v[78:79], v[78:79], v[2:3] op_sel_hi:[1,0]
v_cvt_pk_bf16_f32 v64, v64, v65
v_cvt_pk_bf16_f32 v65, v66, v67
v_cvt_pk_bf16_f32 v66, v68, v69
v_cvt_pk_bf16_f32 v67, v70, v71
v_cvt_pk_bf16_f32 v68, v72, v73
v_cvt_pk_bf16_f32 v69, v74, v75
v_cvt_pk_bf16_f32 v70, v76, v77
v_cvt_pk_bf16_f32 v71, v78, v79
buffer_store_dwordx4 v[64:67], v8, s[4:7], s41 offen offset:2048 sc1
buffer_store_dwordx4 v[68:71], v8, s[4:7], s41 offen offset:3072 sc1
Lajoin:
s_waitcnt vmcnt(0)
s_barrier
s_lshl_b32 s40, s24, 7
s_add_u32 s40, s40, 100679680
s_cmp_eq_u32 s36, 0
s_cbranch_scc0 Lsg_226
s_mov_b64 exec, 1
v_mov_b32 v1, s26
buffer_atomic_add v1, off, s[4:7], s40
s_mov_b64 exec, -1
Lsg_226:
s_add_u32 s20, s20, s28
s_cmp_lt_u32 s20, s29
s_cbranch_scc1 Laloop
s_endpgm
Lfinal:
s_and_b32 s30, s100, 15
s_lshr_b32 s31, s100, 4
s_load_dwordx2 s[8:9], s[0:1], 88
s_load_dwordx2 s[12:13], s[0:1], 40
s_load_dwordx2 s[16:17], s[0:1], 72
s_mov_b32 s10, 2097152
s_mov_b32 s11, 0x20000
s_mov_b32 s14, 4194304
s_mov_b32 s15, 0x20000
s_mov_b32 s18, 524288
s_mov_b32 s19, 0x20000
s_mov_b32 s20, s30
v_and_b32 v1, 63, v0
v_lshlrev_b32 v2, 4, v1
v_lshrrev_b32 v7, 2, v1
v_and_b32 v8, 3, v1
v_lshlrev_b32 v3, 10, v7
v_lshl_add_u32 v3, v8, 4, v3
v_bfe_u32 v7, v1, 2, 3
v_lshrrev_b32 v9, 5, v1
v_lshl_add_u32 v7, v9, 4, v7
v_lshlrev_b32 v4, 6, v7
v_lshl_add_u32 v4, v8, 4, v4
s_mul_i32 s43, s36, 18432
v_add_u32 v4, s43, v4
s_lshl_b32 s40, s36, 10
v_add_u32 v5, s40, v2
v_and_b32 v7, 15, v1
v_lshrrev_b32 v9, 4, v1
v_lshlrev_b32 v6, 10, v7
v_lshl_add_u32 v6, v9, 4, v6
s_lshr_b32 s40, s36, 1
s_lshl_b32 s40, s40, 14
s_and_b32 s41, s36, 1
s_lshl_b32 s41, s41, 3
s_add_u32 s40, s40, s41
s_lshl_b32 s41, s20, 6
s_add_u32 s40, s40, s41
v_add_u32 v6, s40, v6
s_waitcnt lgkmcnt(0)
s_lshl_b32 s40, s36, 19
s_add_u32 s40, s40, s41
s_add_u32 m0, s43, 0
s_nop 0
buffer_load_dwordx4 v3, s[12:15], s40 offen lds
s_add_u32 s40, s40, 16384
s_add_u32 m0, s43, 1024
s_nop 0
buffer_load_dwordx4 v3, s[12:15], s40 offen lds
s_add_u32 s40, s40, 16384
s_add_u32 m0, s43, 2048
s_nop 0
buffer_load_dwordx4 v3, s[12:15], s40 offen lds
s_add_u32 s40, s40, 16384
s_add_u32 m0, s43, 3072
s_nop 0
buffer_load_dwordx4 v3, s[12:15], s40 offen lds
s_add_u32 s40, s40, 16384
s_add_u32 m0, s43, 4096
s_nop 0
buffer_load_dwordx4 v3, s[12:15], s40 offen lds
s_add_u32 s40, s40, 16384
s_add_u32 m0, s43, 5120
s_nop 0
buffer_load_dwordx4 v3, s[12:15], s40 offen lds
s_add_u32 s40, s40, 16384
s_add_u32 m0, s43, 6144
s_nop 0
buffer_load_dwordx4 v3, s[12:15], s40 offen lds
s_add_u32 s40, s40, 16384
s_add_u32 m0, s43, 7168
s_nop 0
buffer_load_dwordx4 v3, s[12:15], s40 offen lds
s_add_u32 s40, s40, 16384
s_add_u32 m0, s43, 8192
s_nop 0
buffer_load_dwordx4 v3, s[12:15], s40 offen lds
s_add_u32 s40, s40, 16384
s_add_u32 m0, s43, 9216
s_nop 0
buffer_load_dwordx4 v3, s[12:15], s40 offen lds
s_add_u32 s40, s40, 16384
s_add_u32 m0, s43, 10240
s_nop 0
buffer_load_dwordx4 v3, s[12:15], s40 offen lds
s_add_u32 s40, s40, 16384
s_add_u32 m0, s43, 11264
s_nop 0
buffer_load_dwordx4 v3, s[12:15], s40 offen lds
s_add_u32 s40, s40, 16384
s_add_u32 m0, s43, 12288
s_nop 0
buffer_load_dwordx4 v3, s[12:15], s40 offen lds
s_add_u32 s40, s40, 16384
s_add_u32 m0, s43, 13312
s_nop 0
buffer_load_dwordx4 v3, s[12:15], s40 offen lds
s_add_u32 s40, s40, 16384
s_add_u32 m0, s43, 14336
s_nop 0
buffer_load_dwordx4 v3, s[12:15], s40 offen lds
s_add_u32 s40, s40, 16384
s_add_u32 m0, s43, 15360
s_nop 0
buffer_load_dwordx4 v3, s[12:15], s40 offen lds
s_add_u32 s40, s40, 16384
s_add_u32 m0, s43, 16384
s_nop 0
buffer_load_dwordx4 v3, s[12:15], s40 offen lds
s_add_u32 s40, s40, 16384
s_add_u32 m0, s43, 17408
s_nop 0
buffer_load_dwordx4 v3, s[12:15], s40 offen lds
s_waitcnt vmcnt(16)
ds_read_b64_tr_b16 v[112:113], v4 offset:0
ds_read_b64_tr_b16 v[114:115], v4 offset:512
ds_read_b64_tr_b16 v[116:117], v4 offset:8
ds_read_b64_tr_b16 v[118:119], v4 offset:520
s_waitcnt vmcnt(14)
ds_read_b64_tr_b16 v[120:121], v4 offset:2048
ds_read_b64_tr_b16 v[122:123], v4 offset:2560
ds_read_b64_tr_b16 v[124:125], v4 offset:2056
ds_read_b64_tr_b16 v[126:127], v4 offset:2568
s_waitcnt vmcnt(12)
ds_read_b64_tr_b16 v[128:129], v4 offset:4096
ds_read_b64_tr_b16 v[130:131], v4 offset:4608
ds_read_b64_tr_b16 v[132:133], v4 offset:4104
ds_read_b64_tr_b16 v[134:135], v4 offset:4616
s_waitcnt vmcnt(10)
ds_read_b64_tr_b16 v[136:137], v4 offset:6144
ds_read_b64_tr_b16 v[138:139], v4 offset:6656
ds_read_b64_tr_b16 v[140:141], v4 offset:6152
ds_read_b64_tr_b16 v[142:143], v4 offset:6664
s_waitcnt vmcnt(8)
ds_read_b64_tr_b16 v[144:145], v4 offset:8192
ds_read_b64_tr_b16 v[146:147], v4 offset:8704
ds_read_b64_tr_b16 v[148:149], v4 offset:8200
ds_read_b64_tr_b16 v[150:151], v4 offset:8712
s_waitcnt vmcnt(6)
ds_read_b64_tr_b16 v[152:153], v4 offset:10240
ds_read_b64_tr_b16 v[154:155], v4 offset:10752
ds_read_b64_tr_b16 v[156:157], v4 offset:10248
ds_read_b64_tr_b16 v[158:159], v4 offset:10760
s_waitcnt vmcnt(4)
ds_read_b64_tr_b16 v[160:161], v4 offset:12288
ds_read_b64_tr_b16 v[162:163], v4 offset:12800
ds_read_b64_tr_b16 v[164:165], v4 offset:12296
ds_read_b64_tr_b16 v[166:167], v4 offset:12808
s_waitcnt vmcnt(2)
ds_read_b64_tr_b16 v[168:169], v4 offset:14336
ds_read_b64_tr_b16 v[170:171], v4 offset:14848
ds_read_b64_tr_b16 v[172:173], v4 offset:14344
ds_read_b64_tr_b16 v[174:175], v4 offset:14856
s_waitcnt vmcnt(0)
ds_read_b64_tr_b16 v[176:177], v4 offset:16384
ds_read_b64_tr_b16 v[178:179], v4 offset:16896
ds_read_b64_tr_b16 v[180:181], v4 offset:16392
ds_read_b64_tr_b16 v[182:183], v4 offset:16904
s_waitcnt lgkmcnt(0)
s_add_u32 s40, s40, 16384
s_add_u32 m0, s43, 0
s_nop 0
buffer_load_dwordx4 v3, s[12:15], s40 offen lds
s_add_u32 s40, s40, 16384
s_add_u32 m0, s43, 1024
s_nop 0
buffer_load_dwordx4 v3, s[12:15], s40 offen lds
s_add_u32 s40, s40, 16384
s_add_u32 m0, s43, 2048
s_nop 0
buffer_load_dwordx4 v3, s[12:15], s40 offen lds
s_add_u32 s40, s40, 16384
s_add_u32 m0, s43, 3072
s_nop 0
buffer_load_dwordx4 v3, s[12:15], s40 offen lds
s_add_u32 s40, s40, 16384
s_add_u32 m0, s43, 4096
s_nop 0
buffer_load_dwordx4 v3, s[12:15], s40 offen lds
s_add_u32 s40, s40, 16384
s_add_u32 m0, s43, 5120
s_nop 0
buffer_load_dwordx4 v3, s[12:15], s40 offen lds
s_add_u32 s40, s40, 16384
s_add_u32 m0, s43, 6144
s_nop 0
buffer_load_dwordx4 v3, s[12:15], s40 offen lds
s_add_u32 s40, s40, 16384
s_add_u32 m0, s43, 7168
s_nop 0
buffer_load_dwordx4 v3, s[12:15], s40 offen lds
s_add_u32 s40, s40, 16384
s_add_u32 m0, s43, 8192
s_nop 0
buffer_load_dwordx4 v3, s[12:15], s40 offen lds
s_add_u32 s40, s40, 16384
s_add_u32 m0, s43, 9216
s_nop 0
buffer_load_dwordx4 v3, s[12:15], s40 offen lds
s_add_u32 s40, s40, 16384
s_add_u32 m0, s43, 10240
s_nop 0
buffer_load_dwordx4 v3, s[12:15], s40 offen lds
s_add_u32 s40, s40, 16384
s_add_u32 m0, s43, 11264
s_nop 0
buffer_load_dwordx4 v3, s[12:15], s40 offen lds
s_add_u32 s40, s40, 16384
s_add_u32 m0, s43, 12288
s_nop 0
buffer_load_dwordx4 v3, s[12:15], s40 offen lds
s_add_u32 s40, s40, 16384
s_add_u32 m0, s43, 13312
s_nop 0
buffer_load_dwordx4 v3, s[12:15], s40 offen lds
s_lshl_b32 s40, s36, 16
s_add_u32 s40, s40, s41
s_add_u32 m0, s43, 14336
s_nop 0
buffer_load_dwordx4 v3, s[16:19], s40 offen lds
s_add_u32 s40, s40, 16384
s_add_u32 m0, s43, 15360
s_nop 0
buffer_load_dwordx4 v3, s[16:19], s40 offen lds
s_add_u32 s40, s40, 16384
s_add_u32 m0, s43, 16384
s_nop 0
buffer_load_dwordx4 v3, s[16:19], s40 offen lds
s_add_u32 s40, s40, 16384
s_add_u32 m0, s43, 17408
s_nop 0
buffer_load_dwordx4 v3, s[16:19], s40 offen lds
s_waitcnt vmcnt(16)
ds_read_b64_tr_b16 v[184:185], v4 offset:0
ds_read_b64_tr_b16 v[186:187], v4 offset:512
ds_read_b64_tr_b16 v[188:189], v4 offset:8
ds_read_b64_tr_b16 v[190:191], v4 offset:520
s_waitcnt vmcnt(14)
ds_read_b64_tr_b16 v[192:193], v4 offset:2048
ds_read_b64_tr_b16 v[194:195], v4 offset:2560
ds_read_b64_tr_b16 v[196:197], v4 offset:2056
ds_read_b64_tr_b16 v[198:199], v4 offset:2568
s_waitcnt vmcnt(12)
ds_read_b64_tr_b16 v[200:201], v4 offset:4096
ds_read_b64_tr_b16 v[202:203], v4 offset:4608
ds_read_b64_tr_b16 v[204:205], v4 offset:4104
ds_read_b64_tr_b16 v[206:207], v4 offset:4616
s_waitcnt vmcnt(10)
ds_read_b64_tr_b16 v[208:209], v4 offset:6144
ds_read_b64_tr_b16 v[210:211], v4 offset:6656
ds_read_b64_tr_b16 v[212:213], v4 offset:6152
ds_read_b64_tr_b16 v[214:215], v4 offset:6664
s_waitcnt vmcnt(8)
ds_read_b64_tr_b16 v[216:217], v4 offset:8192
ds_read_b64_tr_b16 v[218:219], v4 offset:8704
ds_read_b64_tr_b16 v[220:221], v4 offset:8200
ds_read_b64_tr_b16 v[222:223], v4 offset:8712
s_waitcnt vmcnt(6)
ds_read_b64_tr_b16 v[224:225], v4 offset:10240
ds_read_b64_tr_b16 v[226:227], v4 offset:10752
ds_read_b64_tr_b16 v[228:229], v4 offset:10248
ds_read_b64_tr_b16 v[230:231], v4 offset:10760
s_waitcnt vmcnt(4)
ds_read_b64_tr_b16 v[232:233], v4 offset:12288
ds_read_b64_tr_b16 v[234:235], v4 offset:12800
ds_read_b64_tr_b16 v[236:237], v4 offset:12296
ds_read_b64_tr_b16 v[238:239], v4 offset:12808
s_waitcnt vmcnt(2)
ds_read_b64_tr_b16 v[240:241], v4 offset:14336
ds_read_b64_tr_b16 v[242:243], v4 offset:14848
ds_read_b64_tr_b16 v[244:245], v4 offset:14344
ds_read_b64_tr_b16 v[246:247], v4 offset:14856
s_waitcnt vmcnt(0)
ds_read_b64_tr_b16 v[248:249], v4 offset:16384
ds_read_b64_tr_b16 v[250:251], v4 offset:16896
ds_read_b64_tr_b16 v[252:253], v4 offset:16392
ds_read_b64_tr_b16 v[254:255], v4 offset:16904
s_waitcnt lgkmcnt(0)
v_lshlrev_b32 v3, 9, v9
v_lshl_add_u32 v3, v7, 4, v3
s_barrier
s_mov_b32 s29, 8
Lfloop:
s_lshr_b32 s40, s31, 3
s_lshl_b32 s40, s40, 7
s_add_u32 s40, s40, 100687872
s_cmp_eq_u32 s36, 0
s_cbranch_scc0 Lpe_228
Lpl_227:
buffer_load_dword v1, off, s[4:7], s40 sc1
s_add_u32 s33, s33, 1
s_cmp_gt_u32 s33, 524288
s_cbranch_scc1 Lexit
s_waitcnt vmcnt(0)
v_cmp_gt_u32 vcc, 32, v1
s_cbranch_vccz Lpe_228
s_sleep 8
s_branch Lpl_227
Lpe_228:
s_barrier
s_mul_i32 s21, s31, 294912
s_add_u32 s21, s21, 79691776
s_lshl_b32 s40, s36, 12
s_add_u32 s22, s21, s40
s_add_u32 s22, s22, 262144
s_lshl_b32 s40, s36, 15
s_add_u32 s21, s21, s40
buffer_load_dwordx4 v[24:27], v3, s[4:7], s22 offen offset:0 sc1
buffer_load_dwordx4 v[28:31], v3, s[4:7], s22 offen offset:256 sc1
buffer_load_dwordx4 v[32:35], v3, s[4:7], s22 offen offset:2048 sc1
buffer_load_dwordx4 v[36:39], v3, s[4:7], s22 offen offset:2304 sc1
s_waitcnt vmcnt(3)
v_mfma_f32_16x16x32_bf16 v[8:11], v[240:243], v[24:27], 0
v_mfma_f32_16x16x32_bf16 v[12:15], v[244:247], v[24:27], 0
s_waitcnt vmcnt(2)
v_mfma_f32_16x16x32_bf16 v[16:19], v[240:243], v[28:31], 0
v_mfma_f32_16x16x32_bf16 v[20:23], v[244:247], v[28:31], 0
s_waitcnt vmcnt(1)
v_mfma_f32_16x16x32_bf16 v[8:11], v[248:251], v[32:35], v[8:11]
v_mfma_f32_16x16x32_bf16 v[12:15], v[252:255], v[32:35], v[12:15]
s_waitcnt vmcnt(0)
v_mfma_f32_16x16x32_bf16 v[16:19], v[248:251], v[36:39], v[16:19]
v_mfma_f32_16x16x32_bf16 v[20:23], v[252:255], v[36:39], v[20:23]
s_sub_u32 s41, s31, 2
s_max_i32 s41, s41, 0
s_and_b32 s40, s100, 31
s_lshl_b32 s40, s40, 7
s_add_u32 s40, s40, 100696064
s_cmp_eq_u32 s36, 0
s_cbranch_scc0 Lpe_230
Lpl_229:
buffer_load_dword v1, off, s[4:7], s40 sc1
s_add_u32 s33, s33, 1
s_cmp_gt_u32 s33, 524288
s_cbranch_scc1 Lexit
s_waitcnt vmcnt(0)
v_cmp_gt_u32 vcc, s41, v1
s_cbranch_vccz Lpe_230
s_sleep 64
s_branch Lpl_229
Lpe_230:
s_lshl_b32 s40, s31, 7
s_add_u32 s40, s40, 100679680
s_cmp_eq_u32 s36, 0
s_cbranch_scc0 Lpe_232
Lpl_231:
buffer_load_dword v1, off, s[4:7], s40 sc1
s_add_u32 s33, s33, 1
s_cmp_gt_u32 s33, 524288
s_cbranch_scc1 Lexit
s_waitcnt vmcnt(0)
v_cmp_gt_u32 vcc, 16, v1
s_cbranch_vccz Lpe_232
s_sleep 1
s_branch Lpl_231
Lpe_232:
s_barrier
s_add_u32 s42, s21, 0
buffer_load_dwordx4 v[24:27], v3, s[4:7], s42 offen offset:0 sc1
buffer_load_dwordx4 v[28:31], v3, s[4:7], s42 offen offset:256 sc1
buffer_load_dwordx4 v[32:35], v3, s[4:7], s42 offen offset:2048 sc1
buffer_load_dwordx4 v[36:39], v3, s[4:7], s42 offen offset:2304 sc1
s_add_u32 s42, s21, 4096
buffer_load_dwordx4 v[40:43], v3, s[4:7], s42 offen offset:0 sc1
buffer_load_dwordx4 v[44:47], v3, s[4:7], s42 offen offset:256 sc1
buffer_load_dwordx4 v[48:51], v3, s[4:7], s42 offen offset:2048 sc1
buffer_load_dwordx4 v[52:55], v3, s[4:7], s42 offen offset:2304 sc1
s_add_u32 s42, s21, 8192
buffer_load_dwordx4 v[56:59], v3, s[4:7], s42 offen offset:0 sc1
buffer_load_dwordx4 v[60:63], v3, s[4:7], s42 offen offset:256 sc1
buffer_load_dwordx4 v[64:67], v3, s[4:7], s42 offen offset:2048 sc1
buffer_load_dwordx4 v[68:71], v3, s[4:7], s42 offen offset:2304 sc1
s_add_u32 s42, s21, 12288
buffer_load_dwordx4 v[72:75], v3, s[4:7], s42 offen offset:0 sc1
buffer_load_dwordx4 v[76:79], v3, s[4:7], s42 offen offset:256 sc1
buffer_load_dwordx4 v[80:83], v3, s[4:7], s42 offen offset:2048 sc1
buffer_load_dwordx4 v[84:87], v3, s[4:7], s42 offen offset:2304 sc1
s_add_u32 s42, s21, 16384
buffer_load_dwordx4 v[88:91], v3, s[4:7], s42 offen offset:0 sc1
buffer_load_dwordx4 v[92:95], v3, s[4:7], s42 offen offset:256 sc1
buffer_load_dwordx4 v[96:99], v3, s[4:7], s42 offen offset:2048 sc1
buffer_load_dwordx4 v[100:103], v3, s[4:7], s42 offen offset:2304 sc1
s_add_u32 s42, s21, 20480
buffer_load_dwordx4 v[104:107], v3, s[4:7], s42 offen offset:0 sc1
s_waitcnt vmcnt(20)
v_mfma_f32_16x16x32_bf16 v[8:11], v[112:115], v[24:27], v[8:11]
v_mfma_f32_16x16x32_bf16 v[12:15], v[116:119], v[24:27], v[12:15]
buffer_load_dwordx4 v[24:27], v3, s[4:7], s42 offen offset:256 sc1
s_waitcnt vmcnt(20)
v_mfma_f32_16x16x32_bf16 v[16:19], v[112:115], v[28:31], v[16:19]
v_mfma_f32_16x16x32_bf16 v[20:23], v[116:119], v[28:31], v[20:23]
buffer_load_dwordx4 v[28:31], v3, s[4:7], s42 offen offset:2048 sc1
s_waitcnt vmcnt(20)
v_mfma_f32_16x16x32_bf16 v[8:11], v[120:123], v[32:35], v[8:11]
v_mfma_f32_16x16x32_bf16 v[12:15], v[124:127], v[32:35], v[12:15]
buffer_load_dwordx4 v[32:35], v3, s[4:7], s42 offen offset:2304 sc1
s_waitcnt vmcnt(20)
v_mfma_f32_16x16x32_bf16 v[16:19], v[120:123], v[36:39], v[16:19]
v_mfma_f32_16x16x32_bf16 v[20:23], v[124:127], v[36:39], v[20:23]
s_add_u32 s42, s21, 24576
buffer_load_dwordx4 v[36:39], v3, s[4:7], s42 offen offset:0 sc1
s_waitcnt vmcnt(20)
v_mfma_f32_16x16x32_bf16 v[8:11], v[128:131], v[40:43], v[8:11]
v_mfma_f32_16x16x32_bf16 v[12:15], v[132:135], v[40:43], v[12:15]
buffer_load_dwordx4 v[40:43], v3, s[4:7], s42 offen offset:256 sc1
s_waitcnt vmcnt(20)
v_mfma_f32_16x16x32_bf16 v[16:19], v[128:131], v[44:47], v[16:19]
v_mfma_f32_16x16x32_bf16 v[20:23], v[132:135], v[44:47], v[20:23]
buffer_load_dwordx4 v[44:47], v3, s[4:7], s42 offen offset:2048 sc1
s_waitcnt vmcnt(20)
v_mfma_f32_16x16x32_bf16 v[8:11], v[136:139], v[48:51], v[8:11]
v_mfma_f32_16x16x32_bf16 v[12:15], v[140:143], v[48:51], v[12:15]
buffer_load_dwordx4 v[48:51], v3, s[4:7], s42 offen offset:2304 sc1
s_waitcnt vmcnt(20)
v_mfma_f32_16x16x32_bf16 v[16:19], v[136:139], v[52:55], v[16:19]
v_mfma_f32_16x16x32_bf16 v[20:23], v[140:143], v[52:55], v[20:23]
s_add_u32 s42, s21, 28672
buffer_load_dwordx4 v[52:55], v3, s[4:7], s42 offen offset:0 sc1
s_waitcnt vmcnt(20)
v_mfma_f32_16x16x32_bf16 v[8:11], v[144:147], v[56:59], v[8:11]
v_mfma_f32_16x16x32_bf16 v[12:15], v[148:151], v[56:59], v[12:15]
buffer_load_dwordx4 v[56:59], v3, s[4:7], s42 offen offset:256 sc1
s_waitcnt vmcnt(20)
v_mfma_f32_16x16x32_bf16 v[16:19], v[144:147], v[60:63], v[16:19]
v_mfma_f32_16x16x32_bf16 v[20:23], v[148:151], v[60:63], v[20:23]
buffer_load_dwordx4 v[60:63], v3, s[4:7], s42 offen offset:2048 sc1
s_waitcnt vmcnt(20)
v_mfma_f32_16x16x32_bf16 v[8:11], v[152:155], v[64:67], v[8:11]
v_mfma_f32_16x16x32_bf16 v[12:15], v[156:159], v[64:67], v[12:15]
buffer_load_dwordx4 v[64:67], v3, s[4:7], s42 offen offset:2304 sc1
s_waitcnt vmcnt(20)
v_mfma_f32_16x16x32_bf16 v[16:19], v[152:155], v[68:71], v[16:19]
v_mfma_f32_16x16x32_bf16 v[20:23], v[156:159], v[68:71], v[20:23]
s_waitcnt vmcnt(19)
v_mfma_f32_16x16x32_bf16 v[8:11], v[160:163], v[72:75], v[8:11]
v_mfma_f32_16x16x32_bf16 v[12:15], v[164:167], v[72:75], v[12:15]
s_waitcnt vmcnt(18)
v_mfma_f32_16x16x32_bf16 v[16:19], v[160:163], v[76:79], v[16:19]
v_mfma_f32_16x16x32_bf16 v[20:23], v[164:167], v[76:79], v[20:23]
s_waitcnt vmcnt(17)
v_mfma_f32_16x16x32_bf16 v[8:11], v[168:171], v[80:83], v[8:11]
v_mfma_f32_16x16x32_bf16 v[12:15], v[172:175], v[80:83], v[12:15]
s_waitcnt vmcnt(16)
v_mfma_f32_16x16x32_bf16 v[16:19], v[168:171], v[84:87], v[16:19]
v_mfma_f32_16x16x32_bf16 v[20:23], v[172:175], v[84:87], v[20:23]
s_waitcnt vmcnt(15)
v_mfma_f32_16x16x32_bf16 v[8:11], v[176:179], v[88:91], v[8:11]
v_mfma_f32_16x16x32_bf16 v[12:15], v[180:183], v[88:91], v[12:15]
s_waitcnt vmcnt(14)
v_mfma_f32_16x16x32_bf16 v[16:19], v[176:179], v[92:95], v[16:19]
v_mfma_f32_16x16x32_bf16 v[20:23], v[180:183], v[92:95], v[20:23]
s_waitcnt vmcnt(13)
v_mfma_f32_16x16x32_bf16 v[8:11], v[184:187], v[96:99], v[8:11]
v_mfma_f32_16x16x32_bf16 v[12:15], v[188:191], v[96:99], v[12:15]
s_waitcnt vmcnt(12)
v_mfma_f32_16x16x32_bf16 v[16:19], v[184:187], v[100:103], v[16:19]
v_mfma_f32_16x16x32_bf16 v[20:23], v[188:191], v[100:103], v[20:23]
s_waitcnt vmcnt(11)
v_mfma_f32_16x16x32_bf16 v[8:11], v[192:195], v[104:107], v[8:11]
v_mfma_f32_16x16x32_bf16 v[12:15], v[196:199], v[104:107], v[12:15]
s_waitcnt vmcnt(10)
v_mfma_f32_16x16x32_bf16 v[16:19], v[192:195], v[24:27], v[16:19]
v_mfma_f32_16x16x32_bf16 v[20:23], v[196:199], v[24:27], v[20:23]
s_waitcnt vmcnt(9)
v_mfma_f32_16x16x32_bf16 v[8:11], v[200:203], v[28:31], v[8:11]
v_mfma_f32_16x16x32_bf16 v[12:15], v[204:207], v[28:31], v[12:15]
s_waitcnt vmcnt(8)
v_mfma_f32_16x16x32_bf16 v[16:19], v[200:203], v[32:35], v[16:19]
v_mfma_f32_16x16x32_bf16 v[20:23], v[204:207], v[32:35], v[20:23]
s_waitcnt vmcnt(7)
v_mfma_f32_16x16x32_bf16 v[8:11], v[208:211], v[36:39], v[8:11]
v_mfma_f32_16x16x32_bf16 v[12:15], v[212:215], v[36:39], v[12:15]
s_waitcnt vmcnt(6)
v_mfma_f32_16x16x32_bf16 v[16:19], v[208:211], v[40:43], v[16:19]
v_mfma_f32_16x16x32_bf16 v[20:23], v[212:215], v[40:43], v[20:23]
s_waitcnt vmcnt(5)
v_mfma_f32_16x16x32_bf16 v[8:11], v[216:219], v[44:47], v[8:11]
v_mfma_f32_16x16x32_bf16 v[12:15], v[220:223], v[44:47], v[12:15]
s_waitcnt vmcnt(4)
v_mfma_f32_16x16x32_bf16 v[16:19], v[216:219], v[48:51], v[16:19]
v_mfma_f32_16x16x32_bf16 v[20:23], v[220:223], v[48:51], v[20:23]
s_waitcnt vmcnt(3)
v_mfma_f32_16x16x32_bf16 v[8:11], v[224:227], v[52:55], v[8:11]
v_mfma_f32_16x16x32_bf16 v[12:15], v[228:231], v[52:55], v[12:15]
s_waitcnt vmcnt(2)
v_mfma_f32_16x16x32_bf16 v[16:19], v[224:227], v[56:59], v[16:19]
v_mfma_f32_16x16x32_bf16 v[20:23], v[228:231], v[56:59], v[20:23]
s_waitcnt vmcnt(1)
v_mfma_f32_16x16x32_bf16 v[8:11], v[232:235], v[60:63], v[8:11]
v_mfma_f32_16x16x32_bf16 v[12:15], v[236:239], v[60:63], v[12:15]
s_waitcnt vmcnt(0)
v_mfma_f32_16x16x32_bf16 v[16:19], v[232:235], v[64:67], v[16:19]
v_mfma_f32_16x16x32_bf16 v[20:23], v[236:239], v[64:67], v[20:23]
ds_write_b128 v5, v[8:11] offset:0
ds_write_b128 v5, v[12:15] offset:8192
s_nop 1
ds_write_b128 v5, v[16:19] offset:16384
s_nop 2
ds_write_b128 v5, v[20:23] offset:24576
s_waitcnt lgkmcnt(0)
s_barrier
s_cmp_lt_u32 s36, 4
s_cbranch_scc0 Lfs_233
s_lshl_b32 s40, s36, 13
v_add_u32 v7, s40, v2
ds_read_b128 v[24:27], v7 offset:0
ds_read_b128 v[28:31], v7 offset:1024
ds_read_b128 v[32:35], v7 offset:2048
ds_read_b128 v[36:39], v7 offset:3072
ds_read_b128 v[40:43], v7 offset:4096
ds_read_b128 v[44:47], v7 offset:5120
ds_read_b128 v[48:51], v7 offset:6144
ds_read_b128 v[52:55], v7 offset:7168
s_waitcnt lgkmcnt(6)
v_pk_add_f32 v[24:25], v[24:25], v[28:29]
v_pk_add_f32 v[26:27], v[26:27], v[30:31]
s_waitcnt lgkmcnt(5)
v_pk_add_f32 v[24:25], v[24:25], v[32:33]
v_pk_add_f32 v[26:27], v[26:27], v[34:35]
s_waitcnt lgkmcnt(4)
v_pk_add_f32 v[24:25], v[24:25], v[36:37]
v_pk_add_f32 v[26:27], v[26:27], v[38:39]
s_waitcnt lgkmcnt(3)
v_pk_add_f32 v[24:25], v[24:25], v[40:41]
v_pk_add_f32 v[26:27], v[26:27], v[42:43]
s_waitcnt lgkmcnt(2)
v_pk_add_f32 v[24:25], v[24:25], v[44:45]
v_pk_add_f32 v[26:27], v[26:27], v[46:47]
s_waitcnt lgkmcnt(1)
v_pk_add_f32 v[24:25], v[24:25], v[48:49]
v_pk_add_f32 v[26:27], v[26:27], v[50:51]
s_waitcnt lgkmcnt(0)
v_pk_add_f32 v[24:25], v[24:25], v[52:53]
v_pk_add_f32 v[26:27], v[26:27], v[54:55]
v_cvt_pk_bf16_f32 v108, v24, v25
v_cvt_pk_bf16_f32 v109, v26, v27
s_lshl_b32 s40, s31, 15
buffer_store_dwordx2 v[108:109], v6, s[8:11], s40 offen
s_waitcnt vmcnt(0)
Lfs_233:
s_barrier
s_add_u32 s31, s31, 8
s_cmp_lt_u32 s31, 56
s_cbranch_scc1 Lfloop
s_lshr_b32 s40, s100, 4
s_add_u32 s40, s40, 0
s_bfe_u32 s31, s40, 0x20001
s_add_u32 s31, s31, 56
s_and_b32 s23, s40, 1
s_lshl_b32 s23, s23, 8
s_lshr_b32 s40, s31, 3
s_lshl_b32 s40, s40, 7
s_add_u32 s40, s40, 100687872
s_cmp_eq_u32 s36, 0
s_cbranch_scc0 Lpe_235
Lpl_234:
buffer_load_dword v1, off, s[4:7], s40 sc1
s_add_u32 s33, s33, 1
s_cmp_gt_u32 s33, 524288
s_cbranch_scc1 Lexit
s_waitcnt vmcnt(0)
v_cmp_gt_u32 vcc, 32, v1
s_cbranch_vccz Lpe_235
s_sleep 8
s_branch Lpl_234
Lpe_235:
s_barrier
Lfhalf:
s_mul_i32 s21, s31, 294912
s_add_u32 s21, s21, 79691776
s_add_u32 s21, s21, s23
s_lshl_b32 s40, s36, 12
s_add_u32 s22, s21, s40
s_add_u32 s22, s22, 262144
s_lshl_b32 s40, s36, 15
s_add_u32 s21, s21, s40
buffer_load_dwordx4 v[24:27], v3, s[4:7], s22 offen offset:0 sc1
buffer_load_dwordx4 v[28:31], v3, s[4:7], s22 offen offset:2048 sc1
s_waitcnt vmcnt(1)
v_mfma_f32_16x16x32_bf16 v[8:11], v[240:243], v[24:27], 0
v_mfma_f32_16x16x32_bf16 v[12:15], v[244:247], v[24:27], 0
s_waitcnt vmcnt(0)
v_mfma_f32_16x16x32_bf16 v[8:11], v[248:251], v[28:31], v[8:11]
v_mfma_f32_16x16x32_bf16 v[12:15], v[252:255], v[28:31], v[12:15]
s_sub_u32 s41, s31, 2
s_max_i32 s41, s41, 0
s_and_b32 s40, s100, 31
s_lshl_b32 s40, s40, 7
s_add_u32 s40, s40, 100696064
s_cmp_eq_u32 s36, 0
s_cbranch_scc0 Lpe_237
Lpl_236:
buffer_load_dword v1, off, s[4:7], s40 sc1
s_add_u32 s33, s33, 1
s_cmp_gt_u32 s33, 524288
s_cbranch_scc1 Lexit
s_waitcnt vmcnt(0)
v_cmp_gt_u32 vcc, s41, v1
s_cbranch_vccz Lpe_237
s_sleep 64
s_branch Lpl_236
Lpe_237:
s_lshl_b32 s40, s31, 7
s_add_u32 s40, s40, 100679680
s_cmp_eq_u32 s36, 0
s_cbranch_scc0 Lpe_239
Lpl_238:
buffer_load_dword v1, off, s[4:7], s40 sc1
s_add_u32 s33, s33, 1
s_cmp_gt_u32 s33, 524288
s_cbranch_scc1 Lexit
s_waitcnt vmcnt(0)
v_cmp_gt_u32 vcc, 16, v1
s_cbranch_vccz Lpe_239
s_sleep 1
s_branch Lpl_238
Lpe_239:
s_barrier
s_add_u32 s42, s21, 0
buffer_load_dwordx4 v[24:27], v3, s[4:7], s42 offen offset:0 sc1
buffer_load_dwordx4 v[28:31], v3, s[4:7], s42 offen offset:2048 sc1
s_add_u32 s42, s21, 4096
buffer_load_dwordx4 v[32:35], v3, s[4:7], s42 offen offset:0 sc1
buffer_load_dwordx4 v[36:39], v3, s[4:7], s42 offen offset:2048 sc1
s_add_u32 s42, s21, 8192
buffer_load_dwordx4 v[40:43], v3, s[4:7], s42 offen offset:0 sc1
buffer_load_dwordx4 v[44:47], v3, s[4:7], s42 offen offset:2048 sc1
s_add_u32 s42, s21, 12288
buffer_load_dwordx4 v[48:51], v3, s[4:7], s42 offen offset:0 sc1
buffer_load_dwordx4 v[52:55], v3, s[4:7], s42 offen offset:2048 sc1
s_add_u32 s42, s21, 16384
buffer_load_dwordx4 v[56:59], v3, s[4:7], s42 offen offset:0 sc1
buffer_load_dwordx4 v[60:63], v3, s[4:7], s42 offen offset:2048 sc1
s_add_u32 s42, s21, 20480
buffer_load_dwordx4 v[64:67], v3, s[4:7], s42 offen offset:0 sc1
buffer_load_dwordx4 v[68:71], v3, s[4:7], s42 offen offset:2048 sc1
s_add_u32 s42, s21, 24576
buffer_load_dwordx4 v[72:75], v3, s[4:7], s42 offen offset:0 sc1
buffer_load_dwordx4 v[76:79], v3, s[4:7], s42 offen offset:2048 sc1
s_add_u32 s42, s21, 28672
buffer_load_dwordx4 v[80:83], v3, s[4:7], s42 offen offset:0 sc1
buffer_load_dwordx4 v[84:87], v3, s[4:7], s42 offen offset:2048 sc1
s_waitcnt vmcnt(15)
v_mfma_f32_16x16x32_bf16 v[8:11], v[112:115], v[24:27], v[8:11]
v_mfma_f32_16x16x32_bf16 v[12:15], v[116:119], v[24:27], v[12:15]
s_waitcnt vmcnt(14)
v_mfma_f32_16x16x32_bf16 v[8:11], v[120:123], v[28:31], v[8:11]
v_mfma_f32_16x16x32_bf16 v[12:15], v[124:127], v[28:31], v[12:15]
s_waitcnt vmcnt(13)
v_mfma_f32_16x16x32_bf16 v[8:11], v[128:131], v[32:35], v[8:11]
v_mfma_f32_16x16x32_bf16 v[12:15], v[132:135], v[32:35], v[12:15]
s_waitcnt vmcnt(12)
v_mfma_f32_16x16x32_bf16 v[8:11], v[136:139], v[36:39], v[8:11]
v_mfma_f32_16x16x32_bf16 v[12:15], v[140:143], v[36:39], v[12:15]
s_waitcnt vmcnt(11)
v_mfma_f32_16x16x32_bf16 v[8:11], v[144:147], v[40:43], v[8:11]
v_mfma_f32_16x16x32_bf16 v[12:15], v[148:151], v[40:43], v[12:15]
s_waitcnt vmcnt(10)
v_mfma_f32_16x16x32_bf16 v[8:11], v[152:155], v[44:47], v[8:11]
v_mfma_f32_16x16x32_bf16 v[12:15], v[156:159], v[44:47], v[12:15]
s_waitcnt vmcnt(9)
v_mfma_f32_16x16x32_bf16 v[8:11], v[160:163], v[48:51], v[8:11]
v_mfma_f32_16x16x32_bf16 v[12:15], v[164:167], v[48:51], v[12:15]
s_waitcnt vmcnt(8)
v_mfma_f32_16x16x32_bf16 v[8:11], v[168:171], v[52:55], v[8:11]
v_mfma_f32_16x16x32_bf16 v[12:15], v[172:175], v[52:55], v[12:15]
s_waitcnt vmcnt(7)
v_mfma_f32_16x16x32_bf16 v[8:11], v[176:179], v[56:59], v[8:11]
v_mfma_f32_16x16x32_bf16 v[12:15], v[180:183], v[56:59], v[12:15]
s_waitcnt vmcnt(6)
v_mfma_f32_16x16x32_bf16 v[8:11], v[184:187], v[60:63], v[8:11]
v_mfma_f32_16x16x32_bf16 v[12:15], v[188:191], v[60:63], v[12:15]
s_waitcnt vmcnt(5)
v_mfma_f32_16x16x32_bf16 v[8:11], v[192:195], v[64:67], v[8:11]
v_mfma_f32_16x16x32_bf16 v[12:15], v[196:199], v[64:67], v[12:15]
s_waitcnt vmcnt(4)
v_mfma_f32_16x16x32_bf16 v[8:11], v[200:203], v[68:71], v[8:11]
v_mfma_f32_16x16x32_bf16 v[12:15], v[204:207], v[68:71], v[12:15]
s_waitcnt vmcnt(3)
v_mfma_f32_16x16x32_bf16 v[8:11], v[208:211], v[72:75], v[8:11]
v_mfma_f32_16x16x32_bf16 v[12:15], v[212:215], v[72:75], v[12:15]
s_waitcnt vmcnt(2)
v_mfma_f32_16x16x32_bf16 v[8:11], v[216:219], v[76:79], v[8:11]
v_mfma_f32_16x16x32_bf16 v[12:15], v[220:223], v[76:79], v[12:15]
s_waitcnt vmcnt(1)
v_mfma_f32_16x16x32_bf16 v[8:11], v[224:227], v[80:83], v[8:11]
v_mfma_f32_16x16x32_bf16 v[12:15], v[228:231], v[80:83], v[12:15]
s_waitcnt vmcnt(0)
v_mfma_f32_16x16x32_bf16 v[8:11], v[232:235], v[84:87], v[8:11]
v_mfma_f32_16x16x32_bf16 v[12:15], v[236:239], v[84:87], v[12:15]
s_nop 3
ds_write_b128 v5, v[8:11] offset:0
s_nop 2
ds_write_b128 v5, v[12:15] offset:8192
s_waitcnt lgkmcnt(0)
s_barrier
s_cmp_lt_u32 s36, 2
s_cbranch_scc0 Lfs_240
s_lshl_b32 s40, s36, 13
v_add_u32 v7, s40, v2
ds_read_b128 v[24:27], v7 offset:0
ds_read_b128 v[28:31], v7 offset:1024
ds_read_b128 v[32:35], v7 offset:2048
ds_read_b128 v[36:39], v7 offset:3072
ds_read_b128 v[40:43], v7 offset:4096
ds_read_b128 v[44:47], v7 offset:5120
ds_read_b128 v[48:51], v7 offset:6144
ds_read_b128 v[52:55], v7 offset:7168
s_waitcnt lgkmcnt(6)
v_pk_add_f32 v[24:25], v[24:25], v[28:29]
v_pk_add_f32 v[26:27], v[26:27], v[30:31]
s_waitcnt lgkmcnt(5)
v_pk_add_f32 v[24:25], v[24:25], v[32:33]
v_pk_add_f32 v[26:27], v[26:27], v[34:35]
s_waitcnt lgkmcnt(4)
v_pk_add_f32 v[24:25], v[24:25], v[36:37]
v_pk_add_f32 v[26:27], v[26:27], v[38:39]
s_waitcnt lgkmcnt(3)
v_pk_add_f32 v[24:25], v[24:25], v[40:41]
v_pk_add_f32 v[26:27], v[26:27], v[42:43]
s_waitcnt lgkmcnt(2)
v_pk_add_f32 v[24:25], v[24:25], v[44:45]
v_pk_add_f32 v[26:27], v[26:27], v[46:47]
s_waitcnt lgkmcnt(1)
v_pk_add_f32 v[24:25], v[24:25], v[48:49]
v_pk_add_f32 v[26:27], v[26:27], v[50:51]
s_waitcnt lgkmcnt(0)
v_pk_add_f32 v[24:25], v[24:25], v[52:53]
v_pk_add_f32 v[26:27], v[26:27], v[54:55]
v_cvt_pk_bf16_f32 v108, v24, v25
v_cvt_pk_bf16_f32 v109, v26, v27
s_lshl_b32 s40, s31, 15
s_lshl_b32 s41, s23, 6
s_add_u32 s40, s40, s41
buffer_store_dwordx2 v[108:109], v6, s[8:11], s40 offen
s_waitcnt vmcnt(0)
Lfs_240:
s_add_u32 s31, s31, 4
s_cmp_lt_u32 s31, 64
s_cbranch_scc1 Lfhalf
Lexit:
s_endpgm
.p2align 3
.type tile_table,@object
tile_table:
.long 0xffffffff
.long 0x20000
.long 0xffffffff
.long 0x1020000
.long 0xffffffff
.long 0x2020000
.long 0xffffffff
.long 0x3020000
.long 0xffffffff
.long 0x4020000
.long 0xffffffff
.long 0x5020000
.long 0xffffffff
.long 0x6020000
.long 0xffffffff
.long 0x7020000
.long 0xffffffff
.long 0x8020000
.long 0xffffffff
.long 0x9020000
.long 0xffffffff
.long 0xa020000
.long 0xffffffff
.long 0xb020000
.long 0xffffffff
.long 0xc020000
.long 0xffffffff
.long 0xd020000
.long 0xffffffff
.long 0xe020000
.long 0xffffffff
.long 0xf020000
.long 0xffffffff
.long 0x10020000
.long 0xffffffff
.long 0x11020000
.long 0xffffffff
.long 0x12020000
.long 0xffffffff
.long 0x13020000
.long 0xffffffff
.long 0x14020000
.long 0xffffffff
.long 0x15020000
.long 0xffffffff
.long 0x16020000
.long 0xffffffff
.long 0x17020000
.long 0xffffffff
.long 0x18020000
.long 0xffffffff
.long 0x19020000
.long 0xffffffff
.long 0x1a020000
.long 0xffffffff
.long 0x1b020000
.long 0xffffffff
.long 0x1c020000
.long 0xffffffff
.long 0x1d020000
.long 0xffffffff
.long 0x1e020000
.long 0xffffffff
.long 0x1f020000
.long 0x1c00030
.long 0x10105
.long 0xffff0070
.long 0x20020300
.long 0xffff0020
.long 0x101
.long 0xffff0060
.long 0x1010102
.long 0xffff00a0
.long 0x2010103
.long 0x38000e0
.long 0x3010104
.long 0x1c100b0
.long 0x401010d
.long 0xffff0181
.long 0x21020308
.long 0xffff0120
.long 0x1000109
.long 0xffff0160
.long 0x501010a
.long 0xffff01a0
.long 0x601010b
.long 0x78001e0
.long 0x701010c
.long 0x1c200f0
.long 0x8010115
.long 0xffff0130
.long 0x22020310
.long 0xffff0021
.long 0x2000111
.long 0xffff0061
.long 0x9010112
.long 0xffff00a1
.long 0xa010113
.long 0x38200e1
.long 0xb010114
.long 0x1c30170
.long 0xc01011d
.long 0xffff0183
.long 0x23020318
.long 0xffff0121
.long 0x3000119
.long 0xffff0161
.long 0xd01011a
.long 0xffff01a1
.long 0xe01011b
.long 0x78201e1
.long 0xf01011c
.long 0x1c401b0
.long 0x10010125
.long 0xffff01f0
.long 0x24020320
.long 0xffff0022
.long 0x4000121
.long 0xffff0062
.long 0x11010122
.long 0xffff00a2
.long 0x12010123
.long 0x38400e2
.long 0x13010124
.long 0x1c50031
.long 0x1401012d
.long 0xffff0185
.long 0x25020328
.long 0xffff0122
.long 0x5000129
.long 0xffff0162
.long 0x1501012a
.long 0xffff01a2
.long 0x1601012b
.long 0x78401e2
.long 0x1701012c
.long 0x1c60071
.long 0x18010135
.long 0xffff00b1
.long 0x26020330
.long 0xffff0023
.long 0x6000131
.long 0xffff0063
.long 0x19010132
.long 0xffff00a3
.long 0x1a010133
.long 0x38600e3
.long 0x1b010134
.long 0x1c700f1
.long 0x1c01013d
.long 0xffff0187
.long 0x27020338
.long 0xffff0123
.long 0x7000139
.long 0xffff0163
.long 0x1d01013a
.long 0xffff01a3
.long 0x1e01013b
.long 0x78601e3
.long 0x1f01013c
.long 0x1c80131
.long 0x20010145
.long 0xffff0171
.long 0x28020340
.long 0xffff0024
.long 0x8000141
.long 0xffff0064
.long 0x21010142
.long 0xffff00a4
.long 0x22010143
.long 0x38800e4
.long 0x23010144
.long 0x1c901b1
.long 0x2401014d
.long 0xffff0189
.long 0x29020348
.long 0xffff0124
.long 0x9000149
.long 0xffff0164
.long 0x2501014a
.long 0xffff01a4
.long 0x2601014b
.long 0x78801e4
.long 0x2701014c
.long 0x1ca01f1
.long 0x28010155
.long 0xffff0032
.long 0x2a020350
.long 0xffff0025
.long 0xa000151
.long 0xffff0065
.long 0x29010152
.long 0xffff00a5
.long 0x2a010153
.long 0x38a00e5
.long 0x2b010154
.long 0x1cb0072
.long 0x2c01015d
.long 0xffff018b
.long 0x2b020358
.long 0xffff0125
.long 0xb000159
.long 0xffff0165
.long 0x2d01015a
.long 0xffff01a5
.long 0x2e01015b
.long 0x78a01e5
.long 0x2f01015c
.long 0x1cc00b2
.long 0x30010165
.long 0xffff00f2
.long 0x2c020360
.long 0xffff0026
.long 0xc000161
.long 0xffff0066
.long 0x31010162
.long 0xffff00a6
.long 0x32010163
.long 0x38c00e6
.long 0x33010164
.long 0x1cd0132
.long 0x3401016d
.long 0xffff018d
.long 0x2d020368
.long 0xffff0126
.long 0xd000169
.long 0xffff0166
.long 0x3501016a
.long 0xffff01a6
.long 0x3601016b
.long 0x78c01e6
.long 0x3701016c
.long 0x1ce0172
.long 0x38010175
.long 0xffff01b2
.long 0x2e020370
.long 0xffff0027
.long 0xe000171
.long 0xffff0067
.long 0x39010172
.long 0xffff00a7
.long 0x3a010173
.long 0x38e00e7
.long 0x3b010174
.long 0x1cf01f2
.long 0x3c01017d
.long 0xffff018f
.long 0x2f020378
.long 0xffff0127
.long 0xf000179
.long 0xffff0167
.long 0x3d01017a
.long 0xffff01a7
.long 0x3e01017b
.long 0x78e01e7
.long 0x3f01017c
.long 0x1d00033
.long 0x40010185
.long 0xffff0073
.long 0x30020380
.long 0xffff0028
.long 0x10000181
.long 0xffff0068
.long 0x41010182
.long 0xffff00a8
.long 0x42010183
.long 0x39000e8
.long 0x43010184
.long 0x1d100b3
.long 0x4401018d
.long 0xffff0191
.long 0x31020388
.long 0xffff0128
.long 0x11000189
.long 0xffff0168
.long 0x4501018a
.long 0xffff01a8
.long 0x4601018b
.long 0x79001e8
.long 0x4701018c
.long 0x1d200f3
.long 0x48010195
.long 0xffff0133
.long 0x32020390
.long 0xffff0029
.long 0x12000191
.long 0xffff0069
.long 0x49010192
.long 0xffff00a9
.long 0x4a010193
.long 0x39200e9
.long 0x4b010194
.long 0x1d30173
.long 0x4c01019d
.long 0xffff0193
.long 0x33020398
.long 0xffff0129
.long 0x13000199
.long 0xffff0169
.long 0x4d01019a
.long 0xffff01a9
.long 0x4e01019b
.long 0x79201e9
.long 0x4f01019c
.long 0x1d401b3
.long 0x500101a5
.long 0xffff01f3
.long 0x340203a0
.long 0xffff002a
.long 0x140001a1
.long 0xffff006a
.long 0x510101a2
.long 0xffff00aa
.long 0x520101a3
.long 0x39400ea
.long 0x530101a4
.long 0x1d50034
.long 0x540101ad
.long 0xffff0195
.long 0x350203a8
.long 0xffff012a
.long 0x150001a9
.long 0xffff016a
.long 0x550101aa
.long 0xffff01aa
.long 0x560101ab
.long 0x79401ea
.long 0x570101ac
.long 0x1d60074
.long 0x580101b5
.long 0xffff00b4
.long 0x360203b0
.long 0xffff002b
.long 0x160001b1
.long 0xffff006b
.long 0x590101b2
.long 0xffff00ab
.long 0x5a0101b3
.long 0x39600eb
.long 0x5b0101b4
.long 0x1d700f4
.long 0x5c0101bd
.long 0xffff0197
.long 0x370203b8
.long 0xffff012b
.long 0x170001b9
.long 0xffff016b
.long 0x5d0101ba
.long 0xffff01ab
.long 0x5e0101bb
.long 0x79601eb
.long 0x5f0101bc
.long 0x1d80134
.long 0x600101c5
.long 0xffff0174
.long 0x380203c0
.long 0xffff002c
.long 0x180001c1
.long 0xffff006c
.long 0x610101c2
.long 0xffff00ac
.long 0x620101c3
.long 0x39800ec
.long 0x630101c4
.long 0x1d901b4
.long 0x640101cd
.long 0xffff0199
.long 0x390203c8
.long 0xffff012c
.long 0x190001c9
.long 0xffff016c
.long 0x650101ca
.long 0xffff01ac
.long 0x660101cb
.long 0x79801ec
.long 0x670101cc
.long 0x1da01f4
.long 0x680101d5
.long 0xffff0035
.long 0x3a0203d0
.long 0xffff002d
.long 0x1a0001d1
.long 0xffff006d
.long 0x690101d2
.long 0xffff00ad
.long 0x6a0101d3
.long 0x39a00ed
.long 0x6b0101d4
.long 0x1db0075
.long 0x6c0101dd
.long 0xffff019b
.long 0x3b0203d8
.long 0xffff012d
.long 0x1b0001d9
.long 0xffff016d
.long 0x6d0101da
.long 0xffff01ad
.long 0x6e0101db
.long 0x79a01ed
.long 0x6f0101dc
.long 0x1dc00b5
.long 0x700101e5
.long 0xffff00f5
.long 0x3c0203e0
.long 0xffff002e
.long 0x1c0001e1
.long 0xffff006e
.long 0x710101e2
.long 0xffff00ae
.long 0x720101e3
.long 0x39c00ee
.long 0x730101e4
.long 0x1dd0135
.long 0x740101ed
.long 0xffff019d
.long 0x3d0203e8
.long 0xffff012e
.long 0x1d0001e9
.long 0xffff016e
.long 0x750101ea
.long 0xffff01ae
.long 0x760101eb
.long 0x79c01ee
.long 0x770101ec
.long 0x1de0175
.long 0x780101f5
.long 0xffff01b5
.long 0x3e0203f0
.long 0xffff002f
.long 0x1e0001f1
.long 0xffff006f
.long 0x790101f2
.long 0xffff00af
.long 0x7a0101f3
.long 0x39e00ef
.long 0x7b0101f4
.long 0x1df01f5
.long 0x7c0101fd
.long 0xffff019f
.long 0x3f0203f8
.long 0xffff012f
.long 0x1f0001f9
.long 0xffff016f
.long 0x7d0101fa
.long 0xffff01af
.long 0x7e0101fb
.long 0x79e01ef
.long 0x7f0101fc
.size tile_table, 1792

.section .rodata,"a"
.p2align 6
.amdhsa_kernel gated_mix__memory_aug_recurrent_mem_tr__softmax_full_mha__prompt_kernel
  .amdhsa_next_free_vgpr 256
  .amdhsa_next_free_sgpr 102
  .amdhsa_accum_offset 256
  .amdhsa_group_segment_fixed_size 0
  .amdhsa_kernarg_size 112
  .amdhsa_user_sgpr_count 2
  .amdhsa_user_sgpr_kernarg_segment_ptr 1
  .amdhsa_system_sgpr_workgroup_id_x 1
.end_amdhsa_kernel
.text
```
